```python
import torch

def _softmax(x, axis=-1):
    return torch.softmax(x, dim=axis)
def _gelu(x):
    return torch.nn.functional.gelu(x, approximate="tanh")
def _silu(x):
    return torch.nn.functional.silu(x)
def _sigmoid(x):
    return torch.sigmoid(x)
def _layernorm(x, axis=-1, eps=1e-5):
    m = x.mean(dim=axis, keepdim=True)
    v = x.var(dim=axis, keepdim=True, unbiased=False)
    return (x - m) / torch.sqrt(v + eps)
def _scatter_add(tgt, idx, src, axis=0):
    return tgt.clone().index_add_(axis, idx, src)
def _segment_sum(src, seg, n):
    out = torch.zeros((n,) + src.shape[1:], dtype=src.dtype)
    return out.index_add_(0, seg, src)
def _pad(x, pw):
    flat = tuple(v for pair in reversed(pw) for v in pair)
    return torch.nn.functional.pad(x, flat)

kernel_name = 'concat_heads__softmax_full_mha__spectral_gfnet__prompt'

def setup_inputs():

    _w = (lambda a: (lambda t: t.to(torch.bfloat16) if t.is_floating_point() else t)(torch.as_tensor(a)))
    def _A_setup():
        B, S, D = 1, 2048, 448
        return {
            "x": _w((lambda *s: torch.randn(*s, dtype=torch.bfloat16) * 0.2)(B, S, D)),
            "wqkv": _w((lambda *s: torch.randn(*s, dtype=torch.bfloat16) * 0.2)(D, 3 * D)),
            "wo": _w((lambda *s: torch.randn(*s, dtype=torch.bfloat16) * 0.05)(D, D)),
        }
    _A_in = _A_setup()

    def _B_setup():
        B, S, D = 1, 2048, 448
        Df = D // 2 + 1
        return {
            "x": _w((lambda *s: torch.randn(*s, dtype=torch.bfloat16) * 0.05)(B, S, D)),
            "w_r": _w((lambda *s: torch.randn(*s, dtype=torch.bfloat16) * 6.4)(S, Df) * 0.02),
            "w_i": _w((lambda *s: torch.randn(*s, dtype=torch.bfloat16) * 6.4)(S, Df) * 0.02),
        }
    _B_in = _B_setup()

    return {
        "A_x": _A_in["x"],
        "A_wqkv": _A_in["wqkv"],
        "A_wo": _A_in["wo"],
        "B_x": _B_in["x"],
        "B_w_r": _B_in["w_r"],
        "B_w_i": _B_in["w_i"],
    }

def reference(A_x, A_wqkv, A_wo, B_x, B_w_r, B_w_i):
    def _A_ref(x, wqkv, wo):
        B, S, D = x.shape
        H = 16; Dh = D // H
        qkv = (lambda x, *d: x.permute(*d))((x @ wqkv).reshape(B, S, 3, H, Dh), 2, 0, 3, 1, 4)
        q, k, v = qkv[0], qkv[1], qkv[2]
        scale = Dh ** -0.5
        scores = torch.einsum("bhqd,bhkd->bhqk", q, k) * scale
        p = _softmax(scores, axis=-1)
        o = torch.einsum("bhqk,bhkd->bhqd", p, v)
        return (lambda x, *d: x.permute(*d))(o, 0, 2, 1, 3).reshape(B, S, D) @ wo

    def _B_ref(x, w_r, w_i):
        B, S, D = x.shape
        X = (lambda x, axes=(-2,-1): torch.fft.rfft2(x.float(), dim=axes))(x, axes=(-2, -1))
        W = w_r + 1j * w_i
        X = X * W
        y = (lambda x, s, axes=(-2,-1): torch.fft.irfft2(x, s=s, dim=axes).to(torch.bfloat16))(X, (S, D), axes=(-2, -1))
        return y

    a = _A_ref(A_x, A_wqkv, A_wo)
    b = _B_ref(B_x, B_w_r, B_w_i)
    return torch.concatenate([a, b], axis=-1)
```

```asm
; @launch grid=(256,1,1) block=(768,1,1) lds=163840
.amdgcn_target "amdgcn-amd-amdhsa--gfx950"
.text
.globl concat_heads__softmax_full_mha__spectral_gfnet__prompt_kernel
.p2align 8
.type concat_heads__softmax_full_mha__spectral_gfnet__prompt_kernel,@function
concat_heads__softmax_full_mha__spectral_gfnet__prompt_kernel:
    s_cmp_ge_u32 s2, 256
    s_cbranch_scc1 F_end
    s_load_dwordx16 s[4:19], s[0:1], 0
    s_load_dwordx2 s[20:21], s[0:1], 64
    v_and_b32 v1, 63, v0
    v_lshrrev_b32 v2, 6, v0
    s_nop 0
    v_readfirstlane_b32 s22, v2
    s_and_b32 s44, s2, 7
    s_lshr_b32 s45, s2, 3
    s_and_b32 s48, s44, 3
    s_lshr_b32 s46, s44, 2
    s_lshl_b32 s46, s46, 3
    s_and_b32 s47, s45, 7
    s_add_u32 s46, s46, s47
    s_lshr_b32 s49, s45, 3
    s_cmp_ge_u32 s22, 8
    s_cbranch_scc1 F_aux
    s_and_b32 s62, s22, 3
    s_lshl_b32 s62, s62, 12
    v_and_b32 v2, 31, v1
    v_lshlrev_b32 v3, 7, v2
    v_bfe_u32 v15, v1, 1, 3
    v_lshrrev_b32 v25, 5, v1
    v_xor_b32 v15, v15, v25
    v_lshl_add_u32 v3, v15, 4, v3
    v_add_u32 v4, s62, v3
    v_xor_b32 v5, 32, v4
    v_xor_b32 v6, 64, v4
    v_xor_b32 v7, 96, v4
    v_lshrrev_b32 v2, 5, v1
    v_bfe_u32 v3, v1, 2, 2
    v_lshl_add_u32 v2, v2, 3, v3
    v_lshlrev_b32 v2, 8, v2
    v_add_u32 v2, 16384, v2
    v_bfe_u32 v15, v1, 4, 1
    v_lshlrev_b32 v15, 5, v15
    v_and_b32 v25, 3, v1
    v_lshl_add_u32 v15, v25, 3, v15
    s_lshr_b32 s62, s22, 2
    s_mul_i32 s62, s62, 112
    v_lshlrev_b32 v26, 2, v3
    v_add_u32 v25, s62, v15
    v_lshrrev_b32 v27, 4, v25
    v_xor_b32 v27, v27, v26
    v_and_b32 v25, 15, v25
    v_lshl_add_u32 v25, v27, 4, v25
    v_add_u32 v8, v2, v25
    v_add_u32 v25, s62, v15
    v_add_u32 v25, 56, v25
    v_lshrrev_b32 v27, 4, v25
    v_xor_b32 v27, v27, v26
    v_and_b32 v25, 15, v25
    v_lshl_add_u32 v25, v27, 4, v25
    v_add_u32 v9, v2, v25
    v_mov_b32 v32, 0
    v_mov_b32 v33, 0
    v_mov_b32 v34, 0
    v_mov_b32 v35, 0
    v_mov_b32 v36, 0
    v_mov_b32 v37, 0
    v_mov_b32 v38, 0
    v_mov_b32 v39, 0
    v_mov_b32 v40, 0
    v_mov_b32 v41, 0
    v_mov_b32 v42, 0
    v_mov_b32 v43, 0
    v_mov_b32 v44, 0
    v_mov_b32 v45, 0
    v_mov_b32 v46, 0
    v_mov_b32 v47, 0
    v_mov_b32 v48, 0
    v_mov_b32 v49, 0
    v_mov_b32 v50, 0
    v_mov_b32 v51, 0
    v_mov_b32 v52, 0
    v_mov_b32 v53, 0
    v_mov_b32 v54, 0
    v_mov_b32 v55, 0
    v_mov_b32 v56, 0
    v_mov_b32 v57, 0
    v_mov_b32 v58, 0
    v_mov_b32 v59, 0
    v_mov_b32 v60, 0
    v_mov_b32 v61, 0
    v_mov_b32 v62, 0
    v_mov_b32 v63, 0
    s_waitcnt lgkmcnt(0)
    s_mov_b32 s24, s20
    s_and_b32 s25, s21, 0xffff
    s_mov_b32 s26, 14745600
    s_mov_b32 s27, 0x20000
    s_mov_b32 s72, s18
    s_and_b32 s73, s19, 0xffff
    s_mov_b32 s74, 256
    s_mov_b32 s75, 0x20000
    s_cmp_lg_u32 s22, 0
    s_cbranch_scc1 F_notag
    v_mov_b32 v2, 163824
    v_mov_b32 v3, 0
    ds_write_b32 v2, v3
    ds_write_b32 v2, v3 offset:4
    ds_write_b32 v2, v3 offset:8
    ds_write_b32 v2, v3 offset:12
    s_cmp_lg_u32 s2, 0
    s_cbranch_scc1 F_tagw
    s_memrealtime s[70:71]
    s_waitcnt lgkmcnt(0)
    s_or_b32 s70, s70, 1
    s_mov_b64 exec, 1
    v_mov_b32 v20, 0
    v_mov_b32 v2, s70
    v_mov_b32 v3, 0
    buffer_atomic_cmpswap v[2:3], v20, s[72:75], 0 offen sc1
    s_mov_b64 exec, -1
F_tagw:
    s_waitcnt lgkmcnt(0)
F_notag:
    s_cmp_ge_u32 s48, 2
    s_cbranch_scc1 F_vx
    s_barrier
    ds_read_b128 v[64:67], v4 offset:0
    ds_read_b64_tr_b16 v[72:73], v8 offset:0
    ds_read_b64_tr_b16 v[74:75], v8 offset:1024
    ds_read_b64_tr_b16 v[76:77], v9 offset:0
    ds_read_b64_tr_b16 v[78:79], v9 offset:1024
    ds_read_b128 v[68:71], v5 offset:0
    ds_read_b64_tr_b16 v[80:81], v8 offset:4096
    ds_read_b64_tr_b16 v[82:83], v8 offset:5120
    ds_read_b64_tr_b16 v[84:85], v9 offset:4096
    ds_read_b64_tr_b16 v[86:87], v9 offset:5120
    ds_read_b128 v[88:91], v6 offset:0
    ds_read_b64_tr_b16 v[92:93], v8 offset:8192
    ds_read_b64_tr_b16 v[94:95], v8 offset:9216
    ds_read_b64_tr_b16 v[96:97], v9 offset:8192
    ds_read_b64_tr_b16 v[98:99], v9 offset:9216
    s_waitcnt lgkmcnt(10)
    v_mfma_f32_32x32x16_bf16 v[32:47], v[72:75], v[64:67], v[32:47]
    v_mfma_f32_32x32x16_bf16 v[48:63], v[76:79], v[64:67], v[48:63]
    ds_read_b128 v[64:67], v7 offset:0
    ds_read_b64_tr_b16 v[72:73], v8 offset:12288
    ds_read_b64_tr_b16 v[74:75], v8 offset:13312
    ds_read_b64_tr_b16 v[76:77], v9 offset:12288
    ds_read_b64_tr_b16 v[78:79], v9 offset:13312
    s_waitcnt lgkmcnt(10)
    v_mfma_f32_32x32x16_bf16 v[32:47], v[80:83], v[68:71], v[32:47]
    v_mfma_f32_32x32x16_bf16 v[48:63], v[84:87], v[68:71], v[48:63]
    s_barrier
    ds_read_b128 v[68:71], v4 offset:32768
    ds_read_b64_tr_b16 v[80:81], v8 offset:32768
    ds_read_b64_tr_b16 v[82:83], v8 offset:33792
    ds_read_b64_tr_b16 v[84:85], v9 offset:32768
    ds_read_b64_tr_b16 v[86:87], v9 offset:33792
    s_waitcnt lgkmcnt(10)
    v_mfma_f32_32x32x16_bf16 v[32:47], v[92:95], v[88:91], v[32:47]
    v_mfma_f32_32x32x16_bf16 v[48:63], v[96:99], v[88:91], v[48:63]
    ds_read_b128 v[88:91], v5 offset:32768
    ds_read_b64_tr_b16 v[92:93], v8 offset:36864
    ds_read_b64_tr_b16 v[94:95], v8 offset:37888
    ds_read_b64_tr_b16 v[96:97], v9 offset:36864
    ds_read_b64_tr_b16 v[98:99], v9 offset:37888
    s_waitcnt lgkmcnt(10)
    v_mfma_f32_32x32x16_bf16 v[32:47], v[72:75], v[64:67], v[32:47]
    v_mfma_f32_32x32x16_bf16 v[48:63], v[76:79], v[64:67], v[48:63]
    ds_read_b128 v[64:67], v6 offset:32768
    ds_read_b64_tr_b16 v[72:73], v8 offset:40960
    ds_read_b64_tr_b16 v[74:75], v8 offset:41984
    ds_read_b64_tr_b16 v[76:77], v9 offset:40960
    ds_read_b64_tr_b16 v[78:79], v9 offset:41984
    s_waitcnt lgkmcnt(10)
    v_mfma_f32_32x32x16_bf16 v[32:47], v[80:83], v[68:71], v[32:47]
    v_mfma_f32_32x32x16_bf16 v[48:63], v[84:87], v[68:71], v[48:63]
    ds_read_b128 v[68:71], v7 offset:32768
    ds_read_b64_tr_b16 v[80:81], v8 offset:45056
    ds_read_b64_tr_b16 v[82:83], v8 offset:46080
    ds_read_b64_tr_b16 v[84:85], v9 offset:45056
    ds_read_b64_tr_b16 v[86:87], v9 offset:46080
    s_waitcnt lgkmcnt(10)
    v_mfma_f32_32x32x16_bf16 v[32:47], v[92:95], v[88:91], v[32:47]
    v_mfma_f32_32x32x16_bf16 v[48:63], v[96:99], v[88:91], v[48:63]
    s_barrier
    v_add_u32 v4, 0x10000, v4
    v_add_u32 v5, 0x10000, v5
    v_add_u32 v6, 0x10000, v6
    v_add_u32 v7, 0x10000, v7
    v_add_u32 v8, 0x10000, v8
    v_add_u32 v9, 0x10000, v9
    ds_read_b128 v[88:91], v4 offset:0
    ds_read_b64_tr_b16 v[92:93], v8 offset:0
    ds_read_b64_tr_b16 v[94:95], v8 offset:1024
    ds_read_b64_tr_b16 v[96:97], v9 offset:0
    ds_read_b64_tr_b16 v[98:99], v9 offset:1024
    s_waitcnt lgkmcnt(10)
    v_mfma_f32_32x32x16_bf16 v[32:47], v[72:75], v[64:67], v[32:47]
    v_mfma_f32_32x32x16_bf16 v[48:63], v[76:79], v[64:67], v[48:63]
    ds_read_b128 v[64:67], v5 offset:0
    ds_read_b64_tr_b16 v[72:73], v8 offset:4096
    ds_read_b64_tr_b16 v[74:75], v8 offset:5120
    ds_read_b64_tr_b16 v[76:77], v9 offset:4096
    ds_read_b64_tr_b16 v[78:79], v9 offset:5120
    s_waitcnt lgkmcnt(10)
    v_mfma_f32_32x32x16_bf16 v[32:47], v[80:83], v[68:71], v[32:47]
    v_mfma_f32_32x32x16_bf16 v[48:63], v[84:87], v[68:71], v[48:63]
    ds_read_b128 v[68:71], v6 offset:0
    ds_read_b64_tr_b16 v[80:81], v8 offset:8192
    ds_read_b64_tr_b16 v[82:83], v8 offset:9216
    ds_read_b64_tr_b16 v[84:85], v9 offset:8192
    ds_read_b64_tr_b16 v[86:87], v9 offset:9216
    s_waitcnt lgkmcnt(10)
    v_mfma_f32_32x32x16_bf16 v[32:47], v[92:95], v[88:91], v[32:47]
    v_mfma_f32_32x32x16_bf16 v[48:63], v[96:99], v[88:91], v[48:63]
    ds_read_b128 v[88:91], v7 offset:0
    ds_read_b64_tr_b16 v[92:93], v8 offset:12288
    ds_read_b64_tr_b16 v[94:95], v8 offset:13312
    ds_read_b64_tr_b16 v[96:97], v9 offset:12288
    ds_read_b64_tr_b16 v[98:99], v9 offset:13312
    s_waitcnt lgkmcnt(10)
    v_mfma_f32_32x32x16_bf16 v[32:47], v[72:75], v[64:67], v[32:47]
    v_mfma_f32_32x32x16_bf16 v[48:63], v[76:79], v[64:67], v[48:63]
    s_barrier
    ds_read_b128 v[64:67], v4 offset:32768
    ds_read_b64_tr_b16 v[72:73], v8 offset:32768
    ds_read_b64_tr_b16 v[74:75], v8 offset:33792
    ds_read_b64_tr_b16 v[76:77], v9 offset:32768
    ds_read_b64_tr_b16 v[78:79], v9 offset:33792
    s_waitcnt lgkmcnt(10)
    v_mfma_f32_32x32x16_bf16 v[32:47], v[80:83], v[68:71], v[32:47]
    v_mfma_f32_32x32x16_bf16 v[48:63], v[84:87], v[68:71], v[48:63]
    ds_read_b128 v[68:71], v5 offset:32768
    ds_read_b64_tr_b16 v[80:81], v8 offset:36864
    ds_read_b64_tr_b16 v[82:83], v8 offset:37888
    ds_read_b64_tr_b16 v[84:85], v9 offset:36864
    ds_read_b64_tr_b16 v[86:87], v9 offset:37888
    s_waitcnt lgkmcnt(10)
    v_mfma_f32_32x32x16_bf16 v[32:47], v[92:95], v[88:91], v[32:47]
    v_mfma_f32_32x32x16_bf16 v[48:63], v[96:99], v[88:91], v[48:63]
    ds_read_b128 v[88:91], v6 offset:32768
    ds_read_b64_tr_b16 v[92:93], v8 offset:40960
    ds_read_b64_tr_b16 v[94:95], v8 offset:41984
    ds_read_b64_tr_b16 v[96:97], v9 offset:40960
    ds_read_b64_tr_b16 v[98:99], v9 offset:41984
    s_waitcnt lgkmcnt(10)
    v_mfma_f32_32x32x16_bf16 v[32:47], v[72:75], v[64:67], v[32:47]
    v_mfma_f32_32x32x16_bf16 v[48:63], v[76:79], v[64:67], v[48:63]
    ds_read_b128 v[64:67], v7 offset:32768
    ds_read_b64_tr_b16 v[72:73], v8 offset:45056
    ds_read_b64_tr_b16 v[74:75], v8 offset:46080
    ds_read_b64_tr_b16 v[76:77], v9 offset:45056
    ds_read_b64_tr_b16 v[78:79], v9 offset:46080
    s_waitcnt lgkmcnt(10)
    v_mfma_f32_32x32x16_bf16 v[32:47], v[80:83], v[68:71], v[32:47]
    v_mfma_f32_32x32x16_bf16 v[48:63], v[84:87], v[68:71], v[48:63]
    s_barrier
    v_add_u32 v4, 0xffff0000, v4
    v_add_u32 v5, 0xffff0000, v5
    v_add_u32 v6, 0xffff0000, v6
    v_add_u32 v7, 0xffff0000, v7
    v_add_u32 v8, 0xffff0000, v8
    v_add_u32 v9, 0xffff0000, v9
    ds_read_b128 v[68:71], v4 offset:0
    ds_read_b64_tr_b16 v[80:81], v8 offset:0
    ds_read_b64_tr_b16 v[82:83], v8 offset:1024
    ds_read_b64_tr_b16 v[84:85], v9 offset:0
    ds_read_b64_tr_b16 v[86:87], v9 offset:1024
    s_waitcnt lgkmcnt(10)
    v_mfma_f32_32x32x16_bf16 v[32:47], v[92:95], v[88:91], v[32:47]
    v_mfma_f32_32x32x16_bf16 v[48:63], v[96:99], v[88:91], v[48:63]
    ds_read_b128 v[88:91], v5 offset:0
    ds_read_b64_tr_b16 v[92:93], v8 offset:4096
    ds_read_b64_tr_b16 v[94:95], v8 offset:5120
    ds_read_b64_tr_b16 v[96:97], v9 offset:4096
    ds_read_b64_tr_b16 v[98:99], v9 offset:5120
    s_waitcnt lgkmcnt(10)
    v_mfma_f32_32x32x16_bf16 v[32:47], v[72:75], v[64:67], v[32:47]
    v_mfma_f32_32x32x16_bf16 v[48:63], v[76:79], v[64:67], v[48:63]
    ds_read_b128 v[64:67], v6 offset:0
    ds_read_b64_tr_b16 v[72:73], v8 offset:8192
    ds_read_b64_tr_b16 v[74:75], v8 offset:9216
    ds_read_b64_tr_b16 v[76:77], v9 offset:8192
    ds_read_b64_tr_b16 v[78:79], v9 offset:9216
    s_waitcnt lgkmcnt(10)
    v_mfma_f32_32x32x16_bf16 v[32:47], v[80:83], v[68:71], v[32:47]
    v_mfma_f32_32x32x16_bf16 v[48:63], v[84:87], v[68:71], v[48:63]
    ds_read_b128 v[68:71], v7 offset:0
    ds_read_b64_tr_b16 v[80:81], v8 offset:12288
    ds_read_b64_tr_b16 v[82:83], v8 offset:13312
    ds_read_b64_tr_b16 v[84:85], v9 offset:12288
    ds_read_b64_tr_b16 v[86:87], v9 offset:13312
    s_waitcnt lgkmcnt(10)
    v_mfma_f32_32x32x16_bf16 v[32:47], v[92:95], v[88:91], v[32:47]
    v_mfma_f32_32x32x16_bf16 v[48:63], v[96:99], v[88:91], v[48:63]
    s_barrier
    ds_read_b128 v[88:91], v4 offset:32768
    ds_read_b64_tr_b16 v[92:93], v8 offset:32768
    ds_read_b64_tr_b16 v[94:95], v8 offset:33792
    ds_read_b64_tr_b16 v[96:97], v9 offset:32768
    ds_read_b64_tr_b16 v[98:99], v9 offset:33792
    s_waitcnt lgkmcnt(10)
    v_mfma_f32_32x32x16_bf16 v[32:47], v[72:75], v[64:67], v[32:47]
    v_mfma_f32_32x32x16_bf16 v[48:63], v[76:79], v[64:67], v[48:63]
    ds_read_b128 v[64:67], v5 offset:32768
    ds_read_b64_tr_b16 v[72:73], v8 offset:36864
    ds_read_b64_tr_b16 v[74:75], v8 offset:37888
    ds_read_b64_tr_b16 v[76:77], v9 offset:36864
    ds_read_b64_tr_b16 v[78:79], v9 offset:37888
    s_waitcnt lgkmcnt(10)
    v_mfma_f32_32x32x16_bf16 v[32:47], v[80:83], v[68:71], v[32:47]
    v_mfma_f32_32x32x16_bf16 v[48:63], v[84:87], v[68:71], v[48:63]
    ds_read_b128 v[68:71], v6 offset:32768
    ds_read_b64_tr_b16 v[80:81], v8 offset:40960
    ds_read_b64_tr_b16 v[82:83], v8 offset:41984
    ds_read_b64_tr_b16 v[84:85], v9 offset:40960
    ds_read_b64_tr_b16 v[86:87], v9 offset:41984
    s_waitcnt lgkmcnt(10)
    v_mfma_f32_32x32x16_bf16 v[32:47], v[92:95], v[88:91], v[32:47]
    v_mfma_f32_32x32x16_bf16 v[48:63], v[96:99], v[88:91], v[48:63]
    v_mov_b32 v101, 0
    buffer_load_dword v100, v101, s[72:75], 0 offen sc1
    ds_read_b128 v[88:91], v7 offset:32768
    ds_read_b64_tr_b16 v[92:93], v8 offset:45056
    ds_read_b64_tr_b16 v[94:95], v8 offset:46080
    ds_read_b64_tr_b16 v[96:97], v9 offset:45056
    ds_read_b64_tr_b16 v[98:99], v9 offset:46080
    s_waitcnt lgkmcnt(10)
    v_mfma_f32_32x32x16_bf16 v[32:47], v[72:75], v[64:67], v[32:47]
    v_mfma_f32_32x32x16_bf16 v[48:63], v[76:79], v[64:67], v[48:63]
    s_barrier
    v_add_u32 v4, 0x10000, v4
    v_add_u32 v5, 0x10000, v5
    v_add_u32 v6, 0x10000, v6
    v_add_u32 v7, 0x10000, v7
    v_add_u32 v8, 0x10000, v8
    v_add_u32 v9, 0x10000, v9
    ds_read_b128 v[64:67], v4 offset:0
    ds_read_b64_tr_b16 v[72:73], v8 offset:0
    ds_read_b64_tr_b16 v[74:75], v8 offset:1024
    ds_read_b64_tr_b16 v[76:77], v9 offset:0
    ds_read_b64_tr_b16 v[78:79], v9 offset:1024
    s_waitcnt lgkmcnt(10)
    v_mfma_f32_32x32x16_bf16 v[32:47], v[80:83], v[68:71], v[32:47]
    v_mfma_f32_32x32x16_bf16 v[48:63], v[84:87], v[68:71], v[48:63]
    ds_read_b128 v[68:71], v5 offset:0
    ds_read_b64_tr_b16 v[80:81], v8 offset:4096
    ds_read_b64_tr_b16 v[82:83], v8 offset:5120
    ds_read_b64_tr_b16 v[84:85], v9 offset:4096
    ds_read_b64_tr_b16 v[86:87], v9 offset:5120
    s_waitcnt lgkmcnt(10)
    v_mfma_f32_32x32x16_bf16 v[32:47], v[92:95], v[88:91], v[32:47]
    v_mfma_f32_32x32x16_bf16 v[48:63], v[96:99], v[88:91], v[48:63]
    ds_read_b128 v[88:91], v6 offset:0
    ds_read_b64_tr_b16 v[92:93], v8 offset:8192
    ds_read_b64_tr_b16 v[94:95], v8 offset:9216
    ds_read_b64_tr_b16 v[96:97], v9 offset:8192
    ds_read_b64_tr_b16 v[98:99], v9 offset:9216
    s_waitcnt lgkmcnt(10)
    v_mfma_f32_32x32x16_bf16 v[32:47], v[72:75], v[64:67], v[32:47]
    v_mfma_f32_32x32x16_bf16 v[48:63], v[76:79], v[64:67], v[48:63]
    ds_read_b128 v[64:67], v7 offset:0
    ds_read_b64_tr_b16 v[72:73], v8 offset:12288
    ds_read_b64_tr_b16 v[74:75], v8 offset:13312
    ds_read_b64_tr_b16 v[76:77], v9 offset:12288
    ds_read_b64_tr_b16 v[78:79], v9 offset:13312
    s_waitcnt lgkmcnt(10)
    v_mfma_f32_32x32x16_bf16 v[32:47], v[80:83], v[68:71], v[32:47]
    v_mfma_f32_32x32x16_bf16 v[48:63], v[84:87], v[68:71], v[48:63]
    s_waitcnt lgkmcnt(5)
    v_mfma_f32_32x32x16_bf16 v[32:47], v[92:95], v[88:91], v[32:47]
    v_mfma_f32_32x32x16_bf16 v[48:63], v[96:99], v[88:91], v[48:63]
    s_waitcnt lgkmcnt(0)
    v_mfma_f32_32x32x16_bf16 v[32:47], v[72:75], v[64:67], v[32:47]
    v_mfma_f32_32x32x16_bf16 v[48:63], v[76:79], v[64:67], v[48:63]
    s_nop 15
    s_waitcnt vmcnt(0)
    v_readfirstlane_b32 s23, v100
    s_nop 3
    s_cmp_lg_u32 s23, 0
    s_cbranch_scc1 tg1
    s_mov_b32 s72, s18
    s_and_b32 s73, s19, 0xffff
    s_mov_b32 s74, 256
    s_mov_b32 s75, 0x20000
    v_mov_b32 v2, 0
    s_mov_b32 s70, 0
tagL2:
    buffer_load_dword v3, v2, s[72:75], 0 offen sc1
    s_waitcnt vmcnt(0)
    v_readfirstlane_b32 s23, v3
    s_nop 3
    s_cmp_lg_u32 s23, 0
    s_cbranch_scc1 tagD2
    s_add_u32 s70, s70, 1
    s_cmp_lt_u32 s70, 400000
    s_sleep 1
    s_cbranch_scc1 tagL2
tagD2:
tg1:
    s_lshl_b32 s58, s49, 2
    s_lshr_b32 s59, s22, 2
    s_lshl_b32 s59, s59, 1
    s_add_u32 s58, s58, s59
    s_lshl_b32 s58, s58, 6
    s_lshl_b32 s59, s46, 2
    s_add_u32 s58, s58, s59
    s_and_b32 s59, s22, 3
    s_add_u32 s58, s58, s59
    v_lshlrev_b32 v2, 4, v1
    s_cmp_eq_u32 s48, 1
    s_cbranch_scc1 F_kep
    s_mov_b32 s62, 0x3e8b97f6
    v_mul_f32 v32, s62, v32
    v_mul_f32 v33, s62, v33
    v_mul_f32 v34, s62, v34
    v_mul_f32 v35, s62, v35
    v_mul_f32 v36, s62, v36
    v_mul_f32 v37, s62, v37
    v_mul_f32 v38, s62, v38
    v_mul_f32 v39, s62, v39
    v_mul_f32 v40, s62, v40
    v_mul_f32 v41, s62, v41
    v_mul_f32 v42, s62, v42
    v_mul_f32 v43, s62, v43
    v_mul_f32 v44, s62, v44
    v_mul_f32 v45, s62, v45
    v_mul_f32 v46, s62, v46
    v_mul_f32 v47, s62, v47
    v_mul_f32 v48, s62, v48
    v_mul_f32 v49, s62, v49
    v_mul_f32 v50, s62, v50
    v_mul_f32 v51, s62, v51
    v_mul_f32 v52, s62, v52
    v_mul_f32 v53, s62, v53
    v_mul_f32 v54, s62, v54
    v_mul_f32 v55, s62, v55
    v_mul_f32 v56, s62, v56
    v_mul_f32 v57, s62, v57
    v_mul_f32 v58, s62, v58
    v_mul_f32 v59, s62, v59
    v_mul_f32 v60, s62, v60
    v_mul_f32 v61, s62, v61
    v_mul_f32 v62, s62, v62
    v_mul_f32 v63, s62, v63
    s_mov_b32 exec_lo, 0
    v_mov_b32 v44, 0
    v_mov_b32 v45, 0
    v_mov_b32 v46, 0
    v_mov_b32 v47, 0
    v_mov_b32 v60, 0
    v_mov_b32 v61, 0
    v_mov_b32 v62, 0
    v_mov_b32 v63, 0
    s_mov_b32 exec_lo, -1
    v_cvt_pk_bf16_f32 v64, v32, v33
    v_cvt_pk_bf16_f32 v65, v34, v35
    v_cvt_pk_bf16_f32 v66, v36, v37
    v_cvt_pk_bf16_f32 v67, v38, v39
    v_cvt_pk_bf16_f32 v68, v40, v41
    v_cvt_pk_bf16_f32 v69, v42, v43
    v_cvt_pk_bf16_f32 v70, v44, v45
    v_cvt_pk_bf16_f32 v71, v46, v47
    v_cvt_pk_bf16_f32 v72, v48, v49
    v_cvt_pk_bf16_f32 v73, v50, v51
    v_cvt_pk_bf16_f32 v74, v52, v53
    v_cvt_pk_bf16_f32 v75, v54, v55
    v_cvt_pk_bf16_f32 v76, v56, v57
    v_cvt_pk_bf16_f32 v77, v58, v59
    v_cvt_pk_bf16_f32 v78, v60, v61
    v_cvt_pk_bf16_f32 v79, v62, v63
    s_lshl_b32 s58, s58, 11
    s_add_u32 s58, s58, 0
    s_add_u32 s59, s58, 0
    buffer_store_dwordx4 v[64:67], v2, s[24:27], s59 offen sc1
    s_add_u32 s59, s58, 1024
    buffer_store_dwordx4 v[68:71], v2, s[24:27], s59 offen sc1
    s_add_u32 s59, s58, 131072
    buffer_store_dwordx4 v[72:75], v2, s[24:27], s59 offen sc1
    s_add_u32 s59, s58, 132096
    buffer_store_dwordx4 v[76:79], v2, s[24:27], s59 offen sc1
    s_branch F_p1done
F_kep:
    s_mov_b32 exec_lo, 0
    v_mov_b32 v44, 1.0
    v_mov_b32 v45, 0
    v_mov_b32 v46, 0
    v_mov_b32 v47, 0
    v_mov_b32 v60, 1.0
    v_mov_b32 v61, 0
    v_mov_b32 v62, 0
    v_mov_b32 v63, 0
    s_mov_b32 exec_lo, -1
    v_cvt_pk_bf16_f32 v64, v32, v33
    v_cvt_pk_bf16_f32 v65, v34, v35
    v_cvt_pk_bf16_f32 v66, v36, v37
    v_cvt_pk_bf16_f32 v67, v38, v39
    v_cvt_pk_bf16_f32 v68, v40, v41
    v_cvt_pk_bf16_f32 v69, v42, v43
    v_cvt_pk_bf16_f32 v70, v44, v45
    v_cvt_pk_bf16_f32 v71, v46, v47
    v_cvt_pk_bf16_f32 v72, v48, v49
    v_cvt_pk_bf16_f32 v73, v50, v51
    v_cvt_pk_bf16_f32 v74, v52, v53
    v_cvt_pk_bf16_f32 v75, v54, v55
    v_cvt_pk_bf16_f32 v76, v56, v57
    v_cvt_pk_bf16_f32 v77, v58, v59
    v_cvt_pk_bf16_f32 v78, v60, v61
    v_cvt_pk_bf16_f32 v79, v62, v63
    s_lshl_b32 s58, s58, 12
    s_add_u32 s58, s58, 2097152
    s_add_u32 s59, s58, 0
    buffer_store_dwordx4 v[64:67], v2, s[24:27], s59 offen sc1
    s_add_u32 s59, s58, 1024
    buffer_store_dwordx4 v[68:71], v2, s[24:27], s59 offen sc1
    s_add_u32 s59, s58, 262144
    buffer_store_dwordx4 v[72:75], v2, s[24:27], s59 offen sc1
    s_add_u32 s59, s58, 263168
    buffer_store_dwordx4 v[76:79], v2, s[24:27], s59 offen sc1
    s_branch F_p1done
F_vx:
    s_barrier
    ds_read_b128 v[64:67], v4 offset:0
    ds_read_b64_tr_b16 v[72:73], v8 offset:0
    ds_read_b64_tr_b16 v[74:75], v8 offset:1024
    ds_read_b64_tr_b16 v[76:77], v9 offset:0
    ds_read_b64_tr_b16 v[78:79], v9 offset:1024
    ds_read_b128 v[68:71], v5 offset:0
    ds_read_b64_tr_b16 v[80:81], v8 offset:4096
    ds_read_b64_tr_b16 v[82:83], v8 offset:5120
    ds_read_b64_tr_b16 v[84:85], v9 offset:4096
    ds_read_b64_tr_b16 v[86:87], v9 offset:5120
    ds_read_b128 v[88:91], v6 offset:0
    ds_read_b64_tr_b16 v[92:93], v8 offset:8192
    ds_read_b64_tr_b16 v[94:95], v8 offset:9216
    ds_read_b64_tr_b16 v[96:97], v9 offset:8192
    ds_read_b64_tr_b16 v[98:99], v9 offset:9216
    s_waitcnt lgkmcnt(10)
    v_mfma_f32_32x32x16_bf16 v[32:47], v[64:67], v[72:75], v[32:47]
    v_mfma_f32_32x32x16_bf16 v[48:63], v[64:67], v[76:79], v[48:63]
    ds_read_b128 v[64:67], v7 offset:0
    ds_read_b64_tr_b16 v[72:73], v8 offset:12288
    ds_read_b64_tr_b16 v[74:75], v8 offset:13312
    ds_read_b64_tr_b16 v[76:77], v9 offset:12288
    ds_read_b64_tr_b16 v[78:79], v9 offset:13312
    s_waitcnt lgkmcnt(10)
    v_mfma_f32_32x32x16_bf16 v[32:47], v[68:71], v[80:83], v[32:47]
    v_mfma_f32_32x32x16_bf16 v[48:63], v[68:71], v[84:87], v[48:63]
    s_barrier
    ds_read_b128 v[68:71], v4 offset:32768
    ds_read_b64_tr_b16 v[80:81], v8 offset:32768
    ds_read_b64_tr_b16 v[82:83], v8 offset:33792
    ds_read_b64_tr_b16 v[84:85], v9 offset:32768
    ds_read_b64_tr_b16 v[86:87], v9 offset:33792
    s_waitcnt lgkmcnt(10)
    v_mfma_f32_32x32x16_bf16 v[32:47], v[88:91], v[92:95], v[32:47]
    v_mfma_f32_32x32x16_bf16 v[48:63], v[88:91], v[96:99], v[48:63]
    ds_read_b128 v[88:91], v5 offset:32768
    ds_read_b64_tr_b16 v[92:93], v8 offset:36864
    ds_read_b64_tr_b16 v[94:95], v8 offset:37888
    ds_read_b64_tr_b16 v[96:97], v9 offset:36864
    ds_read_b64_tr_b16 v[98:99], v9 offset:37888
    s_waitcnt lgkmcnt(10)
    v_mfma_f32_32x32x16_bf16 v[32:47], v[64:67], v[72:75], v[32:47]
    v_mfma_f32_32x32x16_bf16 v[48:63], v[64:67], v[76:79], v[48:63]
    ds_read_b128 v[64:67], v6 offset:32768
    ds_read_b64_tr_b16 v[72:73], v8 offset:40960
    ds_read_b64_tr_b16 v[74:75], v8 offset:41984
    ds_read_b64_tr_b16 v[76:77], v9 offset:40960
    ds_read_b64_tr_b16 v[78:79], v9 offset:41984
    s_waitcnt lgkmcnt(10)
    v_mfma_f32_32x32x16_bf16 v[32:47], v[68:71], v[80:83], v[32:47]
    v_mfma_f32_32x32x16_bf16 v[48:63], v[68:71], v[84:87], v[48:63]
    ds_read_b128 v[68:71], v7 offset:32768
    ds_read_b64_tr_b16 v[80:81], v8 offset:45056
    ds_read_b64_tr_b16 v[82:83], v8 offset:46080
    ds_read_b64_tr_b16 v[84:85], v9 offset:45056
    ds_read_b64_tr_b16 v[86:87], v9 offset:46080
    s_waitcnt lgkmcnt(10)
    v_mfma_f32_32x32x16_bf16 v[32:47], v[88:91], v[92:95], v[32:47]
    v_mfma_f32_32x32x16_bf16 v[48:63], v[88:91], v[96:99], v[48:63]
    s_barrier
    v_add_u32 v4, 0x10000, v4
    v_add_u32 v5, 0x10000, v5
    v_add_u32 v6, 0x10000, v6
    v_add_u32 v7, 0x10000, v7
    v_add_u32 v8, 0x10000, v8
    v_add_u32 v9, 0x10000, v9
    ds_read_b128 v[88:91], v4 offset:0
    ds_read_b64_tr_b16 v[92:93], v8 offset:0
    ds_read_b64_tr_b16 v[94:95], v8 offset:1024
    ds_read_b64_tr_b16 v[96:97], v9 offset:0
    ds_read_b64_tr_b16 v[98:99], v9 offset:1024
    s_waitcnt lgkmcnt(10)
    v_mfma_f32_32x32x16_bf16 v[32:47], v[64:67], v[72:75], v[32:47]
    v_mfma_f32_32x32x16_bf16 v[48:63], v[64:67], v[76:79], v[48:63]
    ds_read_b128 v[64:67], v5 offset:0
    ds_read_b64_tr_b16 v[72:73], v8 offset:4096
    ds_read_b64_tr_b16 v[74:75], v8 offset:5120
    ds_read_b64_tr_b16 v[76:77], v9 offset:4096
    ds_read_b64_tr_b16 v[78:79], v9 offset:5120
    s_waitcnt lgkmcnt(10)
    v_mfma_f32_32x32x16_bf16 v[32:47], v[68:71], v[80:83], v[32:47]
    v_mfma_f32_32x32x16_bf16 v[48:63], v[68:71], v[84:87], v[48:63]
    ds_read_b128 v[68:71], v6 offset:0
    ds_read_b64_tr_b16 v[80:81], v8 offset:8192
    ds_read_b64_tr_b16 v[82:83], v8 offset:9216
    ds_read_b64_tr_b16 v[84:85], v9 offset:8192
    ds_read_b64_tr_b16 v[86:87], v9 offset:9216
    s_waitcnt lgkmcnt(10)
    v_mfma_f32_32x32x16_bf16 v[32:47], v[88:91], v[92:95], v[32:47]
    v_mfma_f32_32x32x16_bf16 v[48:63], v[88:91], v[96:99], v[48:63]
    ds_read_b128 v[88:91], v7 offset:0
    ds_read_b64_tr_b16 v[92:93], v8 offset:12288
    ds_read_b64_tr_b16 v[94:95], v8 offset:13312
    ds_read_b64_tr_b16 v[96:97], v9 offset:12288
    ds_read_b64_tr_b16 v[98:99], v9 offset:13312
    s_waitcnt lgkmcnt(10)
    v_mfma_f32_32x32x16_bf16 v[32:47], v[64:67], v[72:75], v[32:47]
    v_mfma_f32_32x32x16_bf16 v[48:63], v[64:67], v[76:79], v[48:63]
    s_barrier
    ds_read_b128 v[64:67], v4 offset:32768
    ds_read_b64_tr_b16 v[72:73], v8 offset:32768
    ds_read_b64_tr_b16 v[74:75], v8 offset:33792
    ds_read_b64_tr_b16 v[76:77], v9 offset:32768
    ds_read_b64_tr_b16 v[78:79], v9 offset:33792
    s_waitcnt lgkmcnt(10)
    v_mfma_f32_32x32x16_bf16 v[32:47], v[68:71], v[80:83], v[32:47]
    v_mfma_f32_32x32x16_bf16 v[48:63], v[68:71], v[84:87], v[48:63]
    ds_read_b128 v[68:71], v5 offset:32768
    ds_read_b64_tr_b16 v[80:81], v8 offset:36864
    ds_read_b64_tr_b16 v[82:83], v8 offset:37888
    ds_read_b64_tr_b16 v[84:85], v9 offset:36864
    ds_read_b64_tr_b16 v[86:87], v9 offset:37888
    s_waitcnt lgkmcnt(10)
    v_mfma_f32_32x32x16_bf16 v[32:47], v[88:91], v[92:95], v[32:47]
    v_mfma_f32_32x32x16_bf16 v[48:63], v[88:91], v[96:99], v[48:63]
    ds_read_b128 v[88:91], v6 offset:32768
    ds_read_b64_tr_b16 v[92:93], v8 offset:40960
    ds_read_b64_tr_b16 v[94:95], v8 offset:41984
    ds_read_b64_tr_b16 v[96:97], v9 offset:40960
    ds_read_b64_tr_b16 v[98:99], v9 offset:41984
    s_waitcnt lgkmcnt(10)
    v_mfma_f32_32x32x16_bf16 v[32:47], v[64:67], v[72:75], v[32:47]
    v_mfma_f32_32x32x16_bf16 v[48:63], v[64:67], v[76:79], v[48:63]
    ds_read_b128 v[64:67], v7 offset:32768
    ds_read_b64_tr_b16 v[72:73], v8 offset:45056
    ds_read_b64_tr_b16 v[74:75], v8 offset:46080
    ds_read_b64_tr_b16 v[76:77], v9 offset:45056
    ds_read_b64_tr_b16 v[78:79], v9 offset:46080
    s_waitcnt lgkmcnt(10)
    v_mfma_f32_32x32x16_bf16 v[32:47], v[68:71], v[80:83], v[32:47]
    v_mfma_f32_32x32x16_bf16 v[48:63], v[68:71], v[84:87], v[48:63]
    s_barrier
    v_add_u32 v4, 0xffff0000, v4
    v_add_u32 v5, 0xffff0000, v5
    v_add_u32 v6, 0xffff0000, v6
    v_add_u32 v7, 0xffff0000, v7
    v_add_u32 v8, 0xffff0000, v8
    v_add_u32 v9, 0xffff0000, v9
    ds_read_b128 v[68:71], v4 offset:0
    ds_read_b64_tr_b16 v[80:81], v8 offset:0
    ds_read_b64_tr_b16 v[82:83], v8 offset:1024
    ds_read_b64_tr_b16 v[84:85], v9 offset:0
    ds_read_b64_tr_b16 v[86:87], v9 offset:1024
    s_waitcnt lgkmcnt(10)
    v_mfma_f32_32x32x16_bf16 v[32:47], v[88:91], v[92:95], v[32:47]
    v_mfma_f32_32x32x16_bf16 v[48:63], v[88:91], v[96:99], v[48:63]
    ds_read_b128 v[88:91], v5 offset:0
    ds_read_b64_tr_b16 v[92:93], v8 offset:4096
    ds_read_b64_tr_b16 v[94:95], v8 offset:5120
    ds_read_b64_tr_b16 v[96:97], v9 offset:4096
    ds_read_b64_tr_b16 v[98:99], v9 offset:5120
    s_waitcnt lgkmcnt(10)
    v_mfma_f32_32x32x16_bf16 v[32:47], v[64:67], v[72:75], v[32:47]
    v_mfma_f32_32x32x16_bf16 v[48:63], v[64:67], v[76:79], v[48:63]
    ds_read_b128 v[64:67], v6 offset:0
    ds_read_b64_tr_b16 v[72:73], v8 offset:8192
    ds_read_b64_tr_b16 v[74:75], v8 offset:9216
    ds_read_b64_tr_b16 v[76:77], v9 offset:8192
    ds_read_b64_tr_b16 v[78:79], v9 offset:9216
    s_waitcnt lgkmcnt(10)
    v_mfma_f32_32x32x16_bf16 v[32:47], v[68:71], v[80:83], v[32:47]
    v_mfma_f32_32x32x16_bf16 v[48:63], v[68:71], v[84:87], v[48:63]
    ds_read_b128 v[68:71], v7 offset:0
    ds_read_b64_tr_b16 v[80:81], v8 offset:12288
    ds_read_b64_tr_b16 v[82:83], v8 offset:13312
    ds_read_b64_tr_b16 v[84:85], v9 offset:12288
    ds_read_b64_tr_b16 v[86:87], v9 offset:13312
    s_waitcnt lgkmcnt(10)
    v_mfma_f32_32x32x16_bf16 v[32:47], v[88:91], v[92:95], v[32:47]
    v_mfma_f32_32x32x16_bf16 v[48:63], v[88:91], v[96:99], v[48:63]
    s_barrier
    ds_read_b128 v[88:91], v4 offset:32768
    ds_read_b64_tr_b16 v[92:93], v8 offset:32768
    ds_read_b64_tr_b16 v[94:95], v8 offset:33792
    ds_read_b64_tr_b16 v[96:97], v9 offset:32768
    ds_read_b64_tr_b16 v[98:99], v9 offset:33792
    s_waitcnt lgkmcnt(10)
    v_mfma_f32_32x32x16_bf16 v[32:47], v[64:67], v[72:75], v[32:47]
    v_mfma_f32_32x32x16_bf16 v[48:63], v[64:67], v[76:79], v[48:63]
    ds_read_b128 v[64:67], v5 offset:32768
    ds_read_b64_tr_b16 v[72:73], v8 offset:36864
    ds_read_b64_tr_b16 v[74:75], v8 offset:37888
    ds_read_b64_tr_b16 v[76:77], v9 offset:36864
    ds_read_b64_tr_b16 v[78:79], v9 offset:37888
    s_waitcnt lgkmcnt(10)
    v_mfma_f32_32x32x16_bf16 v[32:47], v[68:71], v[80:83], v[32:47]
    v_mfma_f32_32x32x16_bf16 v[48:63], v[68:71], v[84:87], v[48:63]
    ds_read_b128 v[68:71], v6 offset:32768
    ds_read_b64_tr_b16 v[80:81], v8 offset:40960
    ds_read_b64_tr_b16 v[82:83], v8 offset:41984
    ds_read_b64_tr_b16 v[84:85], v9 offset:40960
    ds_read_b64_tr_b16 v[86:87], v9 offset:41984
    s_waitcnt lgkmcnt(10)
    v_mfma_f32_32x32x16_bf16 v[32:47], v[88:91], v[92:95], v[32:47]
    v_mfma_f32_32x32x16_bf16 v[48:63], v[88:91], v[96:99], v[48:63]
    v_mov_b32 v101, 0
    buffer_load_dword v100, v101, s[72:75], 0 offen sc1
    ds_read_b128 v[88:91], v7 offset:32768
    ds_read_b64_tr_b16 v[92:93], v8 offset:45056
    ds_read_b64_tr_b16 v[94:95], v8 offset:46080
    ds_read_b64_tr_b16 v[96:97], v9 offset:45056
    ds_read_b64_tr_b16 v[98:99], v9 offset:46080
    s_waitcnt lgkmcnt(10)
    v_mfma_f32_32x32x16_bf16 v[32:47], v[64:67], v[72:75], v[32:47]
    v_mfma_f32_32x32x16_bf16 v[48:63], v[64:67], v[76:79], v[48:63]
    s_barrier
    v_add_u32 v4, 0x10000, v4
    v_add_u32 v5, 0x10000, v5
    v_add_u32 v6, 0x10000, v6
    v_add_u32 v7, 0x10000, v7
    v_add_u32 v8, 0x10000, v8
    v_add_u32 v9, 0x10000, v9
    ds_read_b128 v[64:67], v4 offset:0
    ds_read_b64_tr_b16 v[72:73], v8 offset:0
    ds_read_b64_tr_b16 v[74:75], v8 offset:1024
    ds_read_b64_tr_b16 v[76:77], v9 offset:0
    ds_read_b64_tr_b16 v[78:79], v9 offset:1024
    s_waitcnt lgkmcnt(10)
    v_mfma_f32_32x32x16_bf16 v[32:47], v[68:71], v[80:83], v[32:47]
    v_mfma_f32_32x32x16_bf16 v[48:63], v[68:71], v[84:87], v[48:63]
    ds_read_b128 v[68:71], v5 offset:0
    ds_read_b64_tr_b16 v[80:81], v8 offset:4096
    ds_read_b64_tr_b16 v[82:83], v8 offset:5120
    ds_read_b64_tr_b16 v[84:85], v9 offset:4096
    ds_read_b64_tr_b16 v[86:87], v9 offset:5120
    s_waitcnt lgkmcnt(10)
    v_mfma_f32_32x32x16_bf16 v[32:47], v[88:91], v[92:95], v[32:47]
    v_mfma_f32_32x32x16_bf16 v[48:63], v[88:91], v[96:99], v[48:63]
    ds_read_b128 v[88:91], v6 offset:0
    ds_read_b64_tr_b16 v[92:93], v8 offset:8192
    ds_read_b64_tr_b16 v[94:95], v8 offset:9216
    ds_read_b64_tr_b16 v[96:97], v9 offset:8192
    ds_read_b64_tr_b16 v[98:99], v9 offset:9216
    s_waitcnt lgkmcnt(10)
    v_mfma_f32_32x32x16_bf16 v[32:47], v[64:67], v[72:75], v[32:47]
    v_mfma_f32_32x32x16_bf16 v[48:63], v[64:67], v[76:79], v[48:63]
    ds_read_b128 v[64:67], v7 offset:0
    ds_read_b64_tr_b16 v[72:73], v8 offset:12288
    ds_read_b64_tr_b16 v[74:75], v8 offset:13312
    ds_read_b64_tr_b16 v[76:77], v9 offset:12288
    ds_read_b64_tr_b16 v[78:79], v9 offset:13312
    s_waitcnt lgkmcnt(10)
    v_mfma_f32_32x32x16_bf16 v[32:47], v[68:71], v[80:83], v[32:47]
    v_mfma_f32_32x32x16_bf16 v[48:63], v[68:71], v[84:87], v[48:63]
    s_waitcnt lgkmcnt(5)
    v_mfma_f32_32x32x16_bf16 v[32:47], v[88:91], v[92:95], v[32:47]
    v_mfma_f32_32x32x16_bf16 v[48:63], v[88:91], v[96:99], v[48:63]
    s_waitcnt lgkmcnt(0)
    v_mfma_f32_32x32x16_bf16 v[32:47], v[64:67], v[72:75], v[32:47]
    v_mfma_f32_32x32x16_bf16 v[48:63], v[64:67], v[76:79], v[48:63]
    s_nop 15
    s_waitcnt vmcnt(0)
    v_readfirstlane_b32 s23, v100
    s_nop 3
    s_cmp_lg_u32 s23, 0
    s_cbranch_scc1 tg3
    s_mov_b32 s72, s18
    s_and_b32 s73, s19, 0xffff
    s_mov_b32 s74, 256
    s_mov_b32 s75, 0x20000
    v_mov_b32 v2, 0
    s_mov_b32 s70, 0
tagL4:
    buffer_load_dword v3, v2, s[72:75], 0 offen sc1
    s_waitcnt vmcnt(0)
    v_readfirstlane_b32 s23, v3
    s_nop 3
    s_cmp_lg_u32 s23, 0
    s_cbranch_scc1 tagD4
    s_add_u32 s70, s70, 1
    s_cmp_lt_u32 s70, 400000
    s_sleep 1
    s_cbranch_scc1 tagL4
tagD4:
tg3:
    s_cmp_eq_u32 s48, 3
    s_cbranch_scc1 F_xep
    v_and_b32 v2, 31, v1
    v_cmp_lt_u32 vcc, 27, v2
    s_and_saveexec_b64 s[64:65], vcc
    v_cmp_eq_u32 vcc, 28, v2
    s_nop 1
    v_cndmask_b32 v3, 0, 1.0, vcc
    v_mov_b32 v32, v3
    v_mov_b32 v33, v3
    v_mov_b32 v34, v3
    v_mov_b32 v35, v3
    v_mov_b32 v36, v3
    v_mov_b32 v37, v3
    v_mov_b32 v38, v3
    v_mov_b32 v39, v3
    v_mov_b32 v40, v3
    v_mov_b32 v41, v3
    v_mov_b32 v42, v3
    v_mov_b32 v43, v3
    v_mov_b32 v44, v3
    v_mov_b32 v45, v3
    v_mov_b32 v46, v3
    v_mov_b32 v47, v3
    v_mov_b32 v48, v3
    v_mov_b32 v49, v3
    v_mov_b32 v50, v3
    v_mov_b32 v51, v3
    v_mov_b32 v52, v3
    v_mov_b32 v53, v3
    v_mov_b32 v54, v3
    v_mov_b32 v55, v3
    v_mov_b32 v56, v3
    v_mov_b32 v57, v3
    v_mov_b32 v58, v3
    v_mov_b32 v59, v3
    v_mov_b32 v60, v3
    v_mov_b32 v61, v3
    v_mov_b32 v62, v3
    v_mov_b32 v63, v3
    s_mov_b64 exec, s[64:65]
    v_cvt_pk_bf16_f32 v64, v32, v33
    v_cvt_pk_bf16_f32 v65, v34, v35
    v_cvt_pk_bf16_f32 v66, v36, v37
    v_cvt_pk_bf16_f32 v67, v38, v39
    v_cvt_pk_bf16_f32 v68, v40, v41
    v_cvt_pk_bf16_f32 v69, v42, v43
    v_cvt_pk_bf16_f32 v70, v44, v45
    v_cvt_pk_bf16_f32 v71, v46, v47
    v_cvt_pk_bf16_f32 v72, v48, v49
    v_cvt_pk_bf16_f32 v73, v50, v51
    v_cvt_pk_bf16_f32 v74, v52, v53
    v_cvt_pk_bf16_f32 v75, v54, v55
    v_cvt_pk_bf16_f32 v76, v56, v57
    v_cvt_pk_bf16_f32 v77, v58, v59
    v_cvt_pk_bf16_f32 v78, v60, v61
    v_cvt_pk_bf16_f32 v79, v62, v63
    s_lshl_b32 s58, s49, 2
    s_lshr_b32 s59, s22, 2
    s_lshl_b32 s59, s59, 1
    s_add_u32 s58, s58, s59
    s_lshl_b32 s58, s58, 6
    s_lshl_b32 s59, s46, 2
    s_add_u32 s58, s58, s59
    s_and_b32 s59, s22, 3
    s_add_u32 s58, s58, s59
    s_lshl_b32 s58, s58, 12
    s_add_u32 s58, s58, 2099200
    v_lshlrev_b32 v2, 4, v1
    s_add_u32 s59, s58, 0
    buffer_store_dwordx4 v[64:67], v2, s[24:27], s59 offen sc1
    s_add_u32 s59, s58, 1024
    buffer_store_dwordx4 v[68:71], v2, s[24:27], s59 offen sc1
    s_add_u32 s59, s58, 262144
    buffer_store_dwordx4 v[72:75], v2, s[24:27], s59 offen sc1
    s_add_u32 s59, s58, 263168
    buffer_store_dwordx4 v[76:79], v2, s[24:27], s59 offen sc1
    s_branch F_p1done
F_xep:
    v_cvt_pk_bf16_f32 v64, v32, v33
    v_cvt_pk_bf16_f32 v65, v34, v35
    v_cvt_pk_bf16_f32 v66, v36, v37
    v_cvt_pk_bf16_f32 v67, v38, v39
    v_cvt_pk_bf16_f32 v68, v40, v41
    v_cvt_pk_bf16_f32 v69, v42, v43
    v_cvt_pk_bf16_f32 v70, v44, v45
    v_cvt_pk_bf16_f32 v71, v46, v47
    v_cvt_pk_bf16_f32 v72, v48, v49
    v_cvt_pk_bf16_f32 v73, v50, v51
    v_cvt_pk_bf16_f32 v74, v52, v53
    v_cvt_pk_bf16_f32 v75, v54, v55
    v_cvt_pk_bf16_f32 v76, v56, v57
    v_cvt_pk_bf16_f32 v77, v58, v59
    v_cvt_pk_bf16_f32 v78, v60, v61
    v_cvt_pk_bf16_f32 v79, v62, v63
    s_barrier
    s_lshr_b32 s58, s22, 2
    s_mul_i32 s58, s58, 56
    v_and_b32 v2, 31, v1
    v_lshrrev_b32 v3, 5, v1
    s_and_b32 s59, s22, 3
    s_lshl_b32 s59, s59, 2
    v_add_u32 v3, s59, v3
    v_cmp_gt_u32 vcc, 28, v2
    s_and_saveexec_b64 s[64:65], vcc
    v_add_u32 v4, s58, v2
    v_and_b32 v5, 15, v4
    v_add_u32 v6, 0, v3
    v_xor_b32 v6, v6, v5
    v_lshlrev_b32 v6, 4, v6
    v_lshl_add_u32 v6, v4, 8, v6
    ds_write_b128 v6, v[64:67]
    v_add_u32 v6, 2, v3
    v_xor_b32 v6, v6, v5
    v_lshlrev_b32 v6, 4, v6
    v_lshl_add_u32 v6, v4, 8, v6
    ds_write_b128 v6, v[68:71]
    v_add_u32 v4, s58, v2
    v_add_u32 v4, 28, v4
    v_and_b32 v5, 15, v4
    v_add_u32 v6, 0, v3
    v_xor_b32 v6, v6, v5
    v_lshlrev_b32 v6, 4, v6
    v_lshl_add_u32 v6, v4, 8, v6
    ds_write_b128 v6, v[72:75]
    v_add_u32 v6, 2, v3
    v_xor_b32 v6, v6, v5
    v_lshlrev_b32 v6, 4, v6
    v_lshl_add_u32 v6, v4, 8, v6
    ds_write_b128 v6, v[76:79]
    s_mov_b64 exec, s[64:65]
    s_waitcnt lgkmcnt(0)
    s_barrier
    s_mul_i32 s58, s49, 112
    s_lshl_b32 s58, s58, 12
    s_lshr_b32 s59, s46, 1
    s_lshl_b32 s59, s59, 9
    s_add_u32 s58, s58, s59
    s_and_b32 s59, s46, 1
    s_lshl_b32 s59, s59, 8
    s_add_u32 s58, s58, s59
    s_add_u32 s58, s58, 6291456
    v_lshrrev_b32 v2, 4, v0
    v_and_b32 v3, 15, v0
    v_add_u32 v4, 0, v2
    v_and_b32 v5, 15, v4
    v_xor_b32 v5, v5, v3
    v_lshlrev_b32 v5, 4, v5
    v_lshl_add_u32 v5, v4, 8, v5
    ds_read_b128 v[32:35], v5
    v_lshlrev_b32 v6, 12, v4
    v_lshl_add_u32 v8, v3, 4, v6
    v_add_u32 v4, 32, v2
    v_and_b32 v5, 15, v4
    v_xor_b32 v5, v5, v3
    v_lshlrev_b32 v5, 4, v5
    v_lshl_add_u32 v5, v4, 8, v5
    ds_read_b128 v[36:39], v5
    v_lshlrev_b32 v6, 12, v4
    v_lshl_add_u32 v9, v3, 4, v6
    v_add_u32 v4, 64, v2
    v_and_b32 v5, 15, v4
    v_xor_b32 v5, v5, v3
    v_lshlrev_b32 v5, 4, v5
    v_lshl_add_u32 v5, v4, 8, v5
    ds_read_b128 v[40:43], v5
    v_lshlrev_b32 v6, 12, v4
    v_lshl_add_u32 v10, v3, 4, v6
    s_waitcnt lgkmcnt(0)
    buffer_store_dwordx4 v[32:35], v8, s[24:27], s58 offen sc1
    buffer_store_dwordx4 v[36:39], v9, s[24:27], s58 offen sc1
    buffer_store_dwordx4 v[40:43], v10, s[24:27], s58 offen sc1
    v_add_u32 v4, 96, v2
    v_cmp_gt_u32 vcc, 112, v4
    s_and_saveexec_b64 s[64:65], vcc
    s_cbranch_execz F_xfin
    v_add_u32 v4, 96, v2
    v_and_b32 v5, 15, v4
    v_xor_b32 v5, v5, v3
    v_lshlrev_b32 v5, 4, v5
    v_lshl_add_u32 v5, v4, 8, v5
    ds_read_b128 v[44:47], v5
    v_lshlrev_b32 v6, 12, v4
    v_lshl_add_u32 v11, v3, 4, v6
    s_waitcnt lgkmcnt(0)
    buffer_store_dwordx4 v[44:47], v11, s[24:27], s58 offen sc1
F_xfin:
    s_mov_b64 exec, s[64:65]
F_p1done:
    s_waitcnt vmcnt(0)
    v_mov_b32 v2, 163824
    v_mov_b32 v3, 1
    s_mov_b64 exec, 1
    ds_add_rtn_u32 v4, v2, v3 offset:4
    s_mov_b64 exec, -1
    s_waitcnt lgkmcnt(0)
    v_readfirstlane_b32 s50, v4
    s_nop 3
    s_cmp_lg_u32 s50, 7
    s_cbranch_scc1 F_nosig1
    s_lshl_b32 s50, s48, 2
    s_add_u32 s50, s50, s49
    s_lshl_b32 s50, s50, 7
    s_lshl_b32 s51, s46, 2
    s_add_u32 s50, s50, s51
    s_add_u32 s50, s50, 14680064
    s_mov_b64 s[68:69], exec
    s_mov_b64 exec, 1
    v_mov_b32 v2, 0
    v_mov_b32 v3, s23
    buffer_store_dword v3, v2, s[24:27], s50 offen sc1
    s_mov_b64 exec, s[68:69]
F_nosig1:
    s_cmp_ge_u32 s22, 4
    s_cbranch_scc1 F_kl
    s_and_b32 s41, s2, 7
    s_lshl_b32 s41, s41, 1
    s_bfe_u32 s42, s2, 0x10003
    s_add_u32 s41, s41, s42
    s_lshr_b32 s42, s2, 4
    s_and_b32 s43, s22, 1
    s_lshr_b32 s44, s22, 1
    v_lshlrev_b32 v124, 4, v1
    s_lshr_b32 s50, s41, 2
    s_lshl_b32 s50, s50, 7
    s_lshl_b32 s51, s42, 2
    s_add_u32 s50, s50, s51
    s_add_u32 s50, s50, 14680064
    v_mov_b32 v2, s50
    s_mov_b32 s52, 1
    s_mov_b32 s53, 0
    s_mov_b32 s70, 0
    s_mov_b64 s[68:69], exec
plL5:
    s_mov_b64 exec, s[52:53]
    buffer_load_dword v160, v2, s[24:27], 0 offen sc1
    s_waitcnt vmcnt(0)
    s_mov_b64 s[66:67], 0
    s_mov_b64 exec, s[52:53]
    v_cmp_ne_u32 vcc, s23, v160
    s_nop 1
    s_or_b64 s[66:67], s[66:67], vcc
    s_mov_b64 exec, s[68:69]
    s_cmp_eq_u64 s[66:67], 0
    s_cbranch_scc1 plD5
    s_add_u32 s70, s70, 1
    s_cmp_lt_u32 s70, 400000
    s_sleep 2
    s_cbranch_scc1 plL5
plD5:
    s_lshl_b32 s45, s41, 6
    s_lshl_b32 s46, s42, 2
    s_lshl_b32 s47, s43, 1
    s_add_u32 s46, s46, s47
    s_add_u32 s47, s45, s46
    s_lshl_b32 s47, s47, 11
    s_add_u32 s47, s47, 0
    buffer_load_dwordx4 v[4:7], v124, s[24:27], s47 offen offset:0 sc1
    buffer_load_dwordx4 v[8:11], v124, s[24:27], s47 offen offset:1024 sc1
    buffer_load_dwordx4 v[12:15], v124, s[24:27], s47 offen offset:2048 sc1
    buffer_load_dwordx4 v[16:19], v124, s[24:27], s47 offen offset:3072 sc1
    s_lshl_b32 s50, s44, 14
    v_add_u32 v125, s50, v124
    s_mov_b32 s51, 0
F_restart:
    v_add_u32 v126, 0x8000, v125
    v_mov_b32 v60, 0
    v_mov_b32 v61, 0
    v_mov_b32 v62, 0
    v_mov_b32 v63, 0
    v_mov_b32 v64, 0
    v_mov_b32 v65, 0
    v_mov_b32 v66, 0
    v_mov_b32 v67, 0
    v_mov_b32 v68, 0
    v_mov_b32 v69, 0
    v_mov_b32 v70, 0
    v_mov_b32 v71, 0
    v_mov_b32 v72, 0
    v_mov_b32 v73, 0
    v_mov_b32 v74, 0
    v_mov_b32 v75, 0
    v_mov_b32 v76, 0
    v_mov_b32 v77, 0
    v_mov_b32 v78, 0
    v_mov_b32 v79, 0
    v_mov_b32 v80, 0
    v_mov_b32 v81, 0
    v_mov_b32 v82, 0
    v_mov_b32 v83, 0
    v_mov_b32 v84, 0
    v_mov_b32 v85, 0
    v_mov_b32 v86, 0
    v_mov_b32 v87, 0
    v_mov_b32 v88, 0
    v_mov_b32 v89, 0
    v_mov_b32 v90, 0
    v_mov_b32 v91, 0
    v_mov_b32 v56, 0
    v_mov_b32 v57, 0
    v_mov_b32 v58, 0
    v_mov_b32 v59, 0
    v_mov_b32 v120, 0
    v_mov_b32 v121, 0
    v_mov_b32 v122, 0
    v_mov_b32 v123, 0
    s_waitcnt vmcnt(0)
    s_barrier
    ds_read_b128 v[92:95], v125 offset:0
    ds_read_b128 v[96:99], v125 offset:1024
    ds_read_b128 v[108:111], v125 offset:2048
    ds_read_b128 v[112:115], v125 offset:3072
    s_cmp_lg_u32 s51, 0
    s_cbranch_scc1 F_havem
    s_waitcnt lgkmcnt(2)
    v_mfma_f32_32x32x16_bf16 v[20:35], v[92:95], v[4:7], 0
    v_mfma_f32_32x32x16_bf16 v[36:51], v[92:95], v[12:15], 0
    v_mfma_f32_32x32x16_bf16 v[20:35], v[96:99], v[8:11], v[20:35]
    v_mfma_f32_32x32x16_bf16 v[36:51], v[96:99], v[16:19], v[36:51]
    s_nop 15
    v_max3_f32 v129, v20, v21, v22
    v_max3_f32 v130, v23, v24, v25
    v_max3_f32 v131, v26, v27, v28
    v_max3_f32 v132, v29, v30, v31
    v_max3_f32 v129, v129, v32, v33
    v_max3_f32 v130, v130, v34, v35
    v_max3_f32 v129, v129, v130, v131
    v_max_f32 v129, v129, v132
    v_mov_b32 v130, v129
    s_nop 1
    v_permlane32_swap_b32 v129, v130
    s_nop 0
    v_max_f32 v129, v129, v130
    v_cvt_pk_bf16_f32 v130, -v129, 0
    v_lshlrev_b32 v127, 16, v130
    v_xor_b32 v127, 0x80000000, v127
    s_mov_b32 exec_lo, 0
    v_mov_b32 v10, v130
    s_mov_b32 exec_lo, -1
    v_max3_f32 v129, v36, v37, v38
    v_max3_f32 v130, v39, v40, v41
    v_max3_f32 v131, v42, v43, v44
    v_max3_f32 v132, v45, v46, v47
    v_max3_f32 v129, v129, v48, v49
    v_max3_f32 v130, v130, v50, v51
    v_max3_f32 v129, v129, v130, v131
    v_max_f32 v129, v129, v132
    v_mov_b32 v130, v129
    s_nop 1
    v_permlane32_swap_b32 v129, v130
    s_nop 0
    v_max_f32 v129, v129, v130
    v_cvt_pk_bf16_f32 v130, -v129, 0
    v_lshlrev_b32 v128, 16, v130
    v_xor_b32 v128, 0x80000000, v128
    s_mov_b32 exec_lo, 0
    v_mov_b32 v18, v130
    s_mov_b32 exec_lo, -1
F_havem:
    s_waitcnt lgkmcnt(0)
    s_nop 1
    v_mfma_f32_32x32x16_bf16 v[20:35], v[92:95], v[4:7], 0
    v_mfma_f32_32x32x16_bf16 v[20:35], v[96:99], v[8:11], v[20:35]
    s_nop 11
    s_mov_b32 s55, 0
F_loop:
    v_exp_f32 v20, v20
    v_exp_f32 v21, v21
    v_mfma_f32_32x32x16_bf16 v[76:91], v[120:123], v[56:59], v[76:91]
    ds_read_b128 v[100:103], v125 offset:4096
    v_exp_f32 v22, v22
    v_exp_f32 v23, v23
    v_exp_f32 v24, v24
    v_cvt_pk_bf16_f32 v52, v20, v21
    v_cvt_pk_bf16_f32 v53, v22, v23
    v_mfma_f32_32x32x16_bf16 v[36:51], v[92:95], v[12:15], 0
    ds_read_b128 v[104:107], v125 offset:5120
    v_exp_f32 v25, v25
    v_exp_f32 v26, v26
    v_exp_f32 v27, v27
    v_exp_f32 v28, v28
    v_cvt_pk_bf16_f32 v54, v24, v25
    v_mfma_f32_32x32x16_bf16 v[36:51], v[96:99], v[16:19], v[36:51]
    v_cvt_pk_bf16_f32 v55, v26, v27
    v_exp_f32 v29, v29
    v_exp_f32 v30, v30
    v_exp_f32 v31, v31
    s_waitcnt lgkmcnt(2)
    v_mfma_f32_32x32x16_bf16 v[60:75], v[108:111], v[52:55], v[60:75]
    v_exp_f32 v32, v32
    v_exp_f32 v33, v33
    v_cvt_pk_bf16_f32 v56, v28, v29
    v_exp_f32 v34, v34
    v_exp_f32 v35, v35
    v_cvt_pk_bf16_f32 v57, v30, v31
    v_cvt_pk_bf16_f32 v58, v32, v33
    v_cvt_pk_bf16_f32 v59, v34, v35
    v_exp_f32 v36, v36
    v_exp_f32 v37, v37
    v_mfma_f32_32x32x16_bf16 v[60:75], v[112:115], v[56:59], v[60:75]
    v_exp_f32 v38, v38
    v_exp_f32 v39, v39
    v_exp_f32 v40, v40
    v_cvt_pk_bf16_f32 v52, v36, v37
    v_cvt_pk_bf16_f32 v53, v38, v39
    s_waitcnt lgkmcnt(0)
    v_mfma_f32_32x32x16_bf16 v[20:35], v[100:103], v[4:7], 0
    ds_read_b128 v[116:119], v125 offset:6144
    v_exp_f32 v41, v41
    v_exp_f32 v42, v42
    v_exp_f32 v43, v43
    v_exp_f32 v44, v44
    v_cvt_pk_bf16_f32 v54, v40, v41
    v_mfma_f32_32x32x16_bf16 v[20:35], v[104:107], v[8:11], v[20:35]
    ds_read_b128 v[120:123], v125 offset:7168
    v_cvt_pk_bf16_f32 v55, v42, v43
    v_exp_f32 v45, v45
    v_exp_f32 v46, v46
    v_exp_f32 v47, v47
    v_mfma_f32_32x32x16_bf16 v[76:91], v[108:111], v[52:55], v[76:91]
    v_exp_f32 v48, v48
    v_exp_f32 v49, v49
    v_cvt_pk_bf16_f32 v56, v44, v45
    v_exp_f32 v50, v50
    v_exp_f32 v51, v51
    v_cvt_pk_bf16_f32 v57, v46, v47
    v_cvt_pk_bf16_f32 v58, v48, v49
    v_cvt_pk_bf16_f32 v59, v50, v51
    v_exp_f32 v20, v20
    v_exp_f32 v21, v21
    v_mfma_f32_32x32x16_bf16 v[76:91], v[112:115], v[56:59], v[76:91]
    ds_read_b128 v[92:95], v125 offset:8192
    v_exp_f32 v22, v22
    v_exp_f32 v23, v23
    v_exp_f32 v24, v24
    v_cvt_pk_bf16_f32 v52, v20, v21
    v_cvt_pk_bf16_f32 v53, v22, v23
    v_mfma_f32_32x32x16_bf16 v[36:51], v[100:103], v[12:15], 0
    ds_read_b128 v[96:99], v125 offset:9216
    v_exp_f32 v25, v25
    v_exp_f32 v26, v26
    v_exp_f32 v27, v27
    v_exp_f32 v28, v28
    v_cvt_pk_bf16_f32 v54, v24, v25
    v_mfma_f32_32x32x16_bf16 v[36:51], v[104:107], v[16:19], v[36:51]
    v_cvt_pk_bf16_f32 v55, v26, v27
    v_exp_f32 v29, v29
    v_exp_f32 v30, v30
    v_exp_f32 v31, v31
    s_waitcnt lgkmcnt(2)
    v_mfma_f32_32x32x16_bf16 v[60:75], v[116:119], v[52:55], v[60:75]
    v_exp_f32 v32, v32
    v_exp_f32 v33, v33
    v_cvt_pk_bf16_f32 v56, v28, v29
    v_exp_f32 v34, v34
    v_exp_f32 v35, v35
    v_cvt_pk_bf16_f32 v57, v30, v31
    v_cvt_pk_bf16_f32 v58, v32, v33
    v_cvt_pk_bf16_f32 v59, v34, v35
    v_exp_f32 v36, v36
    v_exp_f32 v37, v37
    v_mfma_f32_32x32x16_bf16 v[60:75], v[120:123], v[56:59], v[60:75]
    v_exp_f32 v38, v38
    v_exp_f32 v39, v39
    v_exp_f32 v40, v40
    v_cvt_pk_bf16_f32 v52, v36, v37
    v_cvt_pk_bf16_f32 v53, v38, v39
    s_waitcnt lgkmcnt(0)
    v_mfma_f32_32x32x16_bf16 v[20:35], v[92:95], v[4:7], 0
    ds_read_b128 v[108:111], v125 offset:10240
    v_exp_f32 v41, v41
    v_exp_f32 v42, v42
    v_exp_f32 v43, v43
    v_exp_f32 v44, v44
    v_cvt_pk_bf16_f32 v54, v40, v41
    v_mfma_f32_32x32x16_bf16 v[20:35], v[96:99], v[8:11], v[20:35]
    ds_read_b128 v[112:115], v125 offset:11264
    v_cvt_pk_bf16_f32 v55, v42, v43
    v_exp_f32 v45, v45
    v_exp_f32 v46, v46
    v_exp_f32 v47, v47
    v_mfma_f32_32x32x16_bf16 v[76:91], v[116:119], v[52:55], v[76:91]
    v_exp_f32 v48, v48
    v_exp_f32 v49, v49
    v_cvt_pk_bf16_f32 v56, v44, v45
    v_exp_f32 v50, v50
    v_exp_f32 v51, v51
    v_cvt_pk_bf16_f32 v57, v46, v47
    v_cvt_pk_bf16_f32 v58, v48, v49
    v_cvt_pk_bf16_f32 v59, v50, v51
    v_exp_f32 v20, v20
    v_exp_f32 v21, v21
    v_mfma_f32_32x32x16_bf16 v[76:91], v[120:123], v[56:59], v[76:91]
    ds_read_b128 v[100:103], v125 offset:12288
    v_exp_f32 v22, v22
    v_exp_f32 v23, v23
    v_exp_f32 v24, v24
    v_cvt_pk_bf16_f32 v52, v20, v21
    v_cvt_pk_bf16_f32 v53, v22, v23
    v_mfma_f32_32x32x16_bf16 v[36:51], v[92:95], v[12:15], 0
    ds_read_b128 v[104:107], v125 offset:13312
    v_exp_f32 v25, v25
    v_exp_f32 v26, v26
    v_exp_f32 v27, v27
    v_exp_f32 v28, v28
    v_cvt_pk_bf16_f32 v54, v24, v25
    v_mfma_f32_32x32x16_bf16 v[36:51], v[96:99], v[16:19], v[36:51]
    v_cvt_pk_bf16_f32 v55, v26, v27
    v_exp_f32 v29, v29
    v_exp_f32 v30, v30
    v_exp_f32 v31, v31
    s_waitcnt lgkmcnt(2)
    v_mfma_f32_32x32x16_bf16 v[60:75], v[108:111], v[52:55], v[60:75]
    v_exp_f32 v32, v32
    v_exp_f32 v33, v33
    v_cvt_pk_bf16_f32 v56, v28, v29
    v_exp_f32 v34, v34
    v_exp_f32 v35, v35
    v_cvt_pk_bf16_f32 v57, v30, v31
    v_cvt_pk_bf16_f32 v58, v32, v33
    v_cvt_pk_bf16_f32 v59, v34, v35
    v_exp_f32 v36, v36
    v_exp_f32 v37, v37
    v_mfma_f32_32x32x16_bf16 v[60:75], v[112:115], v[56:59], v[60:75]
    v_exp_f32 v38, v38
    v_exp_f32 v39, v39
    v_exp_f32 v40, v40
    v_cvt_pk_bf16_f32 v52, v36, v37
    v_cvt_pk_bf16_f32 v53, v38, v39
    s_waitcnt lgkmcnt(0)
    v_mfma_f32_32x32x16_bf16 v[20:35], v[100:103], v[4:7], 0
    ds_read_b128 v[116:119], v125 offset:14336
    v_exp_f32 v41, v41
    v_exp_f32 v42, v42
    v_exp_f32 v43, v43
    v_exp_f32 v44, v44
    v_cvt_pk_bf16_f32 v54, v40, v41
    v_mfma_f32_32x32x16_bf16 v[20:35], v[104:107], v[8:11], v[20:35]
    ds_read_b128 v[120:123], v125 offset:15360
    v_cvt_pk_bf16_f32 v55, v42, v43
    v_exp_f32 v45, v45
    v_exp_f32 v46, v46
    v_exp_f32 v47, v47
    v_mfma_f32_32x32x16_bf16 v[76:91], v[108:111], v[52:55], v[76:91]
    v_exp_f32 v48, v48
    v_exp_f32 v49, v49
    v_cvt_pk_bf16_f32 v56, v44, v45
    v_exp_f32 v50, v50
    v_exp_f32 v51, v51
    v_cvt_pk_bf16_f32 v57, v46, v47
    v_cvt_pk_bf16_f32 v58, v48, v49
    v_cvt_pk_bf16_f32 v59, v50, v51
    s_barrier
    v_exp_f32 v20, v20
    v_exp_f32 v21, v21
    v_mfma_f32_32x32x16_bf16 v[76:91], v[112:115], v[56:59], v[76:91]
    ds_read_b128 v[92:95], v126 offset:0
    v_exp_f32 v22, v22
    v_exp_f32 v23, v23
    v_exp_f32 v24, v24
    v_cvt_pk_bf16_f32 v52, v20, v21
    v_cvt_pk_bf16_f32 v53, v22, v23
    v_mfma_f32_32x32x16_bf16 v[36:51], v[100:103], v[12:15], 0
    ds_read_b128 v[96:99], v126 offset:1024
    v_exp_f32 v25, v25
    v_exp_f32 v26, v26
    v_exp_f32 v27, v27
    v_exp_f32 v28, v28
    v_cvt_pk_bf16_f32 v54, v24, v25
    v_mfma_f32_32x32x16_bf16 v[36:51], v[104:107], v[16:19], v[36:51]
    v_cvt_pk_bf16_f32 v55, v26, v27
    v_exp_f32 v29, v29
    v_exp_f32 v30, v30
    v_exp_f32 v31, v31
    s_waitcnt lgkmcnt(2)
    v_mfma_f32_32x32x16_bf16 v[60:75], v[116:119], v[52:55], v[60:75]
    v_exp_f32 v32, v32
    v_exp_f32 v33, v33
    v_cvt_pk_bf16_f32 v56, v28, v29
    v_exp_f32 v34, v34
    v_exp_f32 v35, v35
    v_cvt_pk_bf16_f32 v57, v30, v31
    v_cvt_pk_bf16_f32 v58, v32, v33
    v_cvt_pk_bf16_f32 v59, v34, v35
    v_exp_f32 v36, v36
    v_exp_f32 v37, v37
    v_mfma_f32_32x32x16_bf16 v[60:75], v[120:123], v[56:59], v[60:75]
    v_exp_f32 v38, v38
    v_exp_f32 v39, v39
    v_exp_f32 v40, v40
    v_cvt_pk_bf16_f32 v52, v36, v37
    v_cvt_pk_bf16_f32 v53, v38, v39
    s_waitcnt lgkmcnt(0)
    v_mfma_f32_32x32x16_bf16 v[20:35], v[92:95], v[4:7], 0
    ds_read_b128 v[108:111], v126 offset:2048
    v_exp_f32 v41, v41
    v_exp_f32 v42, v42
    v_exp_f32 v43, v43
    v_exp_f32 v44, v44
    v_cvt_pk_bf16_f32 v54, v40, v41
    v_mfma_f32_32x32x16_bf16 v[20:35], v[96:99], v[8:11], v[20:35]
    ds_read_b128 v[112:115], v126 offset:3072
    v_cvt_pk_bf16_f32 v55, v42, v43
    v_exp_f32 v45, v45
    v_exp_f32 v46, v46
    v_exp_f32 v47, v47
    v_mfma_f32_32x32x16_bf16 v[76:91], v[116:119], v[52:55], v[76:91]
    v_exp_f32 v48, v48
    v_exp_f32 v49, v49
    v_cvt_pk_bf16_f32 v56, v44, v45
    v_exp_f32 v50, v50
    v_exp_f32 v51, v51
    v_cvt_pk_bf16_f32 v57, v46, v47
    v_cvt_pk_bf16_f32 v58, v48, v49
    v_cvt_pk_bf16_f32 v59, v50, v51
    v_mov_b32 v125, v126
    v_add_u32 v126, 0x8000, v126
    v_and_b32 v126, 0x1ffff, v126
    v_exp_f32 v20, v20
    v_exp_f32 v21, v21
    v_mfma_f32_32x32x16_bf16 v[76:91], v[120:123], v[56:59], v[76:91]
    ds_read_b128 v[100:103], v125 offset:4096
    v_exp_f32 v22, v22
    v_exp_f32 v23, v23
    v_exp_f32 v24, v24
    v_cvt_pk_bf16_f32 v52, v20, v21
    v_cvt_pk_bf16_f32 v53, v22, v23
    v_mfma_f32_32x32x16_bf16 v[36:51], v[92:95], v[12:15], 0
    ds_read_b128 v[104:107], v125 offset:5120
    v_exp_f32 v25, v25
    v_exp_f32 v26, v26
    v_exp_f32 v27, v27
    v_exp_f32 v28, v28
    v_cvt_pk_bf16_f32 v54, v24, v25
    v_mfma_f32_32x32x16_bf16 v[36:51], v[96:99], v[16:19], v[36:51]
    v_cvt_pk_bf16_f32 v55, v26, v27
    v_exp_f32 v29, v29
    v_exp_f32 v30, v30
    v_exp_f32 v31, v31
    s_waitcnt lgkmcnt(2)
    v_mfma_f32_32x32x16_bf16 v[60:75], v[108:111], v[52:55], v[60:75]
    v_exp_f32 v32, v32
    v_exp_f32 v33, v33
    v_cvt_pk_bf16_f32 v56, v28, v29
    v_exp_f32 v34, v34
    v_exp_f32 v35, v35
    v_cvt_pk_bf16_f32 v57, v30, v31
    v_cvt_pk_bf16_f32 v58, v32, v33
    v_cvt_pk_bf16_f32 v59, v34, v35
    v_exp_f32 v36, v36
    v_exp_f32 v37, v37
    v_mfma_f32_32x32x16_bf16 v[60:75], v[112:115], v[56:59], v[60:75]
    v_exp_f32 v38, v38
    v_exp_f32 v39, v39
    v_exp_f32 v40, v40
    v_cvt_pk_bf16_f32 v52, v36, v37
    v_cvt_pk_bf16_f32 v53, v38, v39
    s_waitcnt lgkmcnt(0)
    v_mfma_f32_32x32x16_bf16 v[20:35], v[100:103], v[4:7], 0
    ds_read_b128 v[116:119], v125 offset:6144
    v_exp_f32 v41, v41
    v_exp_f32 v42, v42
    v_exp_f32 v43, v43
    v_exp_f32 v44, v44
    v_cvt_pk_bf16_f32 v54, v40, v41
    v_mfma_f32_32x32x16_bf16 v[20:35], v[104:107], v[8:11], v[20:35]
    ds_read_b128 v[120:123], v125 offset:7168
    v_cvt_pk_bf16_f32 v55, v42, v43
    v_exp_f32 v45, v45
    v_exp_f32 v46, v46
    v_exp_f32 v47, v47
    v_mfma_f32_32x32x16_bf16 v[76:91], v[108:111], v[52:55], v[76:91]
    v_exp_f32 v48, v48
    v_exp_f32 v49, v49
    v_cvt_pk_bf16_f32 v56, v44, v45
    v_exp_f32 v50, v50
    v_exp_f32 v51, v51
    v_cvt_pk_bf16_f32 v57, v46, v47
    v_cvt_pk_bf16_f32 v58, v48, v49
    v_cvt_pk_bf16_f32 v59, v50, v51
    v_exp_f32 v20, v20
    v_exp_f32 v21, v21
    v_mfma_f32_32x32x16_bf16 v[76:91], v[112:115], v[56:59], v[76:91]
    ds_read_b128 v[92:95], v125 offset:8192
    v_exp_f32 v22, v22
    v_exp_f32 v23, v23
    v_exp_f32 v24, v24
    v_cvt_pk_bf16_f32 v52, v20, v21
    v_cvt_pk_bf16_f32 v53, v22, v23
    v_mfma_f32_32x32x16_bf16 v[36:51], v[100:103], v[12:15], 0
    ds_read_b128 v[96:99], v125 offset:9216
    v_exp_f32 v25, v25
    v_exp_f32 v26, v26
    v_exp_f32 v27, v27
    v_exp_f32 v28, v28
    v_cvt_pk_bf16_f32 v54, v24, v25
    v_mfma_f32_32x32x16_bf16 v[36:51], v[104:107], v[16:19], v[36:51]
    v_cvt_pk_bf16_f32 v55, v26, v27
    v_exp_f32 v29, v29
    v_exp_f32 v30, v30
    v_exp_f32 v31, v31
    s_waitcnt lgkmcnt(2)
    v_mfma_f32_32x32x16_bf16 v[60:75], v[116:119], v[52:55], v[60:75]
    v_exp_f32 v32, v32
    v_exp_f32 v33, v33
    v_cvt_pk_bf16_f32 v56, v28, v29
    v_exp_f32 v34, v34
    v_exp_f32 v35, v35
    v_cvt_pk_bf16_f32 v57, v30, v31
    v_cvt_pk_bf16_f32 v58, v32, v33
    v_cvt_pk_bf16_f32 v59, v34, v35
    v_exp_f32 v36, v36
    v_exp_f32 v37, v37
    v_mfma_f32_32x32x16_bf16 v[60:75], v[120:123], v[56:59], v[60:75]
    v_exp_f32 v38, v38
    v_exp_f32 v39, v39
    v_exp_f32 v40, v40
    v_cvt_pk_bf16_f32 v52, v36, v37
    v_cvt_pk_bf16_f32 v53, v38, v39
    s_waitcnt lgkmcnt(0)
    v_mfma_f32_32x32x16_bf16 v[20:35], v[92:95], v[4:7], 0
    ds_read_b128 v[108:111], v125 offset:10240
    v_exp_f32 v41, v41
    v_exp_f32 v42, v42
    v_exp_f32 v43, v43
    v_exp_f32 v44, v44
    v_cvt_pk_bf16_f32 v54, v40, v41
    v_mfma_f32_32x32x16_bf16 v[20:35], v[96:99], v[8:11], v[20:35]
    ds_read_b128 v[112:115], v125 offset:11264
    v_cvt_pk_bf16_f32 v55, v42, v43
    v_exp_f32 v45, v45
    v_exp_f32 v46, v46
    v_exp_f32 v47, v47
    v_mfma_f32_32x32x16_bf16 v[76:91], v[116:119], v[52:55], v[76:91]
    v_exp_f32 v48, v48
    v_exp_f32 v49, v49
    v_cvt_pk_bf16_f32 v56, v44, v45
    v_exp_f32 v50, v50
    v_exp_f32 v51, v51
    v_cvt_pk_bf16_f32 v57, v46, v47
    v_cvt_pk_bf16_f32 v58, v48, v49
    v_cvt_pk_bf16_f32 v59, v50, v51
    v_exp_f32 v20, v20
    v_exp_f32 v21, v21
    v_mfma_f32_32x32x16_bf16 v[76:91], v[120:123], v[56:59], v[76:91]
    ds_read_b128 v[100:103], v125 offset:12288
    v_exp_f32 v22, v22
    v_exp_f32 v23, v23
    v_exp_f32 v24, v24
    v_cvt_pk_bf16_f32 v52, v20, v21
    v_cvt_pk_bf16_f32 v53, v22, v23
    v_mfma_f32_32x32x16_bf16 v[36:51], v[92:95], v[12:15], 0
    ds_read_b128 v[104:107], v125 offset:13312
    v_exp_f32 v25, v25
    v_exp_f32 v26, v26
    v_exp_f32 v27, v27
    v_exp_f32 v28, v28
    v_cvt_pk_bf16_f32 v54, v24, v25
    v_mfma_f32_32x32x16_bf16 v[36:51], v[96:99], v[16:19], v[36:51]
    v_cvt_pk_bf16_f32 v55, v26, v27
    v_exp_f32 v29, v29
    v_exp_f32 v30, v30
    v_exp_f32 v31, v31
    s_waitcnt lgkmcnt(2)
    v_mfma_f32_32x32x16_bf16 v[60:75], v[108:111], v[52:55], v[60:75]
    v_exp_f32 v32, v32
    v_exp_f32 v33, v33
    v_cvt_pk_bf16_f32 v56, v28, v29
    v_exp_f32 v34, v34
    v_exp_f32 v35, v35
    v_cvt_pk_bf16_f32 v57, v30, v31
    v_cvt_pk_bf16_f32 v58, v32, v33
    v_cvt_pk_bf16_f32 v59, v34, v35
    v_exp_f32 v36, v36
    v_exp_f32 v37, v37
    v_mfma_f32_32x32x16_bf16 v[60:75], v[112:115], v[56:59], v[60:75]
    v_exp_f32 v38, v38
    v_exp_f32 v39, v39
    v_exp_f32 v40, v40
    v_cvt_pk_bf16_f32 v52, v36, v37
    v_cvt_pk_bf16_f32 v53, v38, v39
    s_waitcnt lgkmcnt(0)
    v_mfma_f32_32x32x16_bf16 v[20:35], v[100:103], v[4:7], 0
    ds_read_b128 v[116:119], v125 offset:14336
    v_exp_f32 v41, v41
    v_exp_f32 v42, v42
    v_exp_f32 v43, v43
    v_exp_f32 v44, v44
    v_cvt_pk_bf16_f32 v54, v40, v41
    v_mfma_f32_32x32x16_bf16 v[20:35], v[104:107], v[8:11], v[20:35]
    ds_read_b128 v[120:123], v125 offset:15360
    v_cvt_pk_bf16_f32 v55, v42, v43
    v_exp_f32 v45, v45
    v_exp_f32 v46, v46
    v_exp_f32 v47, v47
    v_mfma_f32_32x32x16_bf16 v[76:91], v[108:111], v[52:55], v[76:91]
    v_exp_f32 v48, v48
    v_exp_f32 v49, v49
    v_cvt_pk_bf16_f32 v56, v44, v45
    v_exp_f32 v50, v50
    v_exp_f32 v51, v51
    v_cvt_pk_bf16_f32 v57, v46, v47
    v_cvt_pk_bf16_f32 v58, v48, v49
    v_cvt_pk_bf16_f32 v59, v50, v51
    s_barrier
    v_exp_f32 v20, v20
    v_exp_f32 v21, v21
    v_mfma_f32_32x32x16_bf16 v[76:91], v[112:115], v[56:59], v[76:91]
    ds_read_b128 v[92:95], v126 offset:0
    v_exp_f32 v22, v22
    v_exp_f32 v23, v23
    v_exp_f32 v24, v24
    v_cvt_pk_bf16_f32 v52, v20, v21
    v_cvt_pk_bf16_f32 v53, v22, v23
    v_mfma_f32_32x32x16_bf16 v[36:51], v[100:103], v[12:15], 0
    ds_read_b128 v[96:99], v126 offset:1024
    v_exp_f32 v25, v25
    v_exp_f32 v26, v26
    v_exp_f32 v27, v27
    v_exp_f32 v28, v28
    v_cvt_pk_bf16_f32 v54, v24, v25
    v_mfma_f32_32x32x16_bf16 v[36:51], v[104:107], v[16:19], v[36:51]
    v_cvt_pk_bf16_f32 v55, v26, v27
    v_exp_f32 v29, v29
    v_exp_f32 v30, v30
    v_exp_f32 v31, v31
    s_waitcnt lgkmcnt(2)
    v_mfma_f32_32x32x16_bf16 v[60:75], v[116:119], v[52:55], v[60:75]
    v_exp_f32 v32, v32
    v_exp_f32 v33, v33
    v_cvt_pk_bf16_f32 v56, v28, v29
    v_exp_f32 v34, v34
    v_exp_f32 v35, v35
    v_cvt_pk_bf16_f32 v57, v30, v31
    v_cvt_pk_bf16_f32 v58, v32, v33
    v_cvt_pk_bf16_f32 v59, v34, v35
    v_exp_f32 v36, v36
    v_exp_f32 v37, v37
    v_mfma_f32_32x32x16_bf16 v[60:75], v[120:123], v[56:59], v[60:75]
    v_exp_f32 v38, v38
    v_exp_f32 v39, v39
    v_exp_f32 v40, v40
    v_cvt_pk_bf16_f32 v52, v36, v37
    v_cvt_pk_bf16_f32 v53, v38, v39
    s_waitcnt lgkmcnt(0)
    v_mfma_f32_32x32x16_bf16 v[20:35], v[92:95], v[4:7], 0
    ds_read_b128 v[108:111], v126 offset:2048
    v_exp_f32 v41, v41
    v_exp_f32 v42, v42
    v_exp_f32 v43, v43
    v_exp_f32 v44, v44
    v_cvt_pk_bf16_f32 v54, v40, v41
    v_mfma_f32_32x32x16_bf16 v[20:35], v[96:99], v[8:11], v[20:35]
    ds_read_b128 v[112:115], v126 offset:3072
    v_cvt_pk_bf16_f32 v55, v42, v43
    v_exp_f32 v45, v45
    v_exp_f32 v46, v46
    v_exp_f32 v47, v47
    v_mfma_f32_32x32x16_bf16 v[76:91], v[116:119], v[52:55], v[76:91]
    v_exp_f32 v48, v48
    v_exp_f32 v49, v49
    v_cvt_pk_bf16_f32 v56, v44, v45
    v_exp_f32 v50, v50
    v_exp_f32 v51, v51
    v_cvt_pk_bf16_f32 v57, v46, v47
    v_cvt_pk_bf16_f32 v58, v48, v49
    v_cvt_pk_bf16_f32 v59, v50, v51
    v_mov_b32 v125, v126
    v_add_u32 v126, 0x8000, v126
    v_and_b32 v126, 0x1ffff, v126
    s_add_u32 s55, s55, 1
    s_cmp_lt_u32 s55, 4
    s_cbranch_scc1 F_loop
    v_mfma_f32_32x32x16_bf16 v[76:91], v[120:123], v[56:59], v[76:91]
    s_nop 15
    s_waitcnt lgkmcnt(0)
    v_mov_b32 v131, v72
    v_mov_b32 v129, v72
    s_nop 1
    v_permlane32_swap_b32 v131, v129
    v_mov_b32 v131, v88
    v_mov_b32 v130, v88
    s_nop 1
    v_permlane32_swap_b32 v131, v130
    s_cmp_lg_u32 s51, 0
    s_cbranch_scc1 F_nochk
    s_mov_b32 s56, 0x5f800000
    v_max_f32 v131, v129, v130
    v_cmp_u_f32 s[58:59], v129, v130
    v_cmp_ngt_f32 vcc, s56, v131
    s_nop 1
    s_or_b64 vcc, vcc, s[58:59]
    s_cbranch_vccz F_nochk
    v_mov_b32 v131, 140288
    v_mov_b32 v132, 1
    ds_write_b32 v131, v132
F_nochk:
    s_mul_i32 s57, s22, 4608
    s_add_u32 s57, s57, 140352
    s_xor_b32 s58, s22, 2
    s_mul_i32 s58, s58, 4608
    s_add_u32 s58, s58, 140352
    v_add_u32 v131, s57, v124
    v_lshlrev_b32 v132, 3, v1
    v_add_u32 v132, s57, v132
    s_cmp_eq_u32 s44, 0
    s_cbranch_scc1 F_send1
    ds_write_b128 v131, v[60:63] offset:0
    ds_write_b128 v131, v[64:67] offset:1024
    ds_write_b128 v131, v[68:71] offset:2048
    ds_write_b128 v131, v[72:75] offset:3072
    v_mov_b32 v134, v127
    v_mov_b32 v135, v129
    v_mov_b32 v20, v76
    v_mov_b32 v21, v77
    v_mov_b32 v22, v78
    v_mov_b32 v23, v79
    v_mov_b32 v24, v80
    v_mov_b32 v25, v81
    v_mov_b32 v26, v82
    v_mov_b32 v27, v83
    v_mov_b32 v28, v84
    v_mov_b32 v29, v85
    v_mov_b32 v30, v86
    v_mov_b32 v31, v87
    v_mov_b32 v32, v88
    v_mov_b32 v33, v89
    v_mov_b32 v34, v90
    v_mov_b32 v35, v91
    v_mov_b32 v127, v128
    v_mov_b32 v129, v130
    s_branch F_sent
F_send1:
    ds_write_b128 v131, v[76:79] offset:0
    ds_write_b128 v131, v[80:83] offset:1024
    ds_write_b128 v131, v[84:87] offset:2048
    ds_write_b128 v131, v[88:91] offset:3072
    v_mov_b32 v134, v128
    v_mov_b32 v135, v130
    v_mov_b32 v20, v60
    v_mov_b32 v21, v61
    v_mov_b32 v22, v62
    v_mov_b32 v23, v63
    v_mov_b32 v24, v64
    v_mov_b32 v25, v65
    v_mov_b32 v26, v66
    v_mov_b32 v27, v67
    v_mov_b32 v28, v68
    v_mov_b32 v29, v69
    v_mov_b32 v30, v70
    v_mov_b32 v31, v71
    v_mov_b32 v32, v72
    v_mov_b32 v33, v73
    v_mov_b32 v34, v74
    v_mov_b32 v35, v75
F_sent:
    ds_write_b64 v132, v[134:135] offset:4096
    s_waitcnt lgkmcnt(0)
    s_barrier
    v_add_u32 v131, s58, v124
    v_lshlrev_b32 v132, 3, v1
    v_add_u32 v132, s58, v132
    v_mov_b32 v133, 140288
    ds_read_b32 v133, v133
    ds_read_b128 v[36:39], v131 offset:0
    ds_read_b128 v[40:43], v131 offset:1024
    ds_read_b128 v[44:47], v131 offset:2048
    ds_read_b128 v[48:51], v131 offset:3072
    ds_read_b64 v[52:53], v132 offset:4096
    s_waitcnt lgkmcnt(0)
    v_readfirstlane_b32 s56, v133
    s_nop 3
    s_cmp_eq_u32 s56, 1
    s_cbranch_scc1 F_slow
    v_max_f32 v130, v127, v52
    v_sub_f32 v131, v127, v130
    v_sub_f32 v132, v52, v130
    v_exp_f32 v131, v131
    v_exp_f32 v132, v132
    s_nop 0
    v_mul_f32 v130, v131, v129
    v_fmac_f32 v130, v132, v53
    v_rcp_f32 v130, v130
    s_nop 0
    v_mul_f32 v131, v131, v130
    v_mul_f32 v132, v132, v130
    v_mul_f32 v20, v131, v20
    v_mul_f32 v21, v131, v21
    v_mul_f32 v22, v131, v22
    v_mul_f32 v23, v131, v23
    v_mul_f32 v24, v131, v24
    v_mul_f32 v25, v131, v25
    v_mul_f32 v26, v131, v26
    v_mul_f32 v27, v131, v27
    v_mul_f32 v28, v131, v28
    v_mul_f32 v29, v131, v29
    v_mul_f32 v30, v131, v30
    v_mul_f32 v31, v131, v31
    v_mul_f32 v32, v131, v32
    v_mul_f32 v33, v131, v33
    v_mul_f32 v34, v131, v34
    v_mul_f32 v35, v131, v35
    v_fmac_f32 v20, v132, v36
    v_fmac_f32 v21, v132, v37
    v_fmac_f32 v22, v132, v38
    v_fmac_f32 v23, v132, v39
    v_fmac_f32 v24, v132, v40
    v_fmac_f32 v25, v132, v41
    v_fmac_f32 v26, v132, v42
    v_fmac_f32 v27, v132, v43
    v_fmac_f32 v28, v132, v44
    v_fmac_f32 v29, v132, v45
    v_fmac_f32 v30, v132, v46
    v_fmac_f32 v31, v132, v47
    v_fmac_f32 v32, v132, v48
    v_fmac_f32 v33, v132, v49
    v_fmac_f32 v34, v132, v50
    v_fmac_f32 v35, v132, v51
    s_mov_b32 exec_lo, 0
    v_mov_b32 v32, 0
    v_mov_b32 v33, 0
    v_mov_b32 v34, 0
    v_mov_b32 v35, 0
    s_mov_b32 exec_lo, -1
    v_cvt_pk_bf16_f32 v60, v20, v21
    v_cvt_pk_bf16_f32 v61, v22, v23
    v_cvt_pk_bf16_f32 v62, v24, v25
    v_cvt_pk_bf16_f32 v63, v26, v27
    v_cvt_pk_bf16_f32 v64, v28, v29
    v_cvt_pk_bf16_f32 v65, v30, v31
    v_cvt_pk_bf16_f32 v66, v32, v33
    v_cvt_pk_bf16_f32 v67, v34, v35
    s_add_u32 s56, s46, s44
    s_lshl_b32 s56, s56, 4
    s_add_u32 s56, s56, s41
    s_lshl_b32 s56, s56, 11
    s_add_u32 s56, s56, 10485760
    buffer_store_dwordx4 v[60:63], v124, s[24:27], s56 offen sc1
    buffer_store_dwordx4 v[64:67], v124, s[24:27], s56 offen offset:1024 sc1
    v_mov_b32 v2, 163824
    v_mov_b32 v3, 1
    s_waitcnt vmcnt(0)
    s_mov_b64 exec, 1
    ds_add_rtn_u32 v4, v2, v3
    s_mov_b64 exec, -1
    s_waitcnt lgkmcnt(0)
    v_readfirstlane_b32 s56, v4
    s_nop 3
    s_cmp_lg_u32 s56, 3
    s_cbranch_scc1 F_p2done
    s_lshl_b32 s50, s42, 7
    s_lshl_b32 s56, s41, 2
    s_add_u32 s50, s50, s56
    s_add_u32 s50, s50, 14688256
    s_mov_b64 s[68:69], exec
    s_mov_b64 exec, 1
    v_mov_b32 v2, 0
    v_mov_b32 v3, s23
    buffer_store_dword v3, v2, s[24:27], s50 offen sc1
    s_mov_b64 exec, s[68:69]
    s_branch F_p2done
F_slow:
    s_mov_b32 s51, 1
    s_mov_b32 exec_lo, 0
    v_mov_b32 v10, 0
    v_mov_b32 v18, 0
    s_mov_b32 exec_lo, -1
    v_mov_b32 v133, 0xff7fffff
    v_mov_b32 v134, 0xff7fffff
    s_lshl_b32 s56, s44, 5
    s_add_u32 s56, s56, s45
    s_lshl_b32 s56, s56, 12
    s_add_u32 s56, s56, 2097152
    s_mov_b32 s57, 0
F_sloop:
    buffer_load_dwordx4 v[92:95], v124, s[24:27], s56 offen sc1
    buffer_load_dwordx4 v[96:99], v124, s[24:27], s56 offen offset:1024 sc1
    s_waitcnt vmcnt(0)
    v_mfma_f32_32x32x16_bf16 v[20:35], v[92:95], v[4:7], 0
    v_mfma_f32_32x32x16_bf16 v[36:51], v[92:95], v[12:15], 0
    v_mfma_f32_32x32x16_bf16 v[20:35], v[96:99], v[8:11], v[20:35]
    v_mfma_f32_32x32x16_bf16 v[36:51], v[96:99], v[16:19], v[36:51]
    s_nop 15
    v_max3_f32 v133, v133, v20, v21
    v_max3_f32 v134, v134, v36, v37
    v_max3_f32 v133, v133, v22, v23
    v_max3_f32 v134, v134, v38, v39
    v_max3_f32 v133, v133, v24, v25
    v_max3_f32 v134, v134, v40, v41
    v_max3_f32 v133, v133, v26, v27
    v_max3_f32 v134, v134, v42, v43
    v_max3_f32 v133, v133, v28, v29
    v_max3_f32 v134, v134, v44, v45
    v_max3_f32 v133, v133, v30, v31
    v_max3_f32 v134, v134, v46, v47
    v_max3_f32 v133, v133, v32, v33
    v_max3_f32 v134, v134, v48, v49
    v_max3_f32 v133, v133, v34, v35
    v_max3_f32 v134, v134, v50, v51
    s_add_u32 s56, s56, 4096
    s_add_u32 s57, s57, 1
    s_cmp_lt_u32 s57, 32
    s_cbranch_scc1 F_sloop
    v_mov_b32 v129, v133
    v_mov_b32 v130, v129
    s_nop 1
    v_permlane32_swap_b32 v129, v130
    s_nop 0
    v_max_f32 v129, v129, v130
    v_cvt_pk_bf16_f32 v130, -v129, 0
    v_lshlrev_b32 v127, 16, v130
    v_xor_b32 v127, 0x80000000, v127
    s_mov_b32 exec_lo, 0
    v_mov_b32 v10, v130
    s_mov_b32 exec_lo, -1
    v_mov_b32 v129, v134
    v_mov_b32 v130, v129
    s_nop 1
    v_permlane32_swap_b32 v129, v130
    s_nop 0
    v_max_f32 v129, v129, v130
    v_cvt_pk_bf16_f32 v130, -v129, 0
    v_lshlrev_b32 v128, 16, v130
    v_xor_b32 v128, 0x80000000, v128
    s_mov_b32 exec_lo, 0
    v_mov_b32 v18, v130
    s_mov_b32 exec_lo, -1
    s_lshl_b32 s50, s44, 14
    v_add_u32 v125, s50, v124
    s_barrier
    v_mov_b32 v131, 140288
    v_mov_b32 v132, 2
    ds_write_b32 v131, v132
    s_waitcnt lgkmcnt(0)
    s_branch F_restart
F_p2done:
    s_branch F_p2end
F_kl:
    s_and_b32 s41, s2, 7
    s_lshl_b32 s41, s41, 1
    s_bfe_u32 s42, s2, 0x10003
    s_add_u32 s41, s41, s42
    s_lshr_b32 s42, s2, 4
    s_sub_u32 s43, s22, 4
    v_lshlrev_b32 v4, 4, v1
    v_mov_b32 v2, 163824
    s_mov_b32 s60, 0
F_klw:
    ds_read_b32 v3, v2 offset:4
    s_waitcnt lgkmcnt(0)
    v_readfirstlane_b32 s61, v3
    s_nop 3
    s_cmp_ge_u32 s61, 8
    s_cbranch_scc1 F_kld
    s_add_u32 s60, s60, 1
    s_cmp_lt_u32 s60, 400000
    s_sleep 1
    s_cbranch_scc1 F_klw
F_kld:
    v_mov_b32 v2, 140288
    v_mov_b32 v3, 0
    ds_write_b32 v2, v3
    s_lshr_b32 s44, s41, 2
    v_and_b32 v5, 15, v1
    v_lshlrev_b32 v5, 2, v5
    v_bfe_u32 v6, v1, 4, 1
    v_add_u32 v6, 1, v6
    v_lshlrev_b32 v6, 9, v6
    s_lshl_b32 s44, s44, 7
    s_add_u32 s44, s44, 14680064
    v_add3_u32 v5, v5, v6, s44
    s_mov_b32 s45, 0
    s_lshl_b32 s48, s41, 6
    s_add_u32 s48, s48, s43
    s_lshl_b32 s48, s48, 12
    s_add_u32 s48, s48, 2097152
    s_lshl_b32 s49, s43, 12
    s_and_b32 s60, s2, 7
    s_and_b32 s62, s60, 1
    s_lshr_b32 s63, s2, 6
    s_sub_u32 s61, s22, 4
    s_getpc_b64 s[56:57]
    s_add_u32 s56, s56, HTAB@rel32@lo+4
    s_addc_u32 s57, s57, HTAB@rel32@hi+12
    s_cmp_eq_u32 s62, 1
    s_cselect_b32 s58, s56, s8
    s_cselect_b32 s59, s57, s9
    s_mov_b32 s28, s58
    s_and_b32 s29, s59, 0xffff
    s_mov_b32 s30, 401408
    s_mov_b32 s31, 0x20000
    v_lshrrev_b32 v8, 4, v1
    v_mul_u32_u24 v9, 896, v8
    v_lshlrev_b32 v10, 2, v8
    v_and_b32 v11, 15, v1
    v_xor_b32 v10, v10, v11
    v_lshl_add_u32 v12, v10, 4, v9
    s_mul_i32 s57, s63, 224
    v_add_u32 v12, s57, v12
    s_cmp_eq_u32 s62, 1
    s_cbranch_scc1 F_wrB
    s_lshr_b32 s56, s61, 1
    s_mul_i32 s56, s56, 28
    s_and_b32 s57, s61, 1
    s_lshl_b32 s58, s57, 4
    s_add_u32 s56, s56, s58
    s_add_u32 s64, s56, 0
    s_add_u32 s65, s56, 4
    s_add_u32 s66, s56, 8
    s_add_u32 s67, s56, 12
    s_cmp_eq_u32 s57, 1
    s_cselect_b32 s67, s66, s67
    s_mov_b32 s68, 56
    s_branch F_wrd
F_wrB:
    s_lshl_b32 s56, s61, 4
    s_add_u32 s64, s56, 0
    s_add_u32 s65, s56, 4
    s_add_u32 s66, s56, 8
    s_add_u32 s67, s56, 12
    s_mov_b32 s68, 64
F_wrd:
    s_mulk_i32 s64, 896
    s_mulk_i32 s65, 896
    s_mulk_i32 s66, 896
    s_mulk_i32 s67, 896
    s_mulk_i32 s68, 896
    s_lshl_b32 s69, s61, 12
F_klrestart:
    s_mov_b32 s50, 0
    s_lshl_b32 s46, 0x01010101, s50
    s_mov_b32 s60, 0
    s_and_b32 s47, s45, s46
    s_cmp_eq_u32 s47, s46
    s_cbranch_scc1 ndd6
nd6:
    buffer_load_dword v7, v5, s[24:27], 0 offen sc1
    s_waitcnt vmcnt(0)
    v_cmp_eq_u32 vcc, s23, v7
    s_nop 1
    s_mov_b32 s45, vcc_lo
    s_and_b32 s47, s45, s46
    s_cmp_eq_u32 s47, s46
    s_cbranch_scc1 ndd6
    s_add_u32 s60, s60, 1
    s_cmp_lt_u32 s60, 400000
    s_cbranch_scc1 nd6
ndd6:
    s_lshl_b32 s52, s50, 14
    s_add_u32 s52, s52, s48
    s_cmp_gt_u32 s50, 7
    s_cselect_b32 s52, 16777216, s52
    s_and_b32 s53, s50, 3
    s_lshl_b32 s53, s53, 15
    s_add_u32 s53, s53, s49
    s_add_u32 m0, s53, 0
    s_add_u32 s54, s52, 0
    buffer_load_dwordx4 v4, s[24:27], s54 offen sc1 lds
    s_add_u32 m0, s53, 1024
    s_add_u32 s54, s52, 1024
    buffer_load_dwordx4 v4, s[24:27], s54 offen sc1 lds
    s_add_u32 m0, s53, 2048
    s_add_u32 s54, s52, 2048
    buffer_load_dwordx4 v4, s[24:27], s54 offen sc1 lds
    s_add_u32 m0, s53, 3072
    s_add_u32 s54, s52, 3072
    buffer_load_dwordx4 v4, s[24:27], s54 offen sc1 lds
    s_add_u32 m0, s53, 16384
    s_add_u32 s54, s52, 131072
    buffer_load_dwordx4 v4, s[24:27], s54 offen sc1 lds
    s_add_u32 m0, s53, 17408
    s_add_u32 s54, s52, 132096
    buffer_load_dwordx4 v4, s[24:27], s54 offen sc1 lds
    s_add_u32 m0, s53, 18432
    s_add_u32 s54, s52, 133120
    buffer_load_dwordx4 v4, s[24:27], s54 offen sc1 lds
    s_add_u32 m0, s53, 19456
    s_add_u32 s54, s52, 134144
    buffer_load_dwordx4 v4, s[24:27], s54 offen sc1 lds
    s_mov_b32 s50, 1
    s_lshl_b32 s46, 0x01010101, s50
    s_mov_b32 s60, 0
    s_and_b32 s47, s45, s46
    s_cmp_eq_u32 s47, s46
    s_cbranch_scc1 ndd7
nd7:
    buffer_load_dword v7, v5, s[24:27], 0 offen sc1
    s_waitcnt vmcnt(0)
    v_cmp_eq_u32 vcc, s23, v7
    s_nop 1
    s_mov_b32 s45, vcc_lo
    s_and_b32 s47, s45, s46
    s_cmp_eq_u32 s47, s46
    s_cbranch_scc1 ndd7
    s_add_u32 s60, s60, 1
    s_cmp_lt_u32 s60, 400000
    s_cbranch_scc1 nd7
ndd7:
    s_lshl_b32 s52, s50, 14
    s_add_u32 s52, s52, s48
    s_cmp_gt_u32 s50, 7
    s_cselect_b32 s52, 16777216, s52
    s_and_b32 s53, s50, 3
    s_lshl_b32 s53, s53, 15
    s_add_u32 s53, s53, s49
    s_add_u32 m0, s53, 0
    s_add_u32 s54, s52, 0
    buffer_load_dwordx4 v4, s[24:27], s54 offen sc1 lds
    s_add_u32 m0, s53, 1024
    s_add_u32 s54, s52, 1024
    buffer_load_dwordx4 v4, s[24:27], s54 offen sc1 lds
    s_add_u32 m0, s53, 2048
    s_add_u32 s54, s52, 2048
    buffer_load_dwordx4 v4, s[24:27], s54 offen sc1 lds
    s_add_u32 m0, s53, 3072
    s_add_u32 s54, s52, 3072
    buffer_load_dwordx4 v4, s[24:27], s54 offen sc1 lds
    s_add_u32 m0, s53, 16384
    s_add_u32 s54, s52, 131072
    buffer_load_dwordx4 v4, s[24:27], s54 offen sc1 lds
    s_add_u32 m0, s53, 17408
    s_add_u32 s54, s52, 132096
    buffer_load_dwordx4 v4, s[24:27], s54 offen sc1 lds
    s_add_u32 m0, s53, 18432
    s_add_u32 s54, s52, 133120
    buffer_load_dwordx4 v4, s[24:27], s54 offen sc1 lds
    s_add_u32 m0, s53, 19456
    s_add_u32 s54, s52, 134144
    buffer_load_dwordx4 v4, s[24:27], s54 offen sc1 lds
    s_mov_b32 s50, 2
    s_lshl_b32 s46, 0x01010101, s50
    s_mov_b32 s60, 0
    s_and_b32 s47, s45, s46
    s_cmp_eq_u32 s47, s46
    s_cbranch_scc1 ndd8
nd8:
    buffer_load_dword v7, v5, s[24:27], 0 offen sc1
    s_waitcnt vmcnt(0)
    v_cmp_eq_u32 vcc, s23, v7
    s_nop 1
    s_mov_b32 s45, vcc_lo
    s_and_b32 s47, s45, s46
    s_cmp_eq_u32 s47, s46
    s_cbranch_scc1 ndd8
    s_add_u32 s60, s60, 1
    s_cmp_lt_u32 s60, 400000
    s_cbranch_scc1 nd8
ndd8:
    s_lshl_b32 s52, s50, 14
    s_add_u32 s52, s52, s48
    s_cmp_gt_u32 s50, 7
    s_cselect_b32 s52, 16777216, s52
    s_and_b32 s53, s50, 3
    s_lshl_b32 s53, s53, 15
    s_add_u32 s53, s53, s49
    s_add_u32 m0, s53, 0
    s_add_u32 s54, s52, 0
    buffer_load_dwordx4 v4, s[24:27], s54 offen sc1 lds
    s_add_u32 m0, s53, 1024
    s_add_u32 s54, s52, 1024
    buffer_load_dwordx4 v4, s[24:27], s54 offen sc1 lds
    s_add_u32 m0, s53, 2048
    s_add_u32 s54, s52, 2048
    buffer_load_dwordx4 v4, s[24:27], s54 offen sc1 lds
    s_add_u32 m0, s53, 3072
    s_add_u32 s54, s52, 3072
    buffer_load_dwordx4 v4, s[24:27], s54 offen sc1 lds
    s_add_u32 m0, s53, 16384
    s_add_u32 s54, s52, 131072
    buffer_load_dwordx4 v4, s[24:27], s54 offen sc1 lds
    s_add_u32 m0, s53, 17408
    s_add_u32 s54, s52, 132096
    buffer_load_dwordx4 v4, s[24:27], s54 offen sc1 lds
    s_add_u32 m0, s53, 18432
    s_add_u32 s54, s52, 133120
    buffer_load_dwordx4 v4, s[24:27], s54 offen sc1 lds
    s_add_u32 m0, s53, 19456
    s_add_u32 s54, s52, 134144
    buffer_load_dwordx4 v4, s[24:27], s54 offen sc1 lds
    s_waitcnt vmcnt(16) lgkmcnt(0)
    s_barrier
    s_mov_b32 s51, 0
F_klloop:
    s_waitcnt vmcnt(8)
    s_barrier
    s_add_u32 s50, s51, 3
    s_cmp_gt_u32 s50, 7
    s_cbranch_scc1 F_klw3
    s_lshl_b32 s46, 0x01010101, s50
    s_mov_b32 s60, 0
    s_and_b32 s47, s45, s46
    s_cmp_eq_u32 s47, s46
    s_cbranch_scc1 ndd9
nd9:
    buffer_load_dword v7, v5, s[24:27], 0 offen sc1
    s_waitcnt vmcnt(0)
    v_cmp_eq_u32 vcc, s23, v7
    s_nop 1
    s_mov_b32 s45, vcc_lo
    s_and_b32 s47, s45, s46
    s_cmp_eq_u32 s47, s46
    s_cbranch_scc1 ndd9
    s_add_u32 s60, s60, 1
    s_cmp_lt_u32 s60, 400000
    s_cbranch_scc1 nd9
ndd9:
    s_lshl_b32 s52, s50, 14
    s_add_u32 s52, s52, s48
    s_cmp_gt_u32 s50, 7
    s_cselect_b32 s52, 16777216, s52
    s_and_b32 s53, s50, 3
    s_lshl_b32 s53, s53, 15
    s_add_u32 s53, s53, s49
    s_add_u32 m0, s53, 0
    s_add_u32 s54, s52, 0
    buffer_load_dwordx4 v4, s[24:27], s54 offen sc1 lds
    s_add_u32 m0, s53, 1024
    s_add_u32 s54, s52, 1024
    buffer_load_dwordx4 v4, s[24:27], s54 offen sc1 lds
    s_add_u32 m0, s53, 2048
    s_add_u32 s54, s52, 2048
    buffer_load_dwordx4 v4, s[24:27], s54 offen sc1 lds
    s_add_u32 m0, s53, 3072
    s_add_u32 s54, s52, 3072
    buffer_load_dwordx4 v4, s[24:27], s54 offen sc1 lds
    s_add_u32 m0, s53, 16384
    s_add_u32 s54, s52, 131072
    buffer_load_dwordx4 v4, s[24:27], s54 offen sc1 lds
    s_add_u32 m0, s53, 17408
    s_add_u32 s54, s52, 132096
    buffer_load_dwordx4 v4, s[24:27], s54 offen sc1 lds
    s_add_u32 m0, s53, 18432
    s_add_u32 s54, s52, 133120
    buffer_load_dwordx4 v4, s[24:27], s54 offen sc1 lds
    s_add_u32 m0, s53, 19456
    s_add_u32 s54, s52, 134144
    buffer_load_dwordx4 v4, s[24:27], s54 offen sc1 lds
    s_branch F_klnx
F_klw3:
    s_sub_u32 s50, s50, 8
    s_lshl_b32 s56, s50, 1
    s_mul_i32 s57, s56, s68
    s_lshl_b32 s58, s56, 14
    s_add_u32 s58, s58, s69
    s_add_u32 m0, s58, 0
    s_add_u32 s59, s57, s64
    buffer_load_dwordx4 v12, s[28:31], s59 offen lds
    s_add_u32 m0, s58, 1024
    s_add_u32 s59, s57, s65
    buffer_load_dwordx4 v12, s[28:31], s59 offen lds
    s_add_u32 m0, s58, 2048
    s_add_u32 s59, s57, s66
    buffer_load_dwordx4 v12, s[28:31], s59 offen lds
    s_add_u32 m0, s58, 3072
    s_add_u32 s59, s57, s67
    buffer_load_dwordx4 v12, s[28:31], s59 offen lds
    s_lshl_b32 s56, s50, 1
    s_add_u32 s56, s56, 1
    s_mul_i32 s57, s56, s68
    s_lshl_b32 s58, s56, 14
    s_add_u32 s58, s58, s69
    s_add_u32 m0, s58, 0
    s_add_u32 s59, s57, s64
    buffer_load_dwordx4 v12, s[28:31], s59 offen lds
    s_add_u32 m0, s58, 1024
    s_add_u32 s59, s57, s65
    buffer_load_dwordx4 v12, s[28:31], s59 offen lds
    s_add_u32 m0, s58, 2048
    s_add_u32 s59, s57, s66
    buffer_load_dwordx4 v12, s[28:31], s59 offen lds
    s_add_u32 m0, s58, 3072
    s_add_u32 s59, s57, s67
    buffer_load_dwordx4 v12, s[28:31], s59 offen lds
F_klnx:
    s_add_u32 s51, s51, 1
    s_cmp_lt_u32 s51, 8
    s_cbranch_scc1 F_klloop
    s_waitcnt vmcnt(0)
    s_barrier
    v_mov_b32 v2, 140288
    ds_read_b32 v2, v2
    s_waitcnt lgkmcnt(0)
    v_readfirstlane_b32 s56, v2
    s_nop 3
    s_cmp_eq_u32 s56, 1
    s_cbranch_scc0 F_klend
    s_barrier
    s_branch F_klrestart
F_klend:
    s_mov_b32 s50, 3
    s_lshl_b32 s56, s50, 1
    s_mul_i32 s57, s56, s68
    s_lshl_b32 s58, s56, 14
    s_add_u32 s58, s58, s69
    s_add_u32 m0, s58, 0
    s_add_u32 s59, s57, s64
    buffer_load_dwordx4 v12, s[28:31], s59 offen lds
    s_add_u32 m0, s58, 1024
    s_add_u32 s59, s57, s65
    buffer_load_dwordx4 v12, s[28:31], s59 offen lds
    s_add_u32 m0, s58, 2048
    s_add_u32 s59, s57, s66
    buffer_load_dwordx4 v12, s[28:31], s59 offen lds
    s_add_u32 m0, s58, 3072
    s_add_u32 s59, s57, s67
    buffer_load_dwordx4 v12, s[28:31], s59 offen lds
    s_lshl_b32 s56, s50, 1
    s_add_u32 s56, s56, 1
    s_mul_i32 s57, s56, s68
    s_lshl_b32 s58, s56, 14
    s_add_u32 s58, s58, s69
    s_add_u32 m0, s58, 0
    s_add_u32 s59, s57, s64
    buffer_load_dwordx4 v12, s[28:31], s59 offen lds
    s_add_u32 m0, s58, 1024
    s_add_u32 s59, s57, s65
    buffer_load_dwordx4 v12, s[28:31], s59 offen lds
    s_add_u32 m0, s58, 2048
    s_add_u32 s59, s57, s66
    buffer_load_dwordx4 v12, s[28:31], s59 offen lds
    s_add_u32 m0, s58, 3072
    s_add_u32 s59, s57, s67
    buffer_load_dwordx4 v12, s[28:31], s59 offen lds
F_p2end:
    s_waitcnt vmcnt(0)
    s_barrier
    s_and_b32 s60, s2, 7
    s_lshr_b32 s45, s2, 3
    s_and_b32 s48, s60, 1
    s_lshr_b32 s46, s60, 1
    s_lshl_b32 s46, s46, 3
    s_and_b32 s47, s45, 7
    s_add_u32 s46, s46, s47
    s_lshr_b32 s49, s45, 3
    s_mov_b32 s32, s16
    s_and_b32 s33, s17, 0xffff
    s_mov_b32 s34, 3670016
    s_mov_b32 s35, 0x20000
    v_lshrrev_b32 v2, 5, v1
    v_bfe_u32 v3, v1, 2, 2
    v_lshl_add_u32 v2, v2, 2, v3
    v_lshlrev_b32 v16, 8, v2
    v_bfe_u32 v15, v1, 4, 1
    v_lshlrev_b32 v15, 5, v15
    v_and_b32 v17, 3, v1
    v_lshl_add_u32 v15, v17, 3, v15
    s_lshr_b32 s65, s22, 1
    s_mul_i32 s65, s65, 56
    v_add_u32 v17, s65, v15
    v_lshrrev_b32 v18, 4, v17
    v_lshlrev_b32 v19, 2, v3
    v_xor_b32 v18, v18, v19
    v_and_b32 v17, 15, v17
    v_lshl_add_u32 v17, v18, 4, v17
    v_add_u32 v4, v16, v17
    s_and_b32 s65, s22, 1
    s_cmp_eq_u32 s48, 1
    s_cbranch_scc1 F_raB
    s_lshl_b32 s65, s65, 12
    v_lshlrev_b32 v5, 4, v1
    v_add_u32 v5, s65, v5
    s_branch F_radone
F_raB:
    s_lshl_b32 s65, s65, 6
    v_add_u32 v17, s65, v15
    v_lshrrev_b32 v18, 4, v17
    v_bfe_u32 v19, v2, 1, 1
    v_lshlrev_b32 v19, 2, v19
    v_xor_b32 v18, v18, v19
    v_and_b32 v17, 15, v17
    v_lshl_add_u32 v17, v18, 4, v17
    v_lshl_add_u32 v5, v2, 7, v17
F_radone:
    v_add_u32 v5, 131072, v5
    v_mov_b32 v32, 0
    v_mov_b32 v33, 0
    v_mov_b32 v34, 0
    v_mov_b32 v35, 0
    v_mov_b32 v36, 0
    v_mov_b32 v37, 0
    v_mov_b32 v38, 0
    v_mov_b32 v39, 0
    v_mov_b32 v40, 0
    v_mov_b32 v41, 0
    v_mov_b32 v42, 0
    v_mov_b32 v43, 0
    v_mov_b32 v44, 0
    v_mov_b32 v45, 0
    v_mov_b32 v46, 0
    v_mov_b32 v47, 0
    v_and_b32 v2, 31, v1
    s_and_b32 s65, s22, 1
    s_lshl_b32 s65, s65, 5
    v_add_u32 v2, s65, v2
    v_mul_u32_u24 v2, 240, v2
    v_lshrrev_b32 v3, 5, v1
    v_lshl_add_u32 v2, v3, 3, v2
    s_lshr_b32 s65, s22, 1
    s_mul_i32 s65, s65, 56
    v_add_u32 v20, s65, v2
    s_mul_i32 s67, s48, 896
    s_mul_i32 s66, s49, 224
    s_add_u32 s67, s67, s66
    s_lshl_b32 s66, s46, 6
    v_add_u32 v6, 0, v0
    v_min_u32 v6, 895, v6
    v_mul_u32_u24 v7, 4682, v6
    v_lshrrev_b32 v7, 16, v7
    v_mul_u32_u24 v8, 14, v7
    v_sub_u32 v8, v6, v8
    v_mul_u32_u24 v9, 240, v7
    v_lshl_add_u32 v21, v8, 4, v9
    v_add_u32 v7, s66, v7
    s_cmp_eq_u32 s48, 0
    s_cbranch_scc1 F_tk0
    v_and_b32 v9, 3, v7
    v_bfe_u32 v10, v7, 6, 2
    v_lshl_add_u32 v9, v10, 2, v9
    v_lshrrev_b32 v10, 9, v7
    v_lshl_add_u32 v9, v10, 4, v9
    v_lshlrev_b32 v9, 5, v9
    v_bfe_u32 v10, v7, 8, 1
    v_lshl_add_u32 v9, v10, 4, v9
    v_bfe_u32 v10, v7, 2, 4
    v_add_u32 v7, v9, v10
F_tk0:
    v_mul_u32_u24 v7, 1792, v7
    v_lshl_add_u32 v23, v8, 4, v7
    v_add_u32 v6, 512, v0
    v_min_u32 v6, 895, v6
    v_mul_u32_u24 v7, 4682, v6
    v_lshrrev_b32 v7, 16, v7
    v_mul_u32_u24 v8, 14, v7
    v_sub_u32 v8, v6, v8
    v_mul_u32_u24 v9, 240, v7
    v_lshl_add_u32 v22, v8, 4, v9
    v_add_u32 v7, s66, v7
    s_cmp_eq_u32 s48, 0
    s_cbranch_scc1 F_tk1
    v_and_b32 v9, 3, v7
    v_bfe_u32 v10, v7, 6, 2
    v_lshl_add_u32 v9, v10, 2, v9
    v_lshrrev_b32 v10, 9, v7
    v_lshl_add_u32 v9, v10, 4, v9
    v_lshlrev_b32 v9, 5, v9
    v_bfe_u32 v10, v7, 8, 1
    v_lshl_add_u32 v9, v10, 4, v9
    v_bfe_u32 v10, v7, 2, 4
    v_add_u32 v7, v9, v10
F_tk1:
    v_mul_u32_u24 v7, 1792, v7
    v_lshl_add_u32 v24, v8, 4, v7
    s_cmp_eq_u32 s48, 1
    s_cbranch_scc1 F_mainB
    s_barrier
    ds_read_b128 v[48:51], v5 offset:0
    ds_read_b64_tr_b16 v[56:57], v4 offset:0
    ds_read_b64_tr_b16 v[58:59], v4 offset:2048
    ds_read_b128 v[52:55], v5 offset:1024
    ds_read_b64_tr_b16 v[60:61], v4 offset:4096
    ds_read_b64_tr_b16 v[62:63], v4 offset:6144
    ds_read_b128 v[64:67], v5 offset:2048
    ds_read_b64_tr_b16 v[68:69], v4 offset:8192
    ds_read_b64_tr_b16 v[70:71], v4 offset:10240
    s_waitcnt lgkmcnt(6)
    v_mfma_f32_32x32x16_bf16 v[32:47], v[56:59], v[48:51], v[32:47]
    ds_read_b128 v[48:51], v5 offset:3072
    ds_read_b64_tr_b16 v[56:57], v4 offset:12288
    ds_read_b64_tr_b16 v[58:59], v4 offset:14336
    s_waitcnt lgkmcnt(6)
    v_mfma_f32_32x32x16_bf16 v[32:47], v[60:63], v[52:55], v[32:47]
    s_barrier
    ds_read_b128 v[52:55], v5 offset:8192
    ds_read_b64_tr_b16 v[60:61], v4 offset:16384
    ds_read_b64_tr_b16 v[62:63], v4 offset:18432
    s_waitcnt lgkmcnt(6)
    v_mfma_f32_32x32x16_bf16 v[32:47], v[68:71], v[64:67], v[32:47]
    ds_read_b128 v[64:67], v5 offset:9216
    ds_read_b64_tr_b16 v[68:69], v4 offset:20480
    ds_read_b64_tr_b16 v[70:71], v4 offset:22528
    s_waitcnt lgkmcnt(6)
    v_mfma_f32_32x32x16_bf16 v[32:47], v[56:59], v[48:51], v[32:47]
    ds_read_b128 v[48:51], v5 offset:10240
    ds_read_b64_tr_b16 v[56:57], v4 offset:24576
    ds_read_b64_tr_b16 v[58:59], v4 offset:26624
    s_waitcnt lgkmcnt(6)
    v_mfma_f32_32x32x16_bf16 v[32:47], v[60:63], v[52:55], v[32:47]
    ds_read_b128 v[52:55], v5 offset:11264
    ds_read_b64_tr_b16 v[60:61], v4 offset:28672
    ds_read_b64_tr_b16 v[62:63], v4 offset:30720
    s_waitcnt lgkmcnt(6)
    v_mfma_f32_32x32x16_bf16 v[32:47], v[68:71], v[64:67], v[32:47]
    s_barrier
    ds_read_b128 v[64:67], v5 offset:16384
    ds_read_b64_tr_b16 v[68:69], v4 offset:32768
    ds_read_b64_tr_b16 v[70:71], v4 offset:34816
    s_waitcnt lgkmcnt(6)
    v_mfma_f32_32x32x16_bf16 v[32:47], v[56:59], v[48:51], v[32:47]
    ds_read_b128 v[48:51], v5 offset:17408
    ds_read_b64_tr_b16 v[56:57], v4 offset:36864
    ds_read_b64_tr_b16 v[58:59], v4 offset:38912
    s_waitcnt lgkmcnt(6)
    v_mfma_f32_32x32x16_bf16 v[32:47], v[60:63], v[52:55], v[32:47]
    ds_read_b128 v[52:55], v5 offset:18432
    ds_read_b64_tr_b16 v[60:61], v4 offset:40960
    ds_read_b64_tr_b16 v[62:63], v4 offset:43008
    s_waitcnt lgkmcnt(6)
    v_mfma_f32_32x32x16_bf16 v[32:47], v[68:71], v[64:67], v[32:47]
    ds_read_b128 v[64:67], v5 offset:19456
    ds_read_b64_tr_b16 v[68:69], v4 offset:45056
    ds_read_b64_tr_b16 v[70:71], v4 offset:47104
    s_waitcnt lgkmcnt(6)
    v_mfma_f32_32x32x16_bf16 v[32:47], v[56:59], v[48:51], v[32:47]
    s_barrier
    ds_read_b128 v[48:51], v5 offset:24576
    ds_read_b64_tr_b16 v[56:57], v4 offset:49152
    ds_read_b64_tr_b16 v[58:59], v4 offset:51200
    s_waitcnt lgkmcnt(6)
    v_mfma_f32_32x32x16_bf16 v[32:47], v[60:63], v[52:55], v[32:47]
    ds_read_b128 v[52:55], v5 offset:25600
    ds_read_b64_tr_b16 v[60:61], v4 offset:53248
    ds_read_b64_tr_b16 v[62:63], v4 offset:55296
    s_waitcnt lgkmcnt(6)
    v_mfma_f32_32x32x16_bf16 v[32:47], v[68:71], v[64:67], v[32:47]
    ds_read_b128 v[64:67], v5 offset:26624
    ds_read_b64_tr_b16 v[68:69], v4 offset:57344
    ds_read_b64_tr_b16 v[70:71], v4 offset:59392
    s_waitcnt lgkmcnt(6)
    v_mfma_f32_32x32x16_bf16 v[32:47], v[56:59], v[48:51], v[32:47]
    ds_read_b128 v[48:51], v5 offset:27648
    ds_read_b64_tr_b16 v[56:57], v4 offset:61440
    ds_read_b64_tr_b16 v[58:59], v4 offset:63488
    s_waitcnt lgkmcnt(6)
    v_mfma_f32_32x32x16_bf16 v[32:47], v[60:63], v[52:55], v[32:47]
    s_barrier
    v_add_u32 v4, 0x10000, v4
    ds_read_b128 v[52:55], v5 offset:0
    ds_read_b64_tr_b16 v[60:61], v4 offset:0
    ds_read_b64_tr_b16 v[62:63], v4 offset:2048
    s_waitcnt lgkmcnt(6)
    v_mfma_f32_32x32x16_bf16 v[32:47], v[68:71], v[64:67], v[32:47]
    ds_read_b128 v[64:67], v5 offset:1024
    ds_read_b64_tr_b16 v[68:69], v4 offset:4096
    ds_read_b64_tr_b16 v[70:71], v4 offset:6144
    s_waitcnt lgkmcnt(6)
    v_mfma_f32_32x32x16_bf16 v[32:47], v[56:59], v[48:51], v[32:47]
    ds_read_b128 v[48:51], v5 offset:2048
    ds_read_b64_tr_b16 v[56:57], v4 offset:8192
    ds_read_b64_tr_b16 v[58:59], v4 offset:10240
    s_waitcnt lgkmcnt(6)
    v_mfma_f32_32x32x16_bf16 v[32:47], v[60:63], v[52:55], v[32:47]
    ds_read_b128 v[52:55], v5 offset:3072
    ds_read_b64_tr_b16 v[60:61], v4 offset:12288
    ds_read_b64_tr_b16 v[62:63], v4 offset:14336
    s_waitcnt lgkmcnt(6)
    v_mfma_f32_32x32x16_bf16 v[32:47], v[68:71], v[64:67], v[32:47]
    s_barrier
    ds_read_b128 v[64:67], v5 offset:8192
    ds_read_b64_tr_b16 v[68:69], v4 offset:16384
    ds_read_b64_tr_b16 v[70:71], v4 offset:18432
    s_waitcnt lgkmcnt(6)
    v_mfma_f32_32x32x16_bf16 v[32:47], v[56:59], v[48:51], v[32:47]
    ds_read_b128 v[48:51], v5 offset:9216
    ds_read_b64_tr_b16 v[56:57], v4 offset:20480
    ds_read_b64_tr_b16 v[58:59], v4 offset:22528
    s_waitcnt lgkmcnt(6)
    v_mfma_f32_32x32x16_bf16 v[32:47], v[60:63], v[52:55], v[32:47]
    ds_read_b128 v[52:55], v5 offset:10240
    ds_read_b64_tr_b16 v[60:61], v4 offset:24576
    ds_read_b64_tr_b16 v[62:63], v4 offset:26624
    s_waitcnt lgkmcnt(6)
    v_mfma_f32_32x32x16_bf16 v[32:47], v[68:71], v[64:67], v[32:47]
    ds_read_b128 v[64:67], v5 offset:11264
    ds_read_b64_tr_b16 v[68:69], v4 offset:28672
    ds_read_b64_tr_b16 v[70:71], v4 offset:30720
    s_waitcnt lgkmcnt(6)
    v_mfma_f32_32x32x16_bf16 v[32:47], v[56:59], v[48:51], v[32:47]
    s_barrier
    ds_read_b128 v[48:51], v5 offset:16384
    ds_read_b64_tr_b16 v[56:57], v4 offset:32768
    ds_read_b64_tr_b16 v[58:59], v4 offset:34816
    s_waitcnt lgkmcnt(6)
    v_mfma_f32_32x32x16_bf16 v[32:47], v[60:63], v[52:55], v[32:47]
    ds_read_b128 v[52:55], v5 offset:17408
    ds_read_b64_tr_b16 v[60:61], v4 offset:36864
    ds_read_b64_tr_b16 v[62:63], v4 offset:38912
    s_waitcnt lgkmcnt(6)
    v_mfma_f32_32x32x16_bf16 v[32:47], v[68:71], v[64:67], v[32:47]
    ds_read_b128 v[64:67], v5 offset:18432
    ds_read_b64_tr_b16 v[68:69], v4 offset:40960
    ds_read_b64_tr_b16 v[70:71], v4 offset:43008
    s_waitcnt lgkmcnt(6)
    v_mfma_f32_32x32x16_bf16 v[32:47], v[56:59], v[48:51], v[32:47]
    ds_read_b128 v[48:51], v5 offset:19456
    ds_read_b64_tr_b16 v[56:57], v4 offset:45056
    ds_read_b64_tr_b16 v[58:59], v4 offset:47104
    s_waitcnt lgkmcnt(6)
    v_mfma_f32_32x32x16_bf16 v[32:47], v[60:63], v[52:55], v[32:47]
    s_barrier
    ds_read_b128 v[52:55], v5 offset:24576
    ds_read_b64_tr_b16 v[60:61], v4 offset:49152
    ds_read_b64_tr_b16 v[62:63], v4 offset:51200
    s_waitcnt lgkmcnt(6)
    v_mfma_f32_32x32x16_bf16 v[32:47], v[68:71], v[64:67], v[32:47]
    ds_read_b128 v[64:67], v5 offset:25600
    ds_read_b64_tr_b16 v[68:69], v4 offset:53248
    ds_read_b64_tr_b16 v[70:71], v4 offset:55296
    s_waitcnt lgkmcnt(6)
    v_mfma_f32_32x32x16_bf16 v[32:47], v[56:59], v[48:51], v[32:47]
    ds_read_b128 v[48:51], v5 offset:26624
    ds_read_b64_tr_b16 v[56:57], v4 offset:57344
    ds_read_b64_tr_b16 v[58:59], v4 offset:59392
    s_waitcnt lgkmcnt(6)
    v_mfma_f32_32x32x16_bf16 v[32:47], v[60:63], v[52:55], v[32:47]
    ds_read_b128 v[52:55], v5 offset:27648
    ds_read_b64_tr_b16 v[60:61], v4 offset:61440
    ds_read_b64_tr_b16 v[62:63], v4 offset:63488
    s_waitcnt lgkmcnt(6)
    v_mfma_f32_32x32x16_bf16 v[32:47], v[68:71], v[64:67], v[32:47]
    s_waitcnt lgkmcnt(3)
    v_mfma_f32_32x32x16_bf16 v[32:47], v[56:59], v[48:51], v[32:47]
    s_waitcnt lgkmcnt(0)
    v_mfma_f32_32x32x16_bf16 v[32:47], v[60:63], v[52:55], v[32:47]
    s_nop 15
    s_branch F_epi
F_mainB:
    s_barrier
    ds_read_b64_tr_b16 v[48:49], v5 offset:0
    ds_read_b64_tr_b16 v[50:51], v5 offset:1024
    ds_read_b64_tr_b16 v[56:57], v4 offset:0
    ds_read_b64_tr_b16 v[58:59], v4 offset:2048
    ds_read_b64_tr_b16 v[52:53], v5 offset:2048
    ds_read_b64_tr_b16 v[54:55], v5 offset:3072
    ds_read_b64_tr_b16 v[60:61], v4 offset:4096
    ds_read_b64_tr_b16 v[62:63], v4 offset:6144
    ds_read_b64_tr_b16 v[64:65], v5 offset:4096
    ds_read_b64_tr_b16 v[66:67], v5 offset:5120
    ds_read_b64_tr_b16 v[68:69], v4 offset:8192
    ds_read_b64_tr_b16 v[70:71], v4 offset:10240
    s_waitcnt lgkmcnt(8)
    v_mfma_f32_32x32x16_bf16 v[32:47], v[56:59], v[48:51], v[32:47]
    ds_read_b64_tr_b16 v[48:49], v5 offset:6144
    ds_read_b64_tr_b16 v[50:51], v5 offset:7168
    ds_read_b64_tr_b16 v[56:57], v4 offset:12288
    ds_read_b64_tr_b16 v[58:59], v4 offset:14336
    s_waitcnt lgkmcnt(8)
    v_mfma_f32_32x32x16_bf16 v[32:47], v[60:63], v[52:55], v[32:47]
    s_barrier
    ds_read_b64_tr_b16 v[52:53], v5 offset:8192
    ds_read_b64_tr_b16 v[54:55], v5 offset:9216
    ds_read_b64_tr_b16 v[60:61], v4 offset:16384
    ds_read_b64_tr_b16 v[62:63], v4 offset:18432
    s_waitcnt lgkmcnt(8)
    v_mfma_f32_32x32x16_bf16 v[32:47], v[68:71], v[64:67], v[32:47]
    ds_read_b64_tr_b16 v[64:65], v5 offset:10240
    ds_read_b64_tr_b16 v[66:67], v5 offset:11264
    ds_read_b64_tr_b16 v[68:69], v4 offset:20480
    ds_read_b64_tr_b16 v[70:71], v4 offset:22528
    s_waitcnt lgkmcnt(8)
    v_mfma_f32_32x32x16_bf16 v[32:47], v[56:59], v[48:51], v[32:47]
    ds_read_b64_tr_b16 v[48:49], v5 offset:12288
    ds_read_b64_tr_b16 v[50:51], v5 offset:13312
    ds_read_b64_tr_b16 v[56:57], v4 offset:24576
    ds_read_b64_tr_b16 v[58:59], v4 offset:26624
    s_waitcnt lgkmcnt(8)
    v_mfma_f32_32x32x16_bf16 v[32:47], v[60:63], v[52:55], v[32:47]
    ds_read_b64_tr_b16 v[52:53], v5 offset:14336
    ds_read_b64_tr_b16 v[54:55], v5 offset:15360
    ds_read_b64_tr_b16 v[60:61], v4 offset:28672
    ds_read_b64_tr_b16 v[62:63], v4 offset:30720
    s_waitcnt lgkmcnt(8)
    v_mfma_f32_32x32x16_bf16 v[32:47], v[68:71], v[64:67], v[32:47]
    s_barrier
    ds_read_b64_tr_b16 v[64:65], v5 offset:16384
    ds_read_b64_tr_b16 v[66:67], v5 offset:17408
    ds_read_b64_tr_b16 v[68:69], v4 offset:32768
    ds_read_b64_tr_b16 v[70:71], v4 offset:34816
    s_waitcnt lgkmcnt(8)
    v_mfma_f32_32x32x16_bf16 v[32:47], v[56:59], v[48:51], v[32:47]
    ds_read_b64_tr_b16 v[48:49], v5 offset:18432
    ds_read_b64_tr_b16 v[50:51], v5 offset:19456
    ds_read_b64_tr_b16 v[56:57], v4 offset:36864
    ds_read_b64_tr_b16 v[58:59], v4 offset:38912
    s_waitcnt lgkmcnt(8)
    v_mfma_f32_32x32x16_bf16 v[32:47], v[60:63], v[52:55], v[32:47]
    ds_read_b64_tr_b16 v[52:53], v5 offset:20480
    ds_read_b64_tr_b16 v[54:55], v5 offset:21504
    ds_read_b64_tr_b16 v[60:61], v4 offset:40960
    ds_read_b64_tr_b16 v[62:63], v4 offset:43008
    s_waitcnt lgkmcnt(8)
    v_mfma_f32_32x32x16_bf16 v[32:47], v[68:71], v[64:67], v[32:47]
    ds_read_b64_tr_b16 v[64:65], v5 offset:22528
    ds_read_b64_tr_b16 v[66:67], v5 offset:23552
    ds_read_b64_tr_b16 v[68:69], v4 offset:45056
    ds_read_b64_tr_b16 v[70:71], v4 offset:47104
    s_waitcnt lgkmcnt(8)
    v_mfma_f32_32x32x16_bf16 v[32:47], v[56:59], v[48:51], v[32:47]
    s_barrier
    ds_read_b64_tr_b16 v[48:49], v5 offset:24576
    ds_read_b64_tr_b16 v[50:51], v5 offset:25600
    ds_read_b64_tr_b16 v[56:57], v4 offset:49152
    ds_read_b64_tr_b16 v[58:59], v4 offset:51200
    s_waitcnt lgkmcnt(8)
    v_mfma_f32_32x32x16_bf16 v[32:47], v[60:63], v[52:55], v[32:47]
    ds_read_b64_tr_b16 v[52:53], v5 offset:26624
    ds_read_b64_tr_b16 v[54:55], v5 offset:27648
    ds_read_b64_tr_b16 v[60:61], v4 offset:53248
    ds_read_b64_tr_b16 v[62:63], v4 offset:55296
    s_waitcnt lgkmcnt(8)
    v_mfma_f32_32x32x16_bf16 v[32:47], v[68:71], v[64:67], v[32:47]
    ds_read_b64_tr_b16 v[64:65], v5 offset:28672
    ds_read_b64_tr_b16 v[66:67], v5 offset:29696
    ds_read_b64_tr_b16 v[68:69], v4 offset:57344
    ds_read_b64_tr_b16 v[70:71], v4 offset:59392
    s_waitcnt lgkmcnt(8)
    v_mfma_f32_32x32x16_bf16 v[32:47], v[56:59], v[48:51], v[32:47]
    ds_read_b64_tr_b16 v[48:49], v5 offset:30720
    ds_read_b64_tr_b16 v[50:51], v5 offset:31744
    ds_read_b64_tr_b16 v[56:57], v4 offset:61440
    ds_read_b64_tr_b16 v[58:59], v4 offset:63488
    s_waitcnt lgkmcnt(8)
    v_mfma_f32_32x32x16_bf16 v[32:47], v[60:63], v[52:55], v[32:47]
    s_barrier
    v_add_u32 v4, 0x10000, v4
    ds_read_b64_tr_b16 v[52:53], v5 offset:0
    ds_read_b64_tr_b16 v[54:55], v5 offset:1024
    ds_read_b64_tr_b16 v[60:61], v4 offset:0
    ds_read_b64_tr_b16 v[62:63], v4 offset:2048
    s_waitcnt lgkmcnt(8)
    v_mfma_f32_32x32x16_bf16 v[32:47], v[68:71], v[64:67], v[32:47]
    ds_read_b64_tr_b16 v[64:65], v5 offset:2048
    ds_read_b64_tr_b16 v[66:67], v5 offset:3072
    ds_read_b64_tr_b16 v[68:69], v4 offset:4096
    ds_read_b64_tr_b16 v[70:71], v4 offset:6144
    s_waitcnt lgkmcnt(8)
    v_mfma_f32_32x32x16_bf16 v[32:47], v[56:59], v[48:51], v[32:47]
    ds_read_b64_tr_b16 v[48:49], v5 offset:4096
    ds_read_b64_tr_b16 v[50:51], v5 offset:5120
    ds_read_b64_tr_b16 v[56:57], v4 offset:8192
    ds_read_b64_tr_b16 v[58:59], v4 offset:10240
    s_waitcnt lgkmcnt(8)
    v_mfma_f32_32x32x16_bf16 v[32:47], v[60:63], v[52:55], v[32:47]
    ds_read_b64_tr_b16 v[52:53], v5 offset:6144
    ds_read_b64_tr_b16 v[54:55], v5 offset:7168
    ds_read_b64_tr_b16 v[60:61], v4 offset:12288
    ds_read_b64_tr_b16 v[62:63], v4 offset:14336
    s_waitcnt lgkmcnt(8)
    v_mfma_f32_32x32x16_bf16 v[32:47], v[68:71], v[64:67], v[32:47]
    s_barrier
    ds_read_b64_tr_b16 v[64:65], v5 offset:8192
    ds_read_b64_tr_b16 v[66:67], v5 offset:9216
    ds_read_b64_tr_b16 v[68:69], v4 offset:16384
    ds_read_b64_tr_b16 v[70:71], v4 offset:18432
    s_waitcnt lgkmcnt(8)
    v_mfma_f32_32x32x16_bf16 v[32:47], v[56:59], v[48:51], v[32:47]
    ds_read_b64_tr_b16 v[48:49], v5 offset:10240
    ds_read_b64_tr_b16 v[50:51], v5 offset:11264
    ds_read_b64_tr_b16 v[56:57], v4 offset:20480
    ds_read_b64_tr_b16 v[58:59], v4 offset:22528
    s_waitcnt lgkmcnt(8)
    v_mfma_f32_32x32x16_bf16 v[32:47], v[60:63], v[52:55], v[32:47]
    ds_read_b64_tr_b16 v[52:53], v5 offset:12288
    ds_read_b64_tr_b16 v[54:55], v5 offset:13312
    ds_read_b64_tr_b16 v[60:61], v4 offset:24576
    ds_read_b64_tr_b16 v[62:63], v4 offset:26624
    s_waitcnt lgkmcnt(8)
    v_mfma_f32_32x32x16_bf16 v[32:47], v[68:71], v[64:67], v[32:47]
    ds_read_b64_tr_b16 v[64:65], v5 offset:14336
    ds_read_b64_tr_b16 v[66:67], v5 offset:15360
    ds_read_b64_tr_b16 v[68:69], v4 offset:28672
    ds_read_b64_tr_b16 v[70:71], v4 offset:30720
    s_waitcnt lgkmcnt(8)
    v_mfma_f32_32x32x16_bf16 v[32:47], v[56:59], v[48:51], v[32:47]
    s_barrier
    ds_read_b64_tr_b16 v[48:49], v5 offset:16384
    ds_read_b64_tr_b16 v[50:51], v5 offset:17408
    ds_read_b64_tr_b16 v[56:57], v4 offset:32768
    ds_read_b64_tr_b16 v[58:59], v4 offset:34816
    s_waitcnt lgkmcnt(8)
    v_mfma_f32_32x32x16_bf16 v[32:47], v[60:63], v[52:55], v[32:47]
    ds_read_b64_tr_b16 v[52:53], v5 offset:18432
    ds_read_b64_tr_b16 v[54:55], v5 offset:19456
    ds_read_b64_tr_b16 v[60:61], v4 offset:36864
    ds_read_b64_tr_b16 v[62:63], v4 offset:38912
    s_waitcnt lgkmcnt(8)
    v_mfma_f32_32x32x16_bf16 v[32:47], v[68:71], v[64:67], v[32:47]
    ds_read_b64_tr_b16 v[64:65], v5 offset:20480
    ds_read_b64_tr_b16 v[66:67], v5 offset:21504
    ds_read_b64_tr_b16 v[68:69], v4 offset:40960
    ds_read_b64_tr_b16 v[70:71], v4 offset:43008
    s_waitcnt lgkmcnt(8)
    v_mfma_f32_32x32x16_bf16 v[32:47], v[56:59], v[48:51], v[32:47]
    ds_read_b64_tr_b16 v[48:49], v5 offset:22528
    ds_read_b64_tr_b16 v[50:51], v5 offset:23552
    ds_read_b64_tr_b16 v[56:57], v4 offset:45056
    ds_read_b64_tr_b16 v[58:59], v4 offset:47104
    s_waitcnt lgkmcnt(8)
    v_mfma_f32_32x32x16_bf16 v[32:47], v[60:63], v[52:55], v[32:47]
    s_waitcnt lgkmcnt(4)
    v_mfma_f32_32x32x16_bf16 v[32:47], v[68:71], v[64:67], v[32:47]
    s_waitcnt lgkmcnt(0)
    v_mfma_f32_32x32x16_bf16 v[32:47], v[56:59], v[48:51], v[32:47]
    s_barrier
    s_nop 15
F_epi:
    s_cmp_eq_u32 s48, 1
    s_cbranch_scc0 F_nosc
    s_mov_b32 s65, 0x36124925
    v_mul_f32 v32, s65, v32
    v_mul_f32 v33, s65, v33
    v_mul_f32 v34, s65, v34
    v_mul_f32 v35, s65, v35
    v_mul_f32 v36, s65, v36
    v_mul_f32 v37, s65, v37
    v_mul_f32 v38, s65, v38
    v_mul_f32 v39, s65, v39
    v_mul_f32 v40, s65, v40
    v_mul_f32 v41, s65, v41
    v_mul_f32 v42, s65, v42
    v_mul_f32 v43, s65, v43
    v_mul_f32 v44, s65, v44
    v_mul_f32 v45, s65, v45
    v_mul_f32 v46, s65, v46
    v_mul_f32 v47, s65, v47
F_nosc:
    v_cvt_pk_bf16_f32 v48, v32, v33
    v_cvt_pk_bf16_f32 v49, v34, v35
    v_cvt_pk_bf16_f32 v50, v36, v37
    v_cvt_pk_bf16_f32 v51, v38, v39
    v_cvt_pk_bf16_f32 v52, v40, v41
    v_cvt_pk_bf16_f32 v53, v42, v43
    v_cvt_pk_bf16_f32 v54, v44, v45
    v_cvt_pk_bf16_f32 v55, v46, v47
    ds_write_b64 v20, v[48:49] offset:0
    ds_write_b64 v20, v[50:51] offset:16
    ds_write_b64 v20, v[52:53] offset:32
    s_mov_b32 exec_hi, 0
    ds_write_b64 v20, v[54:55] offset:48
    s_mov_b32 exec_hi, -1
    s_waitcnt lgkmcnt(0)
    s_barrier
    ds_read_b128 v[32:35], v21
    ds_read_b128 v[36:39], v22
    s_waitcnt lgkmcnt(1)
    buffer_store_dwordx4 v[32:35], v23, s[32:35], s67 offen
    v_cmp_gt_u32 vcc, 384, v0
    s_and_saveexec_b64 s[64:65], vcc
    s_cbranch_execz F_fin
    s_waitcnt lgkmcnt(0)
    buffer_store_dwordx4 v[36:39], v24, s[32:35], s67 offen
F_fin:
    s_endpgm
F_aux:
    s_sub_u32 s51, s22, 8
    s_getpc_b64 s[52:53]
    s_add_u32 s52, s52, HTAB@rel32@lo+4
    s_addc_u32 s53, s53, HTAB@rel32@hi+12
    v_lshrrev_b32 v2, 3, v1
    s_cmp_eq_u32 s48, 3
    s_cbranch_scc0 F_lp
    v_and_b32 v3, 3, v2
    v_lshlrev_b32 v3, 5, v3
    v_lshrrev_b32 v2, 5, v1
    v_add_u32 v2, v2, v3
F_lp:
    v_mul_u32_u24 v2, 896, v2
    v_and_b32 v3, 7, v1
    v_lshrrev_b32 v4, 4, v1
    v_xor_b32 v5, v3, v4
    v_lshl_add_u32 v10, v5, 4, v2
    v_xor_b32 v5, 4, v5
    v_lshl_add_u32 v11, v5, 4, v2
    s_cmp_eq_u32 s48, 3
    s_cbranch_scc1 F_ltX
    s_lshl_b32 s66, s46, 7
    s_mul_i32 s67, s51, 32
    s_add_u32 s66, s66, s67
    s_add_u32 s56, s66, 0
    s_add_u32 s57, s66, 8
    s_add_u32 s58, s66, 16
    s_add_u32 s59, s66, 24
    s_branch F_ltd
F_ltX:
    s_lshr_b32 s66, s46, 1
    s_lshl_b32 s66, s66, 8
    s_and_b32 s67, s46, 1
    s_lshl_b32 s67, s67, 4
    s_add_u32 s66, s66, s67
    s_mul_i32 s67, s51, 4
    s_add_u32 s66, s66, s67
    s_add_u32 s56, s66, 0
    s_add_u32 s57, s66, 128
    s_add_u32 s58, s66, 2
    s_add_u32 s59, s66, 130
F_ltd:
    s_mulk_i32 s56, 896
    s_mulk_i32 s57, 896
    s_mulk_i32 s58, 896
    s_mulk_i32 s59, 896
    s_cmp_eq_u32 s48, 3
    s_movk_i32 s64, 2688
    s_cselect_b32 s64, 896, s64
    s_mul_i32 s65, s48, 896
    s_cselect_b32 s65, 0, s65
    s_mul_i32 s66, s49, 224
    s_add_u32 s65, s65, s66
    v_lshrrev_b32 v2, 4, v1
    v_mul_lo_u32 v3, v2, s64
    v_lshlrev_b32 v4, 2, v2
    v_and_b32 v5, 15, v1
    v_xor_b32 v4, v4, v5
    v_lshl_add_u32 v12, v4, 4, v3
    v_add_u32 v12, s65, v12
    s_lshl_b32 s65, s64, 2
    s_mul_i32 s66, s64, 16
    s_mul_i32 s66, s66, s51
    s_lshl_b32 s67, s64, 6
    s_mul_i32 s68, s51, 4096
    s_lshr_b32 s69, s45, 3
    s_add_u32 s69, s69, s45
    s_and_b32 s69, s69, 3
    s_lshl_b32 s69, s69, 1
    s_waitcnt lgkmcnt(0)
    s_mov_b32 s24, s20
    s_and_b32 s25, s21, 0xffff
    s_mov_b32 s26, 14745600
    s_mov_b32 s27, 0x20000
    s_cmp_eq_u32 s48, 3
    s_cselect_b32 s54, s10, s4
    s_cselect_b32 s55, s11, s5
    s_mov_b32 s28, s54
    s_and_b32 s29, s55, 0xffff
    s_mov_b32 s30, 1835008
    s_mov_b32 s31, 0x20000
    s_cmp_eq_u32 s48, 3
    s_cselect_b32 s54, s52, s6
    s_cselect_b32 s55, s53, s7
    s_mov_b32 s32, s54
    s_and_b32 s33, s55, 0xffff
    s_cmp_eq_u32 s48, 3
    s_mov_b32 s70, 1204224
    s_cselect_b32 s34, 401408, s70
    s_mov_b32 s35, 0x20000
    s_lshl_b32 s70, s69, 7
    s_mul_i32 s71, s69, s67
    s_add_u32 s71, s71, s66
    s_add_u32 m0, s68, 0
    s_add_u32 s54, s56, s70
    buffer_load_dwordx4 v10, s[28:31], s54 offen lds
    s_add_u32 m0, s68, 16384
    s_nop 0
    buffer_load_dwordx4 v12, s[32:35], s71 offen lds
    s_add_u32 m0, s68, 1024
    s_add_u32 s54, s57, s70
    buffer_load_dwordx4 v11, s[28:31], s54 offen lds
    s_add_u32 m0, s68, 17408
    s_add_u32 s71, s71, s65
    buffer_load_dwordx4 v12, s[32:35], s71 offen lds
    s_add_u32 m0, s68, 2048
    s_add_u32 s54, s58, s70
    buffer_load_dwordx4 v10, s[28:31], s54 offen lds
    s_add_u32 m0, s68, 18432
    s_add_u32 s71, s71, s65
    buffer_load_dwordx4 v12, s[32:35], s71 offen lds
    s_add_u32 m0, s68, 3072
    s_add_u32 s54, s59, s70
    buffer_load_dwordx4 v11, s[28:31], s54 offen lds
    s_add_u32 m0, s68, 19456
    s_add_u32 s71, s71, s65
    buffer_load_dwordx4 v12, s[32:35], s71 offen lds
    s_add_u32 s69, s69, 1
    s_cmp_eq_u32 s69, 7
    s_cselect_b32 s69, 0, s69
    s_lshl_b32 s70, s69, 7
    s_mul_i32 s71, s69, s67
    s_add_u32 s71, s71, s66
    s_add_u32 m0, s68, 32768
    s_add_u32 s54, s56, s70
    buffer_load_dwordx4 v10, s[28:31], s54 offen lds
    s_add_u32 m0, s68, 49152
    s_nop 0
    buffer_load_dwordx4 v12, s[32:35], s71 offen lds
    s_add_u32 m0, s68, 33792
    s_add_u32 s54, s57, s70
    buffer_load_dwordx4 v11, s[28:31], s54 offen lds
    s_add_u32 m0, s68, 50176
    s_add_u32 s71, s71, s65
    buffer_load_dwordx4 v12, s[32:35], s71 offen lds
    s_add_u32 m0, s68, 34816
    s_add_u32 s54, s58, s70
    buffer_load_dwordx4 v10, s[28:31], s54 offen lds
    s_add_u32 m0, s68, 51200
    s_add_u32 s71, s71, s65
    buffer_load_dwordx4 v12, s[32:35], s71 offen lds
    s_add_u32 m0, s68, 35840
    s_add_u32 s54, s59, s70
    buffer_load_dwordx4 v11, s[28:31], s54 offen lds
    s_add_u32 m0, s68, 52224
    s_add_u32 s71, s71, s65
    buffer_load_dwordx4 v12, s[32:35], s71 offen lds
    s_add_u32 s69, s69, 1
    s_cmp_eq_u32 s69, 7
    s_cselect_b32 s69, 0, s69
    s_lshl_b32 s70, s69, 7
    s_mul_i32 s71, s69, s67
    s_add_u32 s71, s71, s66
    s_add_u32 m0, s68, 65536
    s_add_u32 s54, s56, s70
    buffer_load_dwordx4 v10, s[28:31], s54 offen lds
    s_add_u32 m0, s68, 81920
    s_nop 0
    buffer_load_dwordx4 v12, s[32:35], s71 offen lds
    s_add_u32 m0, s68, 66560
    s_add_u32 s54, s57, s70
    buffer_load_dwordx4 v11, s[28:31], s54 offen lds
    s_add_u32 m0, s68, 82944
    s_add_u32 s71, s71, s65
    buffer_load_dwordx4 v12, s[32:35], s71 offen lds
    s_add_u32 m0, s68, 67584
    s_add_u32 s54, s58, s70
    buffer_load_dwordx4 v10, s[28:31], s54 offen lds
    s_add_u32 m0, s68, 83968
    s_add_u32 s71, s71, s65
    buffer_load_dwordx4 v12, s[32:35], s71 offen lds
    s_add_u32 m0, s68, 68608
    s_add_u32 s54, s59, s70
    buffer_load_dwordx4 v11, s[28:31], s54 offen lds
    s_add_u32 m0, s68, 84992
    s_add_u32 s71, s71, s65
    buffer_load_dwordx4 v12, s[32:35], s71 offen lds
    s_add_u32 s69, s69, 1
    s_cmp_eq_u32 s69, 7
    s_cselect_b32 s69, 0, s69
    s_getpc_b64 s[60:61]
    s_add_u32 s60, s60, FTAB@rel32@lo+4
    s_addc_u32 s61, s61, FTAB@rel32@hi+12
    s_mov_b32 s36, s60
    s_and_b32 s37, s61, 0xffff
    s_mov_b32 s38, 63488
    s_mov_b32 s39, 0x20000
    s_bfe_u32 s62, s2, 0x20003
    s_lshl_b32 s62, s62, 2
    s_add_u32 s62, s62, s51
    s_lshl_b32 s62, s62, 12
    v_lshlrev_b32 v34, 6, v1
    buffer_load_dword v35, v34, s[36:39], s62 offen
    s_waitcnt vmcnt(17)
    s_barrier
    s_waitcnt vmcnt(8)
    s_barrier
    s_lshl_b32 s70, s69, 7
    s_mul_i32 s71, s69, s67
    s_add_u32 s71, s71, s66
    s_add_u32 m0, s68, 98304
    s_add_u32 s54, s56, s70
    buffer_load_dwordx4 v10, s[28:31], s54 offen lds
    s_add_u32 m0, s68, 114688
    s_nop 0
    buffer_load_dwordx4 v12, s[32:35], s71 offen lds
    s_add_u32 m0, s68, 99328
    s_add_u32 s54, s57, s70
    buffer_load_dwordx4 v11, s[28:31], s54 offen lds
    s_add_u32 m0, s68, 115712
    s_add_u32 s71, s71, s65
    buffer_load_dwordx4 v12, s[32:35], s71 offen lds
    s_add_u32 m0, s68, 100352
    s_add_u32 s54, s58, s70
    buffer_load_dwordx4 v10, s[28:31], s54 offen lds
    s_add_u32 m0, s68, 116736
    s_add_u32 s71, s71, s65
    buffer_load_dwordx4 v12, s[32:35], s71 offen lds
    s_add_u32 m0, s68, 101376
    s_add_u32 s54, s59, s70
    buffer_load_dwordx4 v11, s[28:31], s54 offen lds
    s_add_u32 m0, s68, 117760
    s_add_u32 s71, s71, s65
    buffer_load_dwordx4 v12, s[32:35], s71 offen lds
    s_add_u32 s69, s69, 1
    s_cmp_eq_u32 s69, 7
    s_cselect_b32 s69, 0, s69
    s_waitcnt vmcnt(8)
    s_barrier
    s_lshl_b32 s70, s69, 7
    s_mul_i32 s71, s69, s67
    s_add_u32 s71, s71, s66
    s_add_u32 m0, s68, 0
    s_add_u32 s54, s56, s70
    buffer_load_dwordx4 v10, s[28:31], s54 offen lds
    s_add_u32 m0, s68, 16384
    s_nop 0
    buffer_load_dwordx4 v12, s[32:35], s71 offen lds
    s_add_u32 m0, s68, 1024
    s_add_u32 s54, s57, s70
    buffer_load_dwordx4 v11, s[28:31], s54 offen lds
    s_add_u32 m0, s68, 17408
    s_add_u32 s71, s71, s65
    buffer_load_dwordx4 v12, s[32:35], s71 offen lds
    s_add_u32 m0, s68, 2048
    s_add_u32 s54, s58, s70
    buffer_load_dwordx4 v10, s[28:31], s54 offen lds
    s_add_u32 m0, s68, 18432
    s_add_u32 s71, s71, s65
    buffer_load_dwordx4 v12, s[32:35], s71 offen lds
    s_add_u32 m0, s68, 3072
    s_add_u32 s54, s59, s70
    buffer_load_dwordx4 v11, s[28:31], s54 offen lds
    s_add_u32 m0, s68, 19456
    s_add_u32 s71, s71, s65
    buffer_load_dwordx4 v12, s[32:35], s71 offen lds
    s_add_u32 s69, s69, 1
    s_cmp_eq_u32 s69, 7
    s_cselect_b32 s69, 0, s69
    s_waitcnt vmcnt(8)
    s_barrier
    s_lshl_b32 s70, s69, 7
    s_mul_i32 s71, s69, s67
    s_add_u32 s71, s71, s66
    s_add_u32 m0, s68, 32768
    s_add_u32 s54, s56, s70
    buffer_load_dwordx4 v10, s[28:31], s54 offen lds
    s_add_u32 m0, s68, 49152
    s_nop 0
    buffer_load_dwordx4 v12, s[32:35], s71 offen lds
    s_add_u32 m0, s68, 33792
    s_add_u32 s54, s57, s70
    buffer_load_dwordx4 v11, s[28:31], s54 offen lds
    s_add_u32 m0, s68, 50176
    s_add_u32 s71, s71, s65
    buffer_load_dwordx4 v12, s[32:35], s71 offen lds
    s_add_u32 m0, s68, 34816
    s_add_u32 s54, s58, s70
    buffer_load_dwordx4 v10, s[28:31], s54 offen lds
    s_add_u32 m0, s68, 51200
    s_add_u32 s71, s71, s65
    buffer_load_dwordx4 v12, s[32:35], s71 offen lds
    s_add_u32 m0, s68, 35840
    s_add_u32 s54, s59, s70
    buffer_load_dwordx4 v11, s[28:31], s54 offen lds
    s_add_u32 m0, s68, 52224
    s_add_u32 s71, s71, s65
    buffer_load_dwordx4 v12, s[32:35], s71 offen lds
    s_add_u32 s69, s69, 1
    s_cmp_eq_u32 s69, 7
    s_cselect_b32 s69, 0, s69
    s_waitcnt vmcnt(8)
    s_barrier
    s_lshl_b32 s70, s69, 7
    s_mul_i32 s71, s69, s67
    s_add_u32 s71, s71, s66
    s_add_u32 m0, s68, 65536
    s_add_u32 s54, s56, s70
    buffer_load_dwordx4 v10, s[28:31], s54 offen lds
    s_add_u32 m0, s68, 81920
    s_nop 0
    buffer_load_dwordx4 v12, s[32:35], s71 offen lds
    s_add_u32 m0, s68, 66560
    s_add_u32 s54, s57, s70
    buffer_load_dwordx4 v11, s[28:31], s54 offen lds
    s_add_u32 m0, s68, 82944
    s_add_u32 s71, s71, s65
    buffer_load_dwordx4 v12, s[32:35], s71 offen lds
    s_add_u32 m0, s68, 67584
    s_add_u32 s54, s58, s70
    buffer_load_dwordx4 v10, s[28:31], s54 offen lds
    s_add_u32 m0, s68, 83968
    s_add_u32 s71, s71, s65
    buffer_load_dwordx4 v12, s[32:35], s71 offen lds
    s_add_u32 m0, s68, 68608
    s_add_u32 s54, s59, s70
    buffer_load_dwordx4 v11, s[28:31], s54 offen lds
    s_add_u32 m0, s68, 84992
    s_add_u32 s71, s71, s65
    buffer_load_dwordx4 v12, s[32:35], s71 offen lds
    s_add_u32 s69, s69, 1
    s_cmp_eq_u32 s69, 7
    s_cselect_b32 s69, 0, s69
    s_mov_b32 s72, s18
    s_and_b32 s73, s19, 0xffff
    s_mov_b32 s74, 256
    s_mov_b32 s75, 0x20000
    v_mov_b32 v33, 0
    buffer_load_dword v32, v33, s[72:75], 0 offen sc1
    s_mov_b32 s36, s12
    s_and_b32 s37, s13, 0xffff
    s_mov_b32 s38, 921600
    s_mov_b32 s39, 0x20000
    s_mov_b32 s72, s14
    s_and_b32 s73, s15, 0xffff
    s_mov_b32 s74, 921600
    s_mov_b32 s75, 0x20000
    v_lshlrev_b32 v13, 1, v1
    s_and_b32 s63, s2, 3
    s_lshl_b32 s63, s63, 7
    s_lshr_b32 s60, s2, 2
    s_lshl_b32 s60, s60, 3
    s_lshl_b32 s61, s51, 1
    s_add_u32 s60, s60, s61
    s_and_b32 s61, s60, 15
    s_lshr_b32 s62, s60, 7
    s_lshl_b32 s62, s62, 4
    s_add_u32 s61, s61, s62
    s_bfe_u32 s62, s60, 0x10006
    s_lshl_b32 s62, s62, 4
    s_bfe_u32 s54, s60, 0x20004
    s_lshl_b32 s54, s54, 2
    s_add_u32 s62, s62, s54
    s_lshl_b32 s62, s62, 6
    s_add_u32 s61, s61, s62
    s_mulk_i32 s61, 450
    s_add_u32 s61, s61, s63
    s_add_u32 s62, s61, 0
    buffer_load_ushort v16, v13, s[36:39], s62 offen
    buffer_load_ushort v20, v13, s[72:75], s62 offen
    s_add_u32 s62, s61, 28800
    buffer_load_ushort v17, v13, s[36:39], s62 offen
    buffer_load_ushort v21, v13, s[72:75], s62 offen
    s_add_u32 s62, s61, 57600
    buffer_load_ushort v18, v13, s[36:39], s62 offen
    buffer_load_ushort v22, v13, s[72:75], s62 offen
    s_add_u32 s62, s61, 86400
    buffer_load_ushort v19, v13, s[36:39], s62 offen
    buffer_load_ushort v23, v13, s[72:75], s62 offen
    s_lshr_b32 s60, s2, 2
    s_lshl_b32 s60, s60, 3
    s_lshl_b32 s61, s51, 1
    s_add_u32 s60, s60, s61
    s_add_u32 s60, s60, 1
    s_and_b32 s61, s60, 15
    s_lshr_b32 s62, s60, 7
    s_lshl_b32 s62, s62, 4
    s_add_u32 s61, s61, s62
    s_bfe_u32 s62, s60, 0x10006
    s_lshl_b32 s62, s62, 4
    s_bfe_u32 s54, s60, 0x20004
    s_lshl_b32 s54, s54, 2
    s_add_u32 s62, s62, s54
    s_lshl_b32 s62, s62, 6
    s_add_u32 s61, s61, s62
    s_mulk_i32 s61, 450
    s_add_u32 s61, s61, s63
    s_add_u32 s62, s61, 0
    buffer_load_ushort v24, v13, s[36:39], s62 offen
    buffer_load_ushort v28, v13, s[72:75], s62 offen
    s_add_u32 s62, s61, 28800
    buffer_load_ushort v25, v13, s[36:39], s62 offen
    buffer_load_ushort v29, v13, s[72:75], s62 offen
    s_add_u32 s62, s61, 57600
    buffer_load_ushort v26, v13, s[36:39], s62 offen
    buffer_load_ushort v30, v13, s[72:75], s62 offen
    s_add_u32 s62, s61, 86400
    buffer_load_ushort v27, v13, s[36:39], s62 offen
    buffer_load_ushort v31, v13, s[72:75], s62 offen
    s_waitcnt vmcnt(25)
    s_barrier
    s_waitcnt vmcnt(17)
    s_barrier
    s_and_b32 s40, s2, 7
    s_mul_i32 s40, s40, 28
    s_lshr_b32 s41, s2, 3
    s_add_u32 s40, s40, s41
    s_cmp_lt_u32 s41, 28
    s_cselect_b32 s40, s40, 255
    s_cmp_eq_u32 s2, 224
    s_cselect_b32 s40, 224, s40
    s_mov_b32 s39, s48
    s_cmp_eq_u32 s39, 3
    s_cbranch_scc0 F_noxe
    s_barrier
    s_barrier
F_noxe:
    s_waitcnt vmcnt(0)
    v_readfirstlane_b32 s23, v32
    s_nop 3
    s_cmp_lg_u32 s23, 0
    s_cbranch_scc1 F_sjtag
    s_mov_b32 s72, s18
    s_and_b32 s73, s19, 0xffff
    s_mov_b32 s74, 256
    s_mov_b32 s75, 0x20000
    v_mov_b32 v2, 0
    s_mov_b32 s70, 0
tagL10:
    buffer_load_dword v3, v2, s[72:75], 0 offen sc1
    s_waitcnt vmcnt(0)
    v_readfirstlane_b32 s23, v3
    s_nop 3
    s_cmp_lg_u32 s23, 0
    s_cbranch_scc1 tagD10
    s_add_u32 s70, s70, 1
    s_cmp_lt_u32 s70, 400000
    s_sleep 1
    s_cbranch_scc1 tagL10
tagD10:
F_sjtag:
    v_lshl_or_b32 v16, v20, 16, v16
    v_lshl_or_b32 v17, v21, 16, v17
    v_lshl_or_b32 v18, v22, 16, v18
    v_lshl_or_b32 v19, v23, 16, v19
    v_lshl_or_b32 v24, v28, 16, v24
    v_lshl_or_b32 v25, v29, 16, v25
    v_lshl_or_b32 v26, v30, 16, v26
    v_lshl_or_b32 v27, v31, 16, v27
    v_mul_u32_u24 v14, 144, v1
    s_lshl_b32 s60, s51, 5
    s_add_u32 s60, s60, 131072
    v_add_u32 v14, s60, v14
    ds_write_b128 v14, v[16:19]
    ds_write_b128 v14, v[24:27] offset:16
    v_mov_b32 v2, 163824
    v_mov_b32 v3, 1
    s_waitcnt lgkmcnt(0)
    s_mov_b64 exec, 1
    ds_add_u32 v2, v3 offset:8
    s_mov_b64 exec, -1
    s_mov_b32 s60, 0
F_sjw:
    ds_read_b32 v4, v2 offset:8
    s_waitcnt lgkmcnt(0)
    v_readfirstlane_b32 s61, v4
    s_nop 3
    s_cmp_ge_u32 s61, 4
    s_cbranch_scc1 F_sjd
    s_add_u32 s60, s60, 1
    s_cmp_lt_u32 s60, 400000
    s_sleep 1
    s_cbranch_scc1 F_sjw
F_sjd:
    v_lshrrev_b32 v4, 3, v1
    s_lshl_b32 s60, s51, 4
    v_add_u32 v4, s60, v4
    v_and_b32 v5, 7, v1
    v_mul_u32_u24 v6, 144, v4
    v_lshl_add_u32 v6, v5, 4, v6
    v_add_u32 v6, 131072, v6
    ds_read_b128 v[16:19], v6
    ds_read_b128 v[20:23], v6 offset:1152
    s_and_b32 s60, s2, 3
    s_lshl_b32 s60, s60, 6
    v_add_u32 v4, s60, v4
    v_lshlrev_b32 v7, 13, v4
    v_lshl_add_u32 v7, v5, 4, v7
    s_lshr_b32 s61, s2, 2
    s_lshl_b32 s61, s61, 7
    s_add_u32 s61, s61, 8388608
    s_waitcnt lgkmcnt(0)
    v_cmp_gt_u32 vcc, 225, v4
    s_and_saveexec_b64 s[62:63], vcc
    buffer_store_dwordx4 v[16:19], v7, s[24:27], s61 offen sc1
    s_mov_b64 exec, s[62:63]
    v_add_u32 v4, 8, v4
    s_add_u32 s61, s61, 65536
    v_cmp_gt_u32 vcc, 225, v4
    s_and_saveexec_b64 s[62:63], vcc
    buffer_store_dwordx4 v[20:23], v7, s[24:27], s61 offen sc1
    s_mov_b64 exec, s[62:63]
    s_cmp_gt_u32 s40, 224
    s_cbranch_scc1 F_nofft0
    s_barrier
    s_waitcnt vmcnt(0)
    v_mov_b32 v2, 163824
    v_mov_b32 v3, 1
    s_mov_b64 exec, 1
    ds_add_rtn_u32 v4, v2, v3 offset:12
    s_mov_b64 exec, -1
    s_waitcnt lgkmcnt(0)
    v_readfirstlane_b32 s60, v4
    s_nop 3
    s_cmp_lg_u32 s60, 3
    s_cbranch_scc1 Fa_sjn
    s_and_b32 s60, s2, 3
    s_lshl_b32 s60, s60, 8
    s_lshr_b32 s61, s2, 2
    s_lshl_b32 s61, s61, 2
    s_add_u32 s60, s60, s61
    s_add_u32 s60, s60, 14684160
    s_mov_b64 s[62:63], exec
    s_mov_b64 exec, 1
    v_mov_b32 v2, 0
    v_mov_b32 v3, s23
    buffer_store_dword v3, v2, s[24:27], s60 offen sc1
    s_mov_b64 exec, s[62:63]
Fa_sjn:
    s_getpc_b64 s[28:29]
    s_add_u32 s28, s28, FTAB@rel32@lo+4
    s_addc_u32 s29, s29, FTAB@rel32@hi+12
    s_and_b32 s29, s29, 0xffff
    s_mov_b32 s30, 63488
    s_mov_b32 s31, 0x20000
    s_sub_u32 s41, s22, 8
    v_lshlrev_b32 v2, 4, v1
    s_mul_i32 s45, s41, 6144
    s_add_u32 s46, s45, 0
    buffer_load_dwordx4 v[36:39], v2, s[28:31], s46 offen offset:0
    buffer_load_dwordx4 v[40:43], v2, s[28:31], s46 offen offset:1024
    buffer_load_dwordx4 v[44:47], v2, s[28:31], s46 offen offset:2048
    buffer_load_dwordx4 v[48:51], v2, s[28:31], s46 offen offset:3072
    s_add_u32 s46, s46, 4096
    buffer_load_dwordx4 v[52:55], v2, s[28:31], s46 offen offset:0
    buffer_load_dwordx4 v[56:59], v2, s[28:31], s46 offen offset:1024
    s_lshl_b32 s47, s41, 12
    s_add_u32 s46, s47, 30720
    buffer_load_dwordx4 v[84:87], v2, s[28:31], s46 offen offset:0
    buffer_load_dwordx4 v[88:91], v2, s[28:31], s46 offen offset:1024
    buffer_load_dwordx4 v[92:95], v2, s[28:31], s46 offen offset:2048
    buffer_load_dwordx4 v[96:99], v2, s[28:31], s46 offen offset:3072
    s_mov_b32 s46, 24576
    buffer_load_dwordx4 v[60:63], v2, s[28:31], s46 offen offset:0
    buffer_load_dwordx4 v[64:67], v2, s[28:31], s46 offen offset:1024
    buffer_load_dwordx4 v[68:71], v2, s[28:31], s46 offen offset:2048
    buffer_load_dwordx4 v[72:75], v2, s[28:31], s46 offen offset:3072
    s_add_u32 s46, s46, 4096
    buffer_load_dwordx4 v[76:79], v2, s[28:31], s46 offen offset:0
    buffer_load_dwordx4 v[80:83], v2, s[28:31], s46 offen offset:1024
    s_add_u32 s46, s47, 47104
    buffer_load_dwordx4 v[108:111], v2, s[28:31], s46 offen offset:0
    buffer_load_dwordx4 v[112:115], v2, s[28:31], s46 offen offset:1024
    buffer_load_dwordx4 v[116:119], v2, s[28:31], s46 offen offset:2048
    buffer_load_dwordx4 v[120:123], v2, s[28:31], s46 offen offset:3072
    s_barrier
    s_mul_i32 s50, s40, 586
    s_lshr_b32 s50, s50, 16
    s_sub_u32 s51, 448, s40
    s_cmp_eq_u32 s40, 0
    s_cselect_b32 s51, 0, s51
    s_mul_i32 s51, s51, 586
    s_lshr_b32 s51, s51, 16
    v_and_b32 v150, 15, v1
    v_lshlrev_b32 v150, 2, v150
    v_cmp_lt_u32 vcc, 15, v1
    v_mov_b32 v151, s50
    v_mov_b32 v152, s51
    v_cndmask_b32 v151, v151, v152, vcc
    v_lshlrev_b32 v151, 7, v151
    v_add_u32 v150, v150, v151
    v_add_u32 v150, 14681600, v150
    s_lshr_b32 s50, s40, 6
    s_lshl_b32 s50, s50, 8
    s_add_u32 s50, s50, 14684160
    v_lshlrev_b32 v151, 2, v1
    v_add_u32 v151, s50, v151
    s_mov_b32 s52, -1
    s_mov_b32 s53, 0
    s_mov_b32 s70, 0
    s_mov_b64 s[68:69], exec
plL11:
    s_mov_b64 exec, s[52:53]
    buffer_load_dword v160, v150, s[24:27], 0 offen sc1
    s_mov_b64 exec, -1
    buffer_load_dword v161, v151, s[24:27], 0 offen sc1
    s_waitcnt vmcnt(0)
    s_mov_b64 s[66:67], 0
    s_mov_b64 exec, s[52:53]
    v_cmp_ne_u32 vcc, s23, v160
    s_nop 1
    s_or_b64 s[66:67], s[66:67], vcc
    s_mov_b64 exec, -1
    v_cmp_ne_u32 vcc, s23, v161
    s_nop 1
    s_or_b64 s[66:67], s[66:67], vcc
    s_mov_b64 exec, s[68:69]
    s_cmp_eq_u64 s[66:67], 0
    s_cbranch_scc1 plD11
    s_add_u32 s70, s70, 1
    s_cmp_lt_u32 s70, 400000
    s_sleep 2
    s_cbranch_scc1 plL11
plD11:
    s_setprio 2
    s_sub_u32 s41, s22, 8
    v_lshlrev_b32 v2, 4, v1
    v_lshrrev_b32 v3, 4, v1
    v_lshlrev_b32 v3, 9, v3
    v_and_b32 v148, 15, v1
    v_lshl_add_u32 v3, v148, 4, v3
    s_lshl_b32 s42, s40, 12
    s_add_u32 s42, s42, 6291456
    s_sub_u32 s43, 448, s40
    s_cmp_eq_u32 s40, 0
    s_cselect_b32 s43, 0, s43
    s_lshl_b32 s44, s43, 12
    s_add_u32 s44, s44, 6291456
    buffer_load_dwordx4 v[4:7], v3, s[24:27], s42 offen offset:0 sc1
    buffer_load_dwordx4 v[20:23], v3, s[24:27], s44 offen offset:0 sc1
    buffer_load_dwordx4 v[8:11], v3, s[24:27], s42 offen offset:2048 sc1
    buffer_load_dwordx4 v[24:27], v3, s[24:27], s44 offen offset:2048 sc1
    buffer_load_dwordx4 v[12:15], v3, s[24:27], s42 offen offset:256 sc1
    buffer_load_dwordx4 v[28:31], v3, s[24:27], s44 offen offset:256 sc1
    buffer_load_dwordx4 v[16:19], v3, s[24:27], s42 offen offset:2304 sc1
    buffer_load_dwordx4 v[32:35], v3, s[24:27], s44 offen offset:2304 sc1
    s_lshl_b32 s46, s40, 13
    s_lshl_b32 s48, s41, 11
    s_add_u32 s46, s46, s48
    s_add_u32 s46, s46, 8388608
    buffer_load_dwordx4 v[100:103], v2, s[24:27], s46 offen offset:0 sc1
    buffer_load_dwordx4 v[104:107], v2, s[24:27], s46 offen offset:1024 sc1
    s_barrier
    s_waitcnt vmcnt(0)
    v_mfma_f32_16x16x32_bf16 v[124:127], v[4:7], v[36:39], 0
    v_mfma_f32_16x16x32_bf16 v[132:135], v[4:7], v[52:55], 0
    v_mfma_f32_16x16x32_bf16 v[128:131], v[12:15], v[36:39], 0
    v_mfma_f32_16x16x32_bf16 v[136:139], v[12:15], v[52:55], 0
    v_mfma_f32_16x16x32_bf16 v[124:127], v[8:11], v[40:43], v[124:127]
    v_mfma_f32_16x16x32_bf16 v[132:135], v[8:11], v[56:59], v[132:135]
    v_mfma_f32_16x16x32_bf16 v[128:131], v[16:19], v[40:43], v[128:131]
    v_mfma_f32_16x16x32_bf16 v[136:139], v[16:19], v[56:59], v[136:139]
    v_mfma_f32_16x16x32_bf16 v[124:127], v[20:23], v[44:47], v[124:127]
    v_mfma_f32_16x16x32_bf16 v[132:135], v[20:23], v[36:39], v[132:135]
    v_mfma_f32_16x16x32_bf16 v[128:131], v[28:31], v[44:47], v[128:131]
    v_mfma_f32_16x16x32_bf16 v[136:139], v[28:31], v[36:39], v[136:139]
    v_mfma_f32_16x16x32_bf16 v[124:127], v[24:27], v[48:51], v[124:127]
    v_mfma_f32_16x16x32_bf16 v[132:135], v[24:27], v[40:43], v[132:135]
    v_mfma_f32_16x16x32_bf16 v[128:131], v[32:35], v[48:51], v[128:131]
    v_mfma_f32_16x16x32_bf16 v[136:139], v[32:35], v[40:43], v[136:139]
    s_nop 7
    v_pk_mul_f32 v[148:149], v[132:133], v[88:89]
    v_pk_mul_f32 v[152:153], v[132:133], v[84:85]
    v_pk_mul_f32 v[150:151], v[134:135], v[90:91]
    v_pk_mul_f32 v[154:155], v[134:135], v[86:87]
    v_pk_fma_f32 v[156:157], v[124:125], v[84:85], v[148:149] neg_lo:[0,0,1] neg_hi:[0,0,1]
    v_pk_fma_f32 v[160:161], v[124:125], v[88:89], v[152:153]
    v_pk_fma_f32 v[158:159], v[126:127], v[86:87], v[150:151] neg_lo:[0,0,1] neg_hi:[0,0,1]
    v_pk_fma_f32 v[162:163], v[126:127], v[90:91], v[154:155]
    v_cvt_pk_bf16_f32 v140, v156, v157
    v_cvt_pk_bf16_f32 v141, v158, v159
    v_cvt_pk_bf16_f32 v144, v160, v161
    v_cvt_pk_bf16_f32 v145, v162, v163
    v_pk_mul_f32 v[148:149], v[136:137], v[96:97]
    v_pk_mul_f32 v[152:153], v[136:137], v[92:93]
    v_pk_mul_f32 v[150:151], v[138:139], v[98:99]
    v_pk_mul_f32 v[154:155], v[138:139], v[94:95]
    v_pk_fma_f32 v[156:157], v[128:129], v[92:93], v[148:149] neg_lo:[0,0,1] neg_hi:[0,0,1]
    v_pk_fma_f32 v[160:161], v[128:129], v[96:97], v[152:153]
    v_pk_fma_f32 v[158:159], v[130:131], v[94:95], v[150:151] neg_lo:[0,0,1] neg_hi:[0,0,1]
    v_pk_fma_f32 v[162:163], v[130:131], v[98:99], v[154:155]
    v_cvt_pk_bf16_f32 v142, v156, v157
    v_cvt_pk_bf16_f32 v143, v158, v159
    v_cvt_pk_bf16_f32 v146, v160, v161
    v_cvt_pk_bf16_f32 v147, v162, v163
    s_nop 1
    v_mfma_f32_16x16x32_bf16 v[124:127], v[60:63], v[140:143], 0
    v_mfma_f32_16x16x32_bf16 v[132:135], v[68:71], v[140:143], 0
    v_mfma_f32_16x16x32_bf16 v[128:131], v[64:67], v[140:143], 0
    v_mfma_f32_16x16x32_bf16 v[136:139], v[72:75], v[140:143], 0
    v_mfma_f32_16x16x32_bf16 v[124:127], v[76:79], v[144:147], v[124:127]
    v_mfma_f32_16x16x32_bf16 v[132:135], v[60:63], v[144:147], v[132:135]
    v_mfma_f32_16x16x32_bf16 v[128:131], v[80:83], v[144:147], v[128:131]
    v_mfma_f32_16x16x32_bf16 v[136:139], v[64:67], v[144:147], v[136:139]
    s_nop 7
    v_lshlrev_b32 v4, 16, v100
    v_and_b32 v8, 0xffff0000, v100
    v_lshlrev_b32 v5, 16, v101
    v_and_b32 v9, 0xffff0000, v101
    v_lshlrev_b32 v6, 16, v102
    v_and_b32 v10, 0xffff0000, v102
    v_lshlrev_b32 v7, 16, v103
    v_and_b32 v11, 0xffff0000, v103
    v_lshlrev_b32 v12, 16, v104
    v_and_b32 v16, 0xffff0000, v104
    v_lshlrev_b32 v13, 16, v105
    v_and_b32 v17, 0xffff0000, v105
    v_lshlrev_b32 v14, 16, v106
    v_and_b32 v18, 0xffff0000, v106
    v_lshlrev_b32 v15, 16, v107
    v_and_b32 v19, 0xffff0000, v107
    v_pk_mul_f32 v[148:149], v[132:133], v[8:9]
    v_pk_mul_f32 v[152:153], v[132:133], v[4:5]
    v_pk_mul_f32 v[150:151], v[134:135], v[10:11]
    v_pk_mul_f32 v[154:155], v[134:135], v[6:7]
    v_pk_fma_f32 v[156:157], v[124:125], v[4:5], v[148:149] neg_lo:[0,0,1] neg_hi:[0,0,1]
    v_pk_fma_f32 v[160:161], v[124:125], v[8:9], v[152:153]
    v_pk_fma_f32 v[158:159], v[126:127], v[6:7], v[150:151] neg_lo:[0,0,1] neg_hi:[0,0,1]
    v_pk_fma_f32 v[162:163], v[126:127], v[10:11], v[154:155]
    v_cvt_pk_bf16_f32 v140, v156, v157
    v_cvt_pk_bf16_f32 v141, v158, v159
    v_cvt_pk_bf16_f32 v144, v160, v161
    v_cvt_pk_bf16_f32 v145, v162, v163
    v_pk_mul_f32 v[148:149], v[136:137], v[16:17]
    v_pk_mul_f32 v[152:153], v[136:137], v[12:13]
    v_pk_mul_f32 v[150:151], v[138:139], v[18:19]
    v_pk_mul_f32 v[154:155], v[138:139], v[14:15]
    v_pk_fma_f32 v[156:157], v[128:129], v[12:13], v[148:149] neg_lo:[0,0,1] neg_hi:[0,0,1]
    v_pk_fma_f32 v[160:161], v[128:129], v[16:17], v[152:153]
    v_pk_fma_f32 v[158:159], v[130:131], v[14:15], v[150:151] neg_lo:[0,0,1] neg_hi:[0,0,1]
    v_pk_fma_f32 v[162:163], v[130:131], v[18:19], v[154:155]
    v_cvt_pk_bf16_f32 v142, v156, v157
    v_cvt_pk_bf16_f32 v143, v158, v159
    v_cvt_pk_bf16_f32 v146, v160, v161
    v_cvt_pk_bf16_f32 v147, v162, v163
    s_nop 1
    v_mfma_f32_16x16x32_bf16 v[124:127], v[140:143], v[60:63], 0
    v_mfma_f32_16x16x32_bf16 v[132:135], v[140:143], v[76:79], 0
    v_mfma_f32_16x16x32_bf16 v[128:131], v[140:143], v[64:67], 0
    v_mfma_f32_16x16x32_bf16 v[136:139], v[140:143], v[80:83], 0
    v_mfma_f32_16x16x32_bf16 v[124:127], v[144:147], v[68:71], v[124:127]
    v_mfma_f32_16x16x32_bf16 v[132:135], v[144:147], v[60:63], v[132:135]
    v_mfma_f32_16x16x32_bf16 v[128:131], v[144:147], v[72:75], v[128:131]
    v_mfma_f32_16x16x32_bf16 v[136:139], v[144:147], v[64:67], v[136:139]
    s_nop 3
    v_and_b32 v164, 15, v1
    v_mul_u32_u24 v164, 144, v164
    v_lshrrev_b32 v165, 4, v1
    v_lshl_add_u32 v166, v165, 3, v164
    s_lshl_b32 s46, s41, 5
    s_add_u32 s46, s46, 131072
    v_add_u32 v166, s46, v166
    v_lshl_add_u32 v167, v165, 4, v164
    v_add_u32 v167, 131072, v167
    s_nop 1
    v_pk_mul_f32 v[148:149], v[132:133], v[112:113]
    v_pk_mul_f32 v[152:153], v[132:133], v[108:109]
    v_pk_mul_f32 v[150:151], v[134:135], v[114:115]
    v_pk_mul_f32 v[154:155], v[134:135], v[110:111]
    v_pk_fma_f32 v[156:157], v[124:125], v[108:109], v[148:149] neg_lo:[0,0,1] neg_hi:[0,0,1]
    v_pk_fma_f32 v[160:161], v[124:125], v[112:113], v[152:153]
    v_pk_fma_f32 v[158:159], v[126:127], v[110:111], v[150:151] neg_lo:[0,0,1] neg_hi:[0,0,1]
    v_pk_fma_f32 v[162:163], v[126:127], v[114:115], v[154:155]
    v_cvt_pk_bf16_f32 v140, v156, v157
    v_cvt_pk_bf16_f32 v141, v158, v159
    v_cvt_pk_bf16_f32 v144, v160, v161
    v_cvt_pk_bf16_f32 v145, v162, v163
    ds_write_b64 v166, v[140:141] offset:0
    ds_write_b64 v166, v[144:145] offset:4608
    v_pk_mul_f32 v[148:149], v[136:137], v[120:121]
    v_pk_mul_f32 v[152:153], v[136:137], v[116:117]
    v_pk_mul_f32 v[150:151], v[138:139], v[122:123]
    v_pk_mul_f32 v[154:155], v[138:139], v[118:119]
    v_pk_fma_f32 v[156:157], v[128:129], v[116:117], v[148:149] neg_lo:[0,0,1] neg_hi:[0,0,1]
    v_pk_fma_f32 v[160:161], v[128:129], v[120:121], v[152:153]
    v_pk_fma_f32 v[158:159], v[130:131], v[118:119], v[150:151] neg_lo:[0,0,1] neg_hi:[0,0,1]
    v_pk_fma_f32 v[162:163], v[130:131], v[122:123], v[154:155]
    v_cvt_pk_bf16_f32 v142, v156, v157
    v_cvt_pk_bf16_f32 v143, v158, v159
    v_cvt_pk_bf16_f32 v146, v160, v161
    v_cvt_pk_bf16_f32 v147, v162, v163
    ds_write_b64 v166, v[142:143] offset:2304
    ds_write_b64 v166, v[146:147] offset:6912
    s_waitcnt lgkmcnt(0)
    s_barrier
    ds_read_b128 v[60:63], v167 offset:0
    ds_read_b128 v[64:67], v167 offset:64
    ds_read_b128 v[68:71], v167 offset:2304
    ds_read_b128 v[72:75], v167 offset:2368
    ds_read_b128 v[76:79], v167 offset:4608
    ds_read_b128 v[80:83], v167 offset:4672
    ds_read_b128 v[84:87], v167 offset:6912
    ds_read_b128 v[88:91], v167 offset:6976
    s_waitcnt lgkmcnt(0)
    v_mfma_f32_16x16x32_bf16 v[124:127], v[36:39], v[60:63], 0
    v_mfma_f32_16x16x32_bf16 v[132:135], v[44:47], v[60:63], 0
    v_mfma_f32_16x16x32_bf16 v[128:131], v[36:39], v[68:71], 0
    v_mfma_f32_16x16x32_bf16 v[136:139], v[44:47], v[68:71], 0
    v_mfma_f32_16x16x32_bf16 v[124:127], v[40:43], v[64:67], v[124:127]
    v_mfma_f32_16x16x32_bf16 v[132:135], v[48:51], v[64:67], v[132:135]
    v_mfma_f32_16x16x32_bf16 v[128:131], v[40:43], v[72:75], v[128:131]
    v_mfma_f32_16x16x32_bf16 v[136:139], v[48:51], v[72:75], v[136:139]
    v_mfma_f32_16x16x32_bf16 v[124:127], v[52:55], v[76:79], v[124:127]
    v_mfma_f32_16x16x32_bf16 v[132:135], v[36:39], v[76:79], v[132:135]
    v_mfma_f32_16x16x32_bf16 v[128:131], v[52:55], v[84:87], v[128:131]
    v_mfma_f32_16x16x32_bf16 v[136:139], v[36:39], v[84:87], v[136:139]
    v_mfma_f32_16x16x32_bf16 v[124:127], v[56:59], v[80:83], v[124:127]
    v_mfma_f32_16x16x32_bf16 v[132:135], v[40:43], v[80:83], v[132:135]
    v_mfma_f32_16x16x32_bf16 v[128:131], v[56:59], v[88:91], v[128:131]
    v_mfma_f32_16x16x32_bf16 v[136:139], v[40:43], v[88:91], v[136:139]
    s_nop 7
    s_cmp_eq_u32 s40, 0
    s_cbranch_scc1 F_avg
    s_cmp_eq_u32 s40, 224
    s_cbranch_scc0 F_noavg
F_avg:
    v_add_f32 v124, v124, v132
    v_mul_f32 v124, 0.5, v124
    v_mov_b32 v132, v124
    v_add_f32 v125, v125, v133
    v_mul_f32 v125, 0.5, v125
    v_mov_b32 v133, v125
    v_add_f32 v126, v126, v134
    v_mul_f32 v126, 0.5, v126
    v_mov_b32 v134, v126
    v_add_f32 v127, v127, v135
    v_mul_f32 v127, 0.5, v127
    v_mov_b32 v135, v127
    v_add_f32 v128, v128, v136
    v_mul_f32 v128, 0.5, v128
    v_mov_b32 v136, v128
    v_add_f32 v129, v129, v137
    v_mul_f32 v129, 0.5, v129
    v_mov_b32 v137, v129
    v_add_f32 v130, v130, v138
    v_mul_f32 v130, 0.5, v130
    v_mov_b32 v138, v130
    v_add_f32 v131, v131, v139
    v_mul_f32 v131, 0.5, v131
    v_mov_b32 v139, v131
F_noavg:
    v_cvt_pk_bf16_f32 v140, v124, v125
    v_cvt_pk_bf16_f32 v141, v126, v127
    v_cvt_pk_bf16_f32 v144, v132, v133
    v_cvt_pk_bf16_f32 v145, v134, v135
    v_cvt_pk_bf16_f32 v142, v128, v129
    v_cvt_pk_bf16_f32 v143, v130, v131
    v_cvt_pk_bf16_f32 v146, v136, v137
    v_cvt_pk_bf16_f32 v147, v138, v139
    v_lshlrev_b32 v2, 3, v1
    s_lshl_b32 s46, s41, 10
    s_lshl_b32 s47, s40, 12
    s_add_u32 s47, s47, s46
    s_add_u32 s47, s47, 12582912
    s_lshl_b32 s48, s43, 12
    s_add_u32 s48, s48, s46
    s_add_u32 s48, s48, 12582912
    buffer_store_dwordx2 v[140:141], v2, s[24:27], s47 offen offset:0 sc1
    buffer_store_dwordx2 v[144:145], v2, s[24:27], s48 offen offset:0 sc1
    buffer_store_dwordx2 v[142:143], v2, s[24:27], s47 offen offset:512 sc1
    buffer_store_dwordx2 v[146:147], v2, s[24:27], s48 offen offset:512 sc1
    s_setprio 0
    s_barrier
    s_waitcnt vmcnt(0)
    s_barrier
    s_cmp_lg_u32 s22, 8
    s_cbranch_scc1 F_fftd
    s_lshl_b32 s50, s40, 2
    s_add_u32 s50, s50, 14692352
    s_mov_b64 s[68:69], exec
    s_mov_b64 exec, 1
    v_mov_b32 v2, 0
    v_mov_b32 v3, s23
    buffer_store_dword v3, v2, s[24:27], s50 offen sc1
    s_mov_b64 exec, s[68:69]
F_fftd:
    s_barrier
    s_barrier
    s_barrier
    s_branch F_fftmb
F_nofft0:
    s_waitcnt vmcnt(0)
    v_mov_b32 v2, 163824
    v_mov_b32 v3, 1
    s_mov_b64 exec, 1
    ds_add_rtn_u32 v4, v2, v3 offset:12
    s_mov_b64 exec, -1
    s_waitcnt lgkmcnt(0)
    v_readfirstlane_b32 s60, v4
    s_nop 3
    s_cmp_lg_u32 s60, 3
    s_cbranch_scc1 Fb_sjn
    s_and_b32 s60, s2, 3
    s_lshl_b32 s60, s60, 8
    s_lshr_b32 s61, s2, 2
    s_lshl_b32 s61, s61, 2
    s_add_u32 s60, s60, s61
    s_add_u32 s60, s60, 14684160
    s_mov_b64 s[62:63], exec
    s_mov_b64 exec, 1
    v_mov_b32 v2, 0
    v_mov_b32 v3, s23
    buffer_store_dword v3, v2, s[24:27], s60 offen sc1
    s_mov_b64 exec, s[62:63]
Fb_sjn:
    s_barrier
    s_barrier
    s_barrier
    s_barrier
    s_barrier
    s_barrier
    s_barrier
    s_barrier
    s_barrier
F_fftmb:
    s_barrier
    v_mov_b32 v2, 140288
    ds_read_b32 v2, v2
    s_waitcnt lgkmcnt(0)
    v_readfirstlane_b32 s56, v2
    s_nop 3
    s_cmp_eq_u32 s56, 1
    s_cbranch_scc0 F_fftok
    s_barrier
    s_barrier
    s_barrier
    s_barrier
    s_barrier
    s_barrier
    s_barrier
    s_barrier
    s_barrier
    s_barrier
    s_barrier
F_fftok:
    s_barrier
    s_and_b32 s60, s2, 7
    s_lshr_b32 s45, s2, 3
    s_and_b32 s48, s60, 1
    s_lshr_b32 s46, s60, 1
    s_lshl_b32 s46, s46, 3
    s_and_b32 s47, s45, 7
    s_add_u32 s46, s46, s47
    s_lshr_b32 s49, s45, 3
    s_sub_u32 s51, s22, 8
    s_cmp_eq_u32 s48, 1
    s_cbranch_scc1 F_tB
    s_lshl_b32 s56, s46, 1
    s_lshr_b32 s57, s51, 1
    s_add_u32 s56, s56, s57
    s_lshl_b32 s56, s56, 4
    s_and_b32 s57, s51, 1
    s_add_u32 s56, s56, s57
    s_lshl_b32 s56, s56, 11
    s_add_u32 s56, s56, 10485760
    v_lshlrev_b32 v10, 4, v1
    s_movk_i32 s57, 4096
    s_movk_i32 s58, 1024
    s_branch F_tD
F_tB:
    v_lshrrev_b32 v2, 3, v1
    v_bfe_u32 v3, v1, 4, 1
    v_lshlrev_b32 v3, 2, v3
    v_and_b32 v4, 7, v1
    v_xor_b32 v3, v3, v4
    v_lshlrev_b32 v3, 4, v3
    v_lshl_add_u32 v10, v2, 12, v3
    s_lshl_b32 s56, s51, 16
    s_lshl_b32 s57, s46, 7
    s_add_u32 s56, s56, s57
    s_add_u32 s56, s56, 12582912
    s_mov_b32 s57, 262144
    s_mov_b32 s58, 32768
F_tD:
    s_lshl_b32 s59, s51, 11
    s_mov_b32 s45, 0
    s_cmp_eq_u32 s48, 1
    s_cbranch_scc0 F_p3A
    v_lshlrev_b32 v4, 2, v1
    v_add_u32 v4, 14692352, v4
    v_add_u32 v5, 256, v4
    v_add_u32 v6, 512, v4
    v_add_u32 v7, 768, v4
    s_mov_b32 s52, -1
    s_mov_b32 s53, 1
    s_mov_b32 s70, 0
    s_mov_b64 s[68:69], exec
plL12:
    s_mov_b64 exec, -1
    buffer_load_dword v160, v4, s[24:27], 0 offen sc1
    s_mov_b64 exec, -1
    buffer_load_dword v161, v5, s[24:27], 0 offen sc1
    s_mov_b64 exec, -1
    buffer_load_dword v162, v6, s[24:27], 0 offen sc1
    s_mov_b64 exec, s[52:53]
    buffer_load_dword v163, v7, s[24:27], 0 offen sc1
    s_waitcnt vmcnt(0)
    s_mov_b64 s[66:67], 0
    s_mov_b64 exec, -1
    v_cmp_ne_u32 vcc, s23, v160
    s_nop 1
    s_or_b64 s[66:67], s[66:67], vcc
    s_mov_b64 exec, -1
    v_cmp_ne_u32 vcc, s23, v161
    s_nop 1
    s_or_b64 s[66:67], s[66:67], vcc
    s_mov_b64 exec, -1
    v_cmp_ne_u32 vcc, s23, v162
    s_nop 1
    s_or_b64 s[66:67], s[66:67], vcc
    s_mov_b64 exec, s[52:53]
    v_cmp_ne_u32 vcc, s23, v163
    s_nop 1
    s_or_b64 s[66:67], s[66:67], vcc
    s_mov_b64 exec, s[68:69]
    s_cmp_eq_u64 s[66:67], 0
    s_cbranch_scc1 plD12
    s_add_u32 s70, s70, 1
    s_cmp_lt_u32 s70, 400000
    s_sleep 2
    s_cbranch_scc1 plL12
plD12:
    s_mov_b32 s45, -1
F_p3A:
    s_lshr_b32 s50, s46, 1
    s_lshl_b32 s50, s50, 7
    s_add_u32 s50, s50, 14688256
    v_and_b32 v5, 15, v1
    v_lshlrev_b32 v5, 2, v5
    v_add_u32 v5, s50, v5
    s_mov_b32 s60, 0
    s_and_b32 s47, s45, 3
    s_cmp_eq_u32 s47, 3
    s_cbranch_scc1 nqd13
nq13:
    buffer_load_dword v7, v5, s[24:27], 0 offen sc1
    s_waitcnt vmcnt(0)
    v_cmp_eq_u32 vcc, s23, v7
    s_nop 1
    s_mov_b32 s45, vcc_lo
    s_and_b32 s47, s45, 3
    s_cmp_eq_u32 s47, 3
    s_cbranch_scc1 nqd13
    s_add_u32 s60, s60, 1
    s_cmp_lt_u32 s60, 400000
    s_cbranch_scc1 nq13
nqd13:
    s_add_u32 m0, s59, 131072
    s_add_u32 s62, s56, s58
    buffer_load_dwordx4 v10, s[24:27], s56 offen sc1 lds
    s_add_u32 m0, s59, 132096
    s_nop 0
    buffer_load_dwordx4 v10, s[24:27], s62 offen sc1 lds
    s_add_u32 s56, s56, s57
    s_mov_b32 s60, 0
    s_and_b32 s47, s45, 12
    s_cmp_eq_u32 s47, 12
    s_cbranch_scc1 nqd14
nq14:
    buffer_load_dword v7, v5, s[24:27], 0 offen sc1
    s_waitcnt vmcnt(0)
    v_cmp_eq_u32 vcc, s23, v7
    s_nop 1
    s_mov_b32 s45, vcc_lo
    s_and_b32 s47, s45, 12
    s_cmp_eq_u32 s47, 12
    s_cbranch_scc1 nqd14
    s_add_u32 s60, s60, 1
    s_cmp_lt_u32 s60, 400000
    s_cbranch_scc1 nq14
nqd14:
    s_add_u32 m0, s59, 139264
    s_add_u32 s62, s56, s58
    buffer_load_dwordx4 v10, s[24:27], s56 offen sc1 lds
    s_add_u32 m0, s59, 140288
    s_nop 0
    buffer_load_dwordx4 v10, s[24:27], s62 offen sc1 lds
    s_add_u32 s56, s56, s57
    s_mov_b32 s60, 0
    s_and_b32 s47, s45, 48
    s_cmp_eq_u32 s47, 48
    s_cbranch_scc1 nqd15
nq15:
    buffer_load_dword v7, v5, s[24:27], 0 offen sc1
    s_waitcnt vmcnt(0)
    v_cmp_eq_u32 vcc, s23, v7
    s_nop 1
    s_mov_b32 s45, vcc_lo
    s_and_b32 s47, s45, 48
    s_cmp_eq_u32 s47, 48
    s_cbranch_scc1 nqd15
    s_add_u32 s60, s60, 1
    s_cmp_lt_u32 s60, 400000
    s_cbranch_scc1 nq15
nqd15:
    s_add_u32 m0, s59, 147456
    s_add_u32 s62, s56, s58
    buffer_load_dwordx4 v10, s[24:27], s56 offen sc1 lds
    s_add_u32 m0, s59, 148480
    s_nop 0
    buffer_load_dwordx4 v10, s[24:27], s62 offen sc1 lds
    s_add_u32 s56, s56, s57
    s_mov_b32 s60, 0
    s_and_b32 s47, s45, 192
    s_cmp_eq_u32 s47, 192
    s_cbranch_scc1 nqd16
nq16:
    buffer_load_dword v7, v5, s[24:27], 0 offen sc1
    s_waitcnt vmcnt(0)
    v_cmp_eq_u32 vcc, s23, v7
    s_nop 1
    s_mov_b32 s45, vcc_lo
    s_and_b32 s47, s45, 192
    s_cmp_eq_u32 s47, 192
    s_cbranch_scc1 nqd16
    s_add_u32 s60, s60, 1
    s_cmp_lt_u32 s60, 400000
    s_cbranch_scc1 nq16
nqd16:
    s_add_u32 m0, s59, 155648
    s_add_u32 s62, s56, s58
    buffer_load_dwordx4 v10, s[24:27], s56 offen sc1 lds
    s_add_u32 m0, s59, 156672
    s_nop 0
    buffer_load_dwordx4 v10, s[24:27], s62 offen sc1 lds
    s_add_u32 s56, s56, s57
    s_waitcnt vmcnt(6)
    s_barrier
    s_waitcnt vmcnt(4)
    s_barrier
    s_waitcnt vmcnt(2)
    s_barrier
    s_mov_b32 s60, 0
    s_and_b32 s47, s45, 768
    s_cmp_eq_u32 s47, 768
    s_cbranch_scc1 nqd17
nq17:
    buffer_load_dword v7, v5, s[24:27], 0 offen sc1
    s_waitcnt vmcnt(0)
    v_cmp_eq_u32 vcc, s23, v7
    s_nop 1
    s_mov_b32 s45, vcc_lo
    s_and_b32 s47, s45, 768
    s_cmp_eq_u32 s47, 768
    s_cbranch_scc1 nqd17
    s_add_u32 s60, s60, 1
    s_cmp_lt_u32 s60, 400000
    s_cbranch_scc1 nq17
nqd17:
    s_add_u32 m0, s59, 131072
    s_add_u32 s62, s56, s58
    buffer_load_dwordx4 v10, s[24:27], s56 offen sc1 lds
    s_add_u32 m0, s59, 132096
    s_nop 0
    buffer_load_dwordx4 v10, s[24:27], s62 offen sc1 lds
    s_add_u32 s56, s56, s57
    s_waitcnt vmcnt(2)
    s_barrier
    s_mov_b32 s60, 0
    s_and_b32 s47, s45, 3072
    s_cmp_eq_u32 s47, 3072
    s_cbranch_scc1 nqd18
nq18:
    buffer_load_dword v7, v5, s[24:27], 0 offen sc1
    s_waitcnt vmcnt(0)
    v_cmp_eq_u32 vcc, s23, v7
    s_nop 1
    s_mov_b32 s45, vcc_lo
    s_and_b32 s47, s45, 3072
    s_cmp_eq_u32 s47, 3072
    s_cbranch_scc1 nqd18
    s_add_u32 s60, s60, 1
    s_cmp_lt_u32 s60, 400000
    s_cbranch_scc1 nq18
nqd18:
    s_add_u32 m0, s59, 139264
    s_add_u32 s62, s56, s58
    buffer_load_dwordx4 v10, s[24:27], s56 offen sc1 lds
    s_add_u32 m0, s59, 140288
    s_nop 0
    buffer_load_dwordx4 v10, s[24:27], s62 offen sc1 lds
    s_add_u32 s56, s56, s57
    s_waitcnt vmcnt(2)
    s_barrier
    s_mov_b32 s60, 0
    s_and_b32 s47, s45, 12288
    s_cmp_eq_u32 s47, 12288
    s_cbranch_scc1 nqd19
nq19:
    buffer_load_dword v7, v5, s[24:27], 0 offen sc1
    s_waitcnt vmcnt(0)
    v_cmp_eq_u32 vcc, s23, v7
    s_nop 1
    s_mov_b32 s45, vcc_lo
    s_and_b32 s47, s45, 12288
    s_cmp_eq_u32 s47, 12288
    s_cbranch_scc1 nqd19
    s_add_u32 s60, s60, 1
    s_cmp_lt_u32 s60, 400000
    s_cbranch_scc1 nq19
nqd19:
    s_add_u32 m0, s59, 147456
    s_add_u32 s62, s56, s58
    buffer_load_dwordx4 v10, s[24:27], s56 offen sc1 lds
    s_add_u32 m0, s59, 148480
    s_nop 0
    buffer_load_dwordx4 v10, s[24:27], s62 offen sc1 lds
    s_add_u32 s56, s56, s57
    s_waitcnt vmcnt(2)
    s_barrier
    s_mov_b32 s60, 0
    s_and_b32 s47, s45, 49152
    s_cmp_eq_u32 s47, 49152
    s_cbranch_scc1 nqd20
nq20:
    buffer_load_dword v7, v5, s[24:27], 0 offen sc1
    s_waitcnt vmcnt(0)
    v_cmp_eq_u32 vcc, s23, v7
    s_nop 1
    s_mov_b32 s45, vcc_lo
    s_and_b32 s47, s45, 49152
    s_cmp_eq_u32 s47, 49152
    s_cbranch_scc1 nqd20
    s_add_u32 s60, s60, 1
    s_cmp_lt_u32 s60, 400000
    s_cbranch_scc1 nq20
nqd20:
    s_add_u32 m0, s59, 155648
    s_add_u32 s62, s56, s58
    buffer_load_dwordx4 v10, s[24:27], s56 offen sc1 lds
    s_add_u32 m0, s59, 156672
    s_nop 0
    buffer_load_dwordx4 v10, s[24:27], s62 offen sc1 lds
    s_add_u32 s56, s56, s57
    s_waitcnt vmcnt(2)
    s_barrier
    s_waitcnt vmcnt(0)
    s_barrier
    s_endpgm
F_end:
    s_endpgm
.section .rodata,"a"
.p2align 6
.amdhsa_kernel concat_heads__softmax_full_mha__spectral_gfnet__prompt_kernel
  .amdhsa_next_free_vgpr 168
  .amdhsa_next_free_sgpr 102
  .amdhsa_accum_offset 168
  .amdhsa_group_segment_fixed_size 0
  .amdhsa_kernarg_size 72
  .amdhsa_user_sgpr_count 2
  .amdhsa_user_sgpr_kernarg_segment_ptr 1
  .amdhsa_system_sgpr_workgroup_id_x 1
.end_amdhsa_kernel
.section .rodata,"a"
.p2align 8
.set cas_0, 0x3f80
.set cas_1, 0x3f82
.set cas_2, 0x3f84
.set cas_3, 0x3f85
.set cas_4, 0x3f87
.set cas_5, 0x3f89
.set cas_6, 0x3f8a
.set cas_7, 0x3f8c
.set cas_8, 0x3f8e
.set cas_9, 0x3f8f
.set cas_10, 0x3f91
.set cas_11, 0x3f92
.set cas_12, 0x3f94
.set cas_13, 0x3f95
.set cas_14, 0x3f97
.set cas_15, 0x3f98
.set cas_16, 0x3f99
.set cas_17, 0x3f9b
.set cas_18, 0x3f9c
.set cas_19, 0x3f9d
.set cas_20, 0x3f9e
.set cas_21, 0x3fa0
.set cas_22, 0x3fa1
.set cas_23, 0x3fa2
.set cas_24, 0x3fa3
.set cas_25, 0x3fa4
.set cas_26, 0x3fa5
.set cas_27, 0x3fa6
.set cas_28, 0x3fa7
.set cas_29, 0x3fa8
.set cas_30, 0x3fa9
.set cas_31, 0x3faa
.set cas_32, 0x3fab
.set cas_33, 0x3fac
.set cas_34, 0x3fac
.set cas_35, 0x3fad
.set cas_36, 0x3fae
.set cas_37, 0x3faf
.set cas_38, 0x3faf
.set cas_39, 0x3fb0
.set cas_40, 0x3fb0
.set cas_41, 0x3fb1
.set cas_42, 0x3fb2
.set cas_43, 0x3fb2
.set cas_44, 0x3fb2
.set cas_45, 0x3fb3
.set cas_46, 0x3fb3
.set cas_47, 0x3fb4
.set cas_48, 0x3fb4
.set cas_49, 0x3fb4
.set cas_50, 0x3fb4
.set cas_51, 0x3fb5
.set cas_52, 0x3fb5
.set cas_53, 0x3fb5
.set cas_54, 0x3fb5
.set cas_55, 0x3fb5
.set cas_56, 0x3fb5
.set cas_57, 0x3fb5
.set cas_58, 0x3fb5
.set cas_59, 0x3fb5
.set cas_60, 0x3fb5
.set cas_61, 0x3fb5
.set cas_62, 0x3fb4
.set cas_63, 0x3fb4
.set cas_64, 0x3fb4
.set cas_65, 0x3fb4
.set cas_66, 0x3fb3
.set cas_67, 0x3fb3
.set cas_68, 0x3fb2
.set cas_69, 0x3fb2
.set cas_70, 0x3fb2
.set cas_71, 0x3fb1
.set cas_72, 0x3fb0
.set cas_73, 0x3fb0
.set cas_74, 0x3faf
.set cas_75, 0x3faf
.set cas_76, 0x3fae
.set cas_77, 0x3fad
.set cas_78, 0x3fac
.set cas_79, 0x3fac
.set cas_80, 0x3fab
.set cas_81, 0x3faa
.set cas_82, 0x3fa9
.set cas_83, 0x3fa8
.set cas_84, 0x3fa7
.set cas_85, 0x3fa6
.set cas_86, 0x3fa5
.set cas_87, 0x3fa4
.set cas_88, 0x3fa3
.set cas_89, 0x3fa2
.set cas_90, 0x3fa1
.set cas_91, 0x3fa0
.set cas_92, 0x3f9e
.set cas_93, 0x3f9d
.set cas_94, 0x3f9c
.set cas_95, 0x3f9b
.set cas_96, 0x3f99
.set cas_97, 0x3f98
.set cas_98, 0x3f97
.set cas_99, 0x3f95
.set cas_100, 0x3f94
.set cas_101, 0x3f92
.set cas_102, 0x3f91
.set cas_103, 0x3f8f
.set cas_104, 0x3f8e
.set cas_105, 0x3f8c
.set cas_106, 0x3f8a
.set cas_107, 0x3f89
.set cas_108, 0x3f87
.set cas_109, 0x3f85
.set cas_110, 0x3f84
.set cas_111, 0x3f82
.set cas_112, 0x3f80
.set cas_113, 0x3f7c
.set cas_114, 0x3f79
.set cas_115, 0x3f75
.set cas_116, 0x3f71
.set cas_117, 0x3f6d
.set cas_118, 0x3f6a
.set cas_119, 0x3f66
.set cas_120, 0x3f62
.set cas_121, 0x3f5e
.set cas_122, 0x3f5a
.set cas_123, 0x3f56
.set cas_124, 0x3f52
.set cas_125, 0x3f4d
.set cas_126, 0x3f49
.set cas_127, 0x3f45
.set cas_128, 0x3f41
.set cas_129, 0x3f3c
.set cas_130, 0x3f38
.set cas_131, 0x3f34
.set cas_132, 0x3f2f
.set cas_133, 0x3f2b
.set cas_134, 0x3f26
.set cas_135, 0x3f22
.set cas_136, 0x3f1d
.set cas_137, 0x3f18
.set cas_138, 0x3f14
.set cas_139, 0x3f0f
.set cas_140, 0x3f0b
.set cas_141, 0x3f06
.set cas_142, 0x3f01
.set cas_143, 0x3ef9
.set cas_144, 0x3eef
.set cas_145, 0x3ee6
.set cas_146, 0x3edc
.set cas_147, 0x3ed2
.set cas_148, 0x3ec8
.set cas_149, 0x3ebf
.set cas_150, 0x3eb5
.set cas_151, 0x3eab
.set cas_152, 0x3ea1
.set cas_153, 0x3e97
.set cas_154, 0x3e8d
.set cas_155, 0x3e83
.set cas_156, 0x3e73
.set cas_157, 0x3e5f
.set cas_158, 0x3e4a
.set cas_159, 0x3e36
.set cas_160, 0x3e22
.set cas_161, 0x3e0e
.set cas_162, 0x3df3
.set cas_163, 0x3dcb
.set cas_164, 0x3da2
.set cas_165, 0x3d74
.set cas_166, 0x3d22
.set cas_167, 0x3ca2
.set cas_168, 0x2500
.set cas_169, 0xbca2
.set cas_170, 0xbd22
.set cas_171, 0xbd74
.set cas_172, 0xbda2
.set cas_173, 0xbdcb
.set cas_174, 0xbdf3
.set cas_175, 0xbe0e
.set cas_176, 0xbe22
.set cas_177, 0xbe36
.set cas_178, 0xbe4a
.set cas_179, 0xbe5f
.set cas_180, 0xbe73
.set cas_181, 0xbe83
.set cas_182, 0xbe8d
.set cas_183, 0xbe97
.set cas_184, 0xbea1
.set cas_185, 0xbeab
.set cas_186, 0xbeb5
.set cas_187, 0xbebf
.set cas_188, 0xbec8
.set cas_189, 0xbed2
.set cas_190, 0xbedc
.set cas_191, 0xbee6
.set cas_192, 0xbeef
.set cas_193, 0xbef9
.set cas_194, 0xbf01
.set cas_195, 0xbf06
.set cas_196, 0xbf0b
.set cas_197, 0xbf0f
.set cas_198, 0xbf14
.set cas_199, 0xbf18
.set cas_200, 0xbf1d
.set cas_201, 0xbf22
.set cas_202, 0xbf26
.set cas_203, 0xbf2b
.set cas_204, 0xbf2f
.set cas_205, 0xbf34
.set cas_206, 0xbf38
.set cas_207, 0xbf3c
.set cas_208, 0xbf41
.set cas_209, 0xbf45
.set cas_210, 0xbf49
.set cas_211, 0xbf4d
.set cas_212, 0xbf52
.set cas_213, 0xbf56
.set cas_214, 0xbf5a
.set cas_215, 0xbf5e
.set cas_216, 0xbf62
.set cas_217, 0xbf66
.set cas_218, 0xbf6a
.set cas_219, 0xbf6d
.set cas_220, 0xbf71
.set cas_221, 0xbf75
.set cas_222, 0xbf79
.set cas_223, 0xbf7c
.set cas_224, 0xbf80
.set cas_225, 0xbf82
.set cas_226, 0xbf84
.set cas_227, 0xbf85
.set cas_228, 0xbf87
.set cas_229, 0xbf89
.set cas_230, 0xbf8a
.set cas_231, 0xbf8c
.set cas_232, 0xbf8e
.set cas_233, 0xbf8f
.set cas_234, 0xbf91
.set cas_235, 0xbf92
.set cas_236, 0xbf94
.set cas_237, 0xbf95
.set cas_238, 0xbf97
.set cas_239, 0xbf98
.set cas_240, 0xbf99
.set cas_241, 0xbf9b
.set cas_242, 0xbf9c
.set cas_243, 0xbf9d
.set cas_244, 0xbf9e
.set cas_245, 0xbfa0
.set cas_246, 0xbfa1
.set cas_247, 0xbfa2
.set cas_248, 0xbfa3
.set cas_249, 0xbfa4
.set cas_250, 0xbfa5
.set cas_251, 0xbfa6
.set cas_252, 0xbfa7
.set cas_253, 0xbfa8
.set cas_254, 0xbfa9
.set cas_255, 0xbfaa
.set cas_256, 0xbfab
.set cas_257, 0xbfac
.set cas_258, 0xbfac
.set cas_259, 0xbfad
.set cas_260, 0xbfae
.set cas_261, 0xbfaf
.set cas_262, 0xbfaf
.set cas_263, 0xbfb0
.set cas_264, 0xbfb0
.set cas_265, 0xbfb1
.set cas_266, 0xbfb2
.set cas_267, 0xbfb2
.set cas_268, 0xbfb2
.set cas_269, 0xbfb3
.set cas_270, 0xbfb3
.set cas_271, 0xbfb4
.set cas_272, 0xbfb4
.set cas_273, 0xbfb4
.set cas_274, 0xbfb4
.set cas_275, 0xbfb5
.set cas_276, 0xbfb5
.set cas_277, 0xbfb5
.set cas_278, 0xbfb5
.set cas_279, 0xbfb5
.set cas_280, 0xbfb5
.set cas_281, 0xbfb5
.set cas_282, 0xbfb5
.set cas_283, 0xbfb5
.set cas_284, 0xbfb5
.set cas_285, 0xbfb5
.set cas_286, 0xbfb4
.set cas_287, 0xbfb4
.set cas_288, 0xbfb4
.set cas_289, 0xbfb4
.set cas_290, 0xbfb3
.set cas_291, 0xbfb3
.set cas_292, 0xbfb2
.set cas_293, 0xbfb2
.set cas_294, 0xbfb2
.set cas_295, 0xbfb1
.set cas_296, 0xbfb0
.set cas_297, 0xbfb0
.set cas_298, 0xbfaf
.set cas_299, 0xbfaf
.set cas_300, 0xbfae
.set cas_301, 0xbfad
.set cas_302, 0xbfac
.set cas_303, 0xbfac
.set cas_304, 0xbfab
.set cas_305, 0xbfaa
.set cas_306, 0xbfa9
.set cas_307, 0xbfa8
.set cas_308, 0xbfa7
.set cas_309, 0xbfa6
.set cas_310, 0xbfa5
.set cas_311, 0xbfa4
.set cas_312, 0xbfa3
.set cas_313, 0xbfa2
.set cas_314, 0xbfa1
.set cas_315, 0xbfa0
.set cas_316, 0xbf9e
.set cas_317, 0xbf9d
.set cas_318, 0xbf9c
.set cas_319, 0xbf9b
.set cas_320, 0xbf99
.set cas_321, 0xbf98
.set cas_322, 0xbf97
.set cas_323, 0xbf95
.set cas_324, 0xbf94
.set cas_325, 0xbf92
.set cas_326, 0xbf91
.set cas_327, 0xbf8f
.set cas_328, 0xbf8e
.set cas_329, 0xbf8c
.set cas_330, 0xbf8a
.set cas_331, 0xbf89
.set cas_332, 0xbf87
.set cas_333, 0xbf85
.set cas_334, 0xbf84
.set cas_335, 0xbf82
.set cas_336, 0xbf80
.set cas_337, 0xbf7c
.set cas_338, 0xbf79
.set cas_339, 0xbf75
.set cas_340, 0xbf71
.set cas_341, 0xbf6d
.set cas_342, 0xbf6a
.set cas_343, 0xbf66
.set cas_344, 0xbf62
.set cas_345, 0xbf5e
.set cas_346, 0xbf5a
.set cas_347, 0xbf56
.set cas_348, 0xbf52
.set cas_349, 0xbf4d
.set cas_350, 0xbf49
.set cas_351, 0xbf45
.set cas_352, 0xbf41
.set cas_353, 0xbf3c
.set cas_354, 0xbf38
.set cas_355, 0xbf34
.set cas_356, 0xbf2f
.set cas_357, 0xbf2b
.set cas_358, 0xbf26
.set cas_359, 0xbf22
.set cas_360, 0xbf1d
.set cas_361, 0xbf18
.set cas_362, 0xbf14
.set cas_363, 0xbf0f
.set cas_364, 0xbf0b
.set cas_365, 0xbf06
.set cas_366, 0xbf01
.set cas_367, 0xbef9
.set cas_368, 0xbeef
.set cas_369, 0xbee6
.set cas_370, 0xbedc
.set cas_371, 0xbed2
.set cas_372, 0xbec8
.set cas_373, 0xbebf
.set cas_374, 0xbeb5
.set cas_375, 0xbeab
.set cas_376, 0xbea1
.set cas_377, 0xbe97
.set cas_378, 0xbe8d
.set cas_379, 0xbe83
.set cas_380, 0xbe73
.set cas_381, 0xbe5f
.set cas_382, 0xbe4a
.set cas_383, 0xbe36
.set cas_384, 0xbe22
.set cas_385, 0xbe0e
.set cas_386, 0xbdf3
.set cas_387, 0xbdcb
.set cas_388, 0xbda2
.set cas_389, 0xbd74
.set cas_390, 0xbd22
.set cas_391, 0xbca2
.set cas_392, 0xa5c0
.set cas_393, 0x3ca2
.set cas_394, 0x3d22
.set cas_395, 0x3d74
.set cas_396, 0x3da2
.set cas_397, 0x3dcb
.set cas_398, 0x3df3
.set cas_399, 0x3e0e
.set cas_400, 0x3e22
.set cas_401, 0x3e36
.set cas_402, 0x3e4a
.set cas_403, 0x3e5f
.set cas_404, 0x3e73
.set cas_405, 0x3e83
.set cas_406, 0x3e8d
.set cas_407, 0x3e97
.set cas_408, 0x3ea1
.set cas_409, 0x3eab
.set cas_410, 0x3eb5
.set cas_411, 0x3ebf
.set cas_412, 0x3ec8
.set cas_413, 0x3ed2
.set cas_414, 0x3edc
.set cas_415, 0x3ee6
.set cas_416, 0x3eef
.set cas_417, 0x3ef9
.set cas_418, 0x3f01
.set cas_419, 0x3f06
.set cas_420, 0x3f0b
.set cas_421, 0x3f0f
.set cas_422, 0x3f14
.set cas_423, 0x3f18
.set cas_424, 0x3f1d
.set cas_425, 0x3f22
.set cas_426, 0x3f26
.set cas_427, 0x3f2b
.set cas_428, 0x3f2f
.set cas_429, 0x3f34
.set cas_430, 0x3f38
.set cas_431, 0x3f3c
.set cas_432, 0x3f41
.set cas_433, 0x3f45
.set cas_434, 0x3f49
.set cas_435, 0x3f4d
.set cas_436, 0x3f52
.set cas_437, 0x3f56
.set cas_438, 0x3f5a
.set cas_439, 0x3f5e
.set cas_440, 0x3f62
.set cas_441, 0x3f66
.set cas_442, 0x3f6a
.set cas_443, 0x3f6d
.set cas_444, 0x3f71
.set cas_445, 0x3f75
.set cas_446, 0x3f79
.set cas_447, 0x3f7c
.altmacro
.macro hpair a, b
  .long cas_\a | (cas_\b << 16)
.endm
.macro hrow d
  .set hidx, 0
  .rept 224
    hpair %hidx, %((hidx + \d) % 448)
    .set hidx, (hidx + 2*\d) % 448
  .endr
.endm
HTAB:
.set hd, 0
.rept 448
  hrow %hd
  .set hd, hd + 1
.endr
.noaltmacro
.p2align 8
FTAB:
.quad 0x3f003f003f003f00,0x3f003f003f003f00,0x3eab3ec93ee63f00,0x3d8e3e0d3e523e8b,0x3e0d3e8b3ec93f00,0xbec9be8bbe0d2480,0xbd8e3e0d3eab3f00,0xbf2dbf17bee6be8b
.quad 0xbe8b24803e8b3f00,0xbf27bf35bf27bf00,0xbee6be0d3e523f00,0xbeabbf17bf34bf27,0xbf17be8b3e0d3f00,0x3e0dbe8bbf17bf35,0xbf2dbec93d8e3f00,0x3f0c3e0dbeabbf27
.quad 0xbf35bf0024803f00,0x3f353f00a500bf00,0xbf2dbf17bd8e3f00,0x3f0c3f323eabbe8b,0xbf17bf27be0d3f00,0x3e0d3f273f17a500,0xbee6bf32be523f00,0xbeab3ec93f343e8b
.quad 0xbe8bbf35be8b3f00,0xbf2725403f273f00,0xbd8ebf32beab3f00,0xbf2dbec93ee63f27,0x3e0dbf27bec93f00,0xbec9bf273e0d3f35,0x3eabbf17bee63f00,0x3d8ebf32be523f27
.quad 0x3f003f003f003f00,0x3f003f003f003f00,0xbe52be0dbd8e2480,0xbee6bec9beabbe8b,0xbf32bf27bf17bf00,0xbf17bf27bf32bf35,0xbee6bf17bf2dbf35,0x3eab3e0dbd8ebe8b
.quad 0x3e8ba500be8bbf00,0x3f273f353f273f00,0x3f343f173eaba500,0xbe523e0d3ee63f27,0x3ec93f273f323f00,0xbf32bf27bec92540,0xbeab3e0d3f0c3f35,0x3d8ebec9bf2dbf27
.quad 0xbf35bf0025403f00,0x3f353f0025e0bf00,0xbeabbf32bf0c2540,0x3d8e3f173f2d3e8b,0x3ec9be8bbf32bf00,0xbf32be8b3ec93f35,0x3f343ec9beabbf35,0xbe52bf32bee63e8b
.quad 0x3e8b3f353e8bbf00,0x3f272540bf27bf00,0xbee63ec93f2d25e0,0x3eab3f323d8ebf27,0xbf32be8b3f173f00,0xbf173e8b3f322540,0xbe52bf323d8e3f35,0xbee6bf173eab3f27
.quad 0x3f003f003f003f00,0x3f003f003f003f00,0xbf20bf17bf0cbf00,0xbf34bf32bf2dbf27,0xbe0dbe8bbec9bf00,0x3ec93e8b3e0da500,0x3f343f323f203f00,0x3e523ec93f0c3f27
.quad 0xbe8b25403e8b3f00,0xbf27bf35bf27bf00,0xbf0cbf32bf2dbf00,0x3f203ec93d8ebe8b,0x3f173e8bbe0dbf00,0xbe0d3e8b3f173f35,0x3e523f173f343f00,0xbee6bf32bf20be8b
.quad 0xbf35bf00a5a03f00,0x3f353f002540bf00,0x3e52bec9bf34bf00,0xbee63e0d3f203f27,0x3f173f273e0dbf00,0xbe0dbf27bf17a480,0xbf0c3e0d3f2d3f00,0x3f203f17bd8ebf27
.quad 0xbe8bbf35be8b3f00,0xbf27273c3f273f00,0x3f343e0dbf20bf00,0x3e52bf17bf0c3e8b,0xbe0d3f273ec9bf00,0x3ec93f27be0dbf35,0xbf20bec93f0c3f00,0xbf34be0d3f2d3e8b
.quad 0x3f003f003f003f00,0x3f003f003f003f00,0xbf2dbf32bf34bf35,0xbf0cbf17bf20bf27,0x3f323f273f173f00,0x3f173f273f323f35,0xbf0cbec9be522540,0xbf20bf32bf34bf27
.quad 0x3e8b25e0be8bbf00,0x3f273f353f273f00,0x3d8e3ec93f203f35,0xbf2dbf32bf0cbe8b,0xbec9bf27bf32bf00,0x3f323f273ec92540,0x3f203f323ee62540,0xbf34bf17be523e8b
.quad 0xbf35bf00a4803f00,0x3f353f000000bf00,0x3f203e0dbee6bf35,0xbf34bec93e523f27,0xbec93e8b3f323f00,0x3f323e8bbec9bf35,0x3d8ebf17bf202480,0xbf2dbe0d3f0c3f27
.quad 0x3e8b3f353e8bbf00,0x3f27a7c2bf27bf00,0xbf0cbf173e523f35,0xbf203e0d3f343e8b,0x3f323e8bbf17bf00,0x3f17be8bbf322754,0xbf2d3e0d3f34a5e0,0xbf0c3ec93f20be8b
.quad 0x3f003f003f003f00,0x3f003f003f003f00,0xbeabbec9bee6bf00,0xbd8ebe0dbe52be8b,0x3e0d3e8b3ec93f00,0xbec9be8bbe0d2540,0x3d8ebe0dbeabbf00,0x3f2d3f173ee63e8b
.quad 0xbe8ba5a03e8b3f00,0xbf27bf35bf27bf00,0x3ee63e0dbe52bf00,0x3eab3f173f343f27,0xbf17be8b3e0d3f00,0x3e0dbe8bbf17bf35,0x3f2d3ec9bd8ebf00,0xbf0cbe0d3eab3f27
.quad 0xbf35bf0024803f00,0x3f353f00a540bf00,0x3f2d3f173d8ebf00,0xbf0cbf32beab3e8b,0xbf17bf27be0d3f00,0x3e0d3f273f17a5e0,0x3ee63f323e52bf00,0x3eabbec9bf34be8b
.quad 0xbe8bbf35be8b3f00,0xbf2727643f273f00,0x3d8e3f323eabbf00,0x3f2d3ec9bee6bf27,0x3e0dbf27bec93f00,0xbec9bf273e0d3f35,0xbeab3f173ee6bf00,0xbd8e3f323e52bf27
.quad 0x3f003f003f003f00,0x3f003f003f003f00,0x3e523e0d3d8ea500,0x3ee63ec93eab3e8b,0xbf32bf27bf17bf00,0xbf17bf27bf32bf35,0x3ee63f173f2d3f35,0xbeabbe0d3d8e3e8b
.quad 0x3e8b2540be8bbf00,0x3f273f353f273f00,0xbf34bf17beaba480,0x3e52be0dbee6bf27,0x3ec93f273f323f00,0xbf32bf27bec9273c,0x3eabbe0dbf0cbf35,0xbd8e3ec93f2d3f27
.quad 0xbf35bf0027483f00,0x3f353f00a5e0bf00,0x3eab3f323f0ca5e0,0xbd8ebf17bf2dbe8b,0x3ec9be8bbf32bf00,0xbf32be8b3ec93f35,0xbf34bec93eab3f35,0x3e523f323ee6be8b
.quad 0x3e8b3f353e8bbf00,0x3f27a670bf27bf00,0x3ee6bec9bf2d276c,0xbeabbf32bd8e3f27,0xbf32be8b3f173f00,0xbf173e8b3f32a7da,0x3e523f32bd8ebf35,0x3ee63f17beabbf27
.quad 0x3f003f003f003f00,0x3f003f003f003f00,0x3f203f173f0c3f00,0x3f343f323f2d3f27,0xbe0dbe8bbec9bf00,0x3ec93e8b3e0d25e0,0xbf34bf32bf20bf00,0xbe52bec9bf0cbf27
.quad 0xbe8ba4803e8b3f00,0xbf27bf35bf27bf00,0x3f0c3f323f2d3f00,0xbf20bec9bd8e3e8b,0x3f173e8bbe0dbf00,0xbe0d3e8b3f173f35,0xbe52bf17bf34bf00,0x3ee63f323f203e8b
.quad 0xbf35bf0027543f00,0x3f353f00a610bf00,0xbe523ec93f343f00,0x3ee6be0dbf20bf27,0x3f173f273e0dbf00,0xbe0dbf27bf17a6f8,0x3f0cbe0dbf2dbf00,0xbf20bf173d8e3f27
.quad 0xbe8bbf35be8b3f00,0xbf2727823f273f00,0xbf34be0d3f203f00,0xbe523f173f0cbe8b,0xbe0d3f273ec9bf00,0x3ec93f27be0dbf35,0x3f203ec9bf0cbf00,0x3f343e0dbf2dbe8b
.quad 0x3f003f003f003f00,0x3f003f003f003f00,0x3f2d3f323f343f35,0x3f0c3f173f203f27,0x3f323f273f173f00,0x3f173f273f323f35,0x3f0c3ec93e522540,0x3f203f323f343f27
.quad 0x3e8b0000be8bbf00,0x3f273f353f273f00,0xbd8ebec9bf20bf35,0x3f2d3f323f0c3e8b,0xbec9bf27bf32bf00,0x3f323f273ec9a7c2,0xbf20bf32bee62754,0x3f343f173e52be8b
.quad 0xbf35bf0027643f00,0x3f353f00a650bf00,0xbf20be0d3ee63f35,0x3f343ec9be52bf27,0xbec93e8b3f323f00,0x3f323e8bbec9bf35,0xbd8e3f173f20a698,0x3f2d3e0dbf0cbf27
.quad 0x3e8b3f353e8bbf00,0x3f27a7e6bf27bf00,0x3f0c3f17be52bf35,0x3f20be0dbf34be8b,0x3f323e8bbf17bf00,0x3f17be8bbf322825,0x3f2dbe0dbf34a670,0x3f0cbec9bf203e8b
.quad 0x3f003f003f003f00,0x3f003f003f003f00,0x3f203f173f0c3f00,0x3f343f323f2d3f27,0x3f323f273f173f00,0x3f173f273f323f35,0x3f343f323f203f00,0x3e523ec93f0c3f27
.quad 0x3f273f353f273f00,0xbe8b24803e8b3f00,0x3f0c3f323f2d3f00,0xbf20bec9bd8e3e8b,0x3ec93f273f323f00,0xbf32bf27bec92480,0x3e523f173f343f00,0xbee6bf32bf20be8b
.quad 0x24803f003f353f00,0xa540bf00bf35bf00,0xbe523ec93f343f00,0x3ee6be0dbf20bf27,0xbec93e8b3f323f00,0x3f323e8bbec9bf35,0xbf0c3e0d3f2d3f00,0x3f203f17bd8ebf27
.quad 0xbf2724803f273f00,0x3e8b3f353e8bbf00,0xbf34be0d3f203f00,0xbe523f173f0cbe8b,0xbf32be8b3f173f00,0xbf173e8b3f32a540,0xbf20bec93f0c3f00,0xbf34be0d3f2d3e8b
.quad 0x3f003f003f003f00,0x3f003f003f003f00,0x3f2d3f323f343f35,0x3f0c3f173f203f27,0x3e0d3e8b3ec93f00,0xbec9be8bbe0d2480,0xbf0cbec9be522480,0xbf20bf32bf34bf27
.quad 0xbf27bf35bf27bf00,0x3e8ba540be8bbf00,0xbd8ebec9bf20bf35,0x3f2d3f323f0c3e8b,0x3f173e8bbe0dbf00,0xbe0d3e8b3f173f35,0x3f203f323ee6a540,0xbf34bf17be523e8b
.quad 0x26703f003f353f00,0xa688bf00bf35bf00,0xbf20be0d3ee63f35,0x3f343ec9be52bf27,0xbf17bf27be0d3f00,0x3e0d3f273f17a688,0x3d8ebf17bf202670,0xbf2dbe0d3f0c3f27
.quad 0x3f27a688bf27bf00,0xbe8bbf35be8b3f00,0x3f0c3f17be52bf35,0x3f20be0dbf34be8b,0xbe0d3f273ec9bf00,0x3ec93f27be0dbf35,0xbf2d3e0d3f34a688,0xbf0c3ec93f20be8b
.quad 0x3f003f003f003f00,0x3f003f003f003f00,0x3eab3ec93ee63f00,0x3d8e3e0d3e523e8b,0xbf32bf27bf17bf00,0xbf17bf27bf32bf35,0x3d8ebe0dbeabbf00,0x3f2d3f173ee63e8b
.quad 0x3f273f353f273f00,0xbe8b26703e8b3f00,0xbee6be0d3e523f00,0xbeabbf17bf34bf27,0xbec9bf27bf32bf00,0x3f323f273ec9a688,0x3f2d3ec9bd8ebf00,0xbf0cbe0d3eab3f27
.quad 0x26983f003f353f00,0xa6a8bf00bf35bf00,0xbf2dbf17bd8e3f00,0x3f0c3f323eabbe8b,0x3ec9be8bbf32bf00,0xbf32be8b3ec93f35,0x3ee63f323e52bf00,0x3eabbec9bf34be8b
.quad 0xbf2726a83f273f00,0x3e8b3f353e8bbf00,0xbd8ebf32beab3f00,0xbf2dbec93ee63f27,0x3f323e8bbf17bf00,0x3f17be8bbf3226c8,0xbeab3f173ee6bf00,0xbd8e3f323e52bf27
.quad 0x3f003f003f003f00,0x3f003f003f003f00,0xbe52be0dbd8e2480,0xbee6bec9beabbe8b,0xbe0dbe8bbec9bf00,0x3ec93e8b3e0da540,0x3ee63f173f2d3f35,0xbeabbe0d3d8e3e8b
.quad 0xbf27bf35bf27bf00,0x3e8ba688be8bbf00,0x3f343f173eaba688,0xbe523e0d3ee63f27,0xbf17be8b3e0d3f00,0x3e0dbe8bbf17bf35,0x3eabbe0dbf0cbf35,0xbd8e3ec93f2d3f27
.quad 0x26a83f003f353f00,0xa6b8bf00bf35bf00,0xbeabbf32bf0c26a8,0x3d8e3f173f2d3e8b,0x3f173f273e0dbf00,0xbe0dbf27bf1726c8,0xbf34bec93eab3f35,0x3e523f323ee6be8b
.quad 0x3f272698bf27bf00,0xbe8bbf35be8b3f00,0xbee63ec93f2da6d8,0x3eab3f323d8ebf27,0x3e0dbf27bec93f00,0xbec9bf273e0d3f35,0x3e523f32bd8ebf35,0x3ee63f17beabbf27
.quad 0x3f003f003f003f00,0x3f003f003f003f00,0xbf20bf17bf0cbf00,0xbf34bf32bf2dbf27,0x3f323f273f173f00,0x3f173f273f323f35,0xbf34bf32bf20bf00,0xbe52bec9bf0cbf27
.quad 0x3f273f353f273f00,0xbe8b26983e8b3f00,0xbf0cbf32bf2dbf00,0x3f203ec93d8ebe8b,0x3ec93f273f323f00,0xbf32bf27bec926a8,0xbe52bf17bf34bf00,0x3ee63f323f203e8b
.quad 0x26c83f003f353f00,0xa6d8bf00bf35bf00,0x3e52bec9bf34bf00,0xbee63e0d3f203f27,0xbec93e8b3f323f00,0x3f323e8bbec9bf35,0x3f0cbe0dbf2dbf00,0xbf20bf173d8e3f27
.quad 0xbf27a76c3f273f00,0x3e8b3f353e8bbf00,0x3f343e0dbf20bf00,0x3e52bf17bf0c3e8b,0xbf32be8b3f173f00,0xbf173e8b3f322610,0x3f203ec9bf0cbf00,0x3f343e0dbf2dbe8b
.quad 0x3f003f003f003f00,0x3f003f003f003f00,0xbf2dbf32bf34bf35,0xbf0cbf17bf20bf27,0x3e0d3e8b3ec93f00,0xbec9be8bbe0d2670,0x3f0c3ec93e52a688,0x3f203f323f343f27
.quad 0xbf27bf35bf27bf00,0x3e8ba6a8be8bbf00,0x3d8e3ec93f203f35,0xbf2dbf32bf0cbe8b,0x3f173e8bbe0dbf00,0xbe0d3e8b3f173f35,0xbf20bf32bee626c8,0x3f343f173e52be8b
.quad 0x26e03f003f353f00,0x2670bf00bf35bf00,0x3f203e0dbee6bf35,0xbf34bec93e523f27,0xbf17bf27be0d3f00,0x3e0d3f273f17a79c,0xbd8e3f173f202650,0x3f2d3e0dbf0cbf27
.quad 0x3f272610bf27bf00,0xbe8bbf35be8b3f00,0xbf0cbf173e523f35,0xbf203e0d3f343e8b,0xbe0d3f273ec9bf00,0x3ec93f27be0dbf35,0x3f2dbe0dbf342724,0x3f0cbec9bf203e8b
.quad 0x3f003f003f003f00,0x3f003f003f003f00,0xbeabbec9bee6bf00,0xbd8ebe0dbe52be8b,0xbf32bf27bf17bf00,0xbf17bf27bf32bf35,0xbd8e3e0d3eab3f00,0xbf2dbf17bee6be8b
.quad 0x3f273f353f273f00,0xbe8b26a83e8b3f00,0x3ee63e0dbe52bf00,0x3eab3f173f343f27,0xbec9bf27bf32bf00,0x3f323f273ec92698,0xbf2dbec93d8e3f00,0x3f0c3e0dbeabbf27
.quad 0x26f83f003f353f00,0x2650bf00bf35bf00,0x3f2d3f173d8ebf00,0xbf0cbf32beab3e8b,0x3ec9be8bbf32bf00,0xbf32be8b3ec93f35,0xbee6bf32be523f00,0xbeab3ec93f343e8b
.quad 0xbf2727243f273f00,0x3e8b3f353e8bbf00,0x3d8e3f323eabbf00,0x3f2d3ec9bee6bf27,0x3f323e8bbf17bf00,0x3f17be8bbf32a807,0x3eabbf17bee63f00,0x3d8ebf32be523f27
.quad 0x3f003f003f003f00,0x3f003f003f003f00,0x3e523e0d3d8ea540,0x3ee63ec93eab3e8b,0xbe0dbe8bbec9bf00,0x3ec93e8b3e0da688,0xbee6bf17bf2dbf35,0x3eab3e0dbd8ebe8b
.quad 0xbf27bf35bf27bf00,0x3e8ba6b8be8bbf00,0xbf34bf17beab26c8,0x3e52be0dbee6bf27,0xbf17be8b3e0d3f00,0x3e0dbe8bbf17bf35,0xbeab3e0d3f0c3f35,0x3d8ebec9bf2dbf27
.quad 0x270c3f003f353f00,0x2610bf00bf35bf00,0x3eab3f323f0c2610,0xbd8ebf17bf2dbe8b,0x3f173f273e0dbf00,0xbe0dbf27bf172724,0x3f343ec9beabbf35,0xbe52bf32bee63e8b
.quad 0x3f27a7b6bf27bf00,0xbe8bbf35be8b3f00,0x3ee6bec9bf2d273c,0xbeabbf32bd8e3f27,0x3e0dbf27bec93f00,0xbec9bf273e0d3f35,0xbe52bf323d8e3f35,0xbee6bf173eab3f27
.quad 0xbf00bf00bf00bf00,0xbf00bf00bf00bf00,0xbf20bf17bf0cbf00,0xbf34bf32bf2dbf27,0xbf32bf27bf17bf00,0xbf17bf27bf32bf35,0xbf34bf32bf20bf00,0xbe52bec9bf0cbf27
.quad 0xbf27bf35bf27bf00,0x3e8ba480be8bbf00,0xbf0cbf32bf2dbf00,0x3f203ec93d8ebe8b,0xbec9bf27bf32bf00,0x3f323f273ec9a480,0xbe52bf17bf34bf00,0x3ee63f323f203e8b
.quad 0xa480bf00bf35bf00,0x25403f003f353f00,0x3e52bec9bf34bf00,0xbee63e0d3f203f27,0x3ec9be8bbf32bf00,0xbf32be8b3ec93f35,0x3f0cbe0dbf2dbf00,0xbf20bf173d8e3f27
.quad 0x3f27a480bf27bf00,0xbe8bbf35be8b3f00,0x3f343e0dbf20bf00,0x3e52bf17bf0c3e8b,0x3f323e8bbf17bf00,0x3f17be8bbf322540,0x3f203ec9bf0cbf00,0x3f343e0dbf2dbe8b
.quad 0xbf00bf00bf00bf00,0xbf00bf00bf00bf00,0xbf2dbf32bf34bf35,0xbf0cbf17bf20bf27,0xbe0dbe8bbec9bf00,0x3ec93e8b3e0da480,0x3f0c3ec93e52a480,0x3f203f323f343f27
.quad 0x3f273f353f273f00,0xbe8b25403e8b3f00,0x3d8e3ec93f203f35,0xbf2dbf32bf0cbe8b,0xbf17be8b3e0d3f00,0x3e0dbe8bbf17bf35,0xbf20bf32bee62540,0x3f343f173e52be8b
.quad 0xa670bf00bf35bf00,0x26883f003f353f00,0x3f203e0dbee6bf35,0xbf34bec93e523f27,0x3f173f273e0dbf00,0xbe0dbf27bf172688,0xbd8e3f173f20a670,0x3f2d3e0dbf0cbf27
.quad 0xbf2726883f273f00,0x3e8b3f353e8bbf00,0xbf0cbf173e523f35,0xbf203e0d3f343e8b,0x3e0dbf27bec93f00,0xbec9bf273e0d3f35,0x3f2dbe0dbf342688,0x3f0cbec9bf203e8b
.quad 0xbf00bf00bf00bf00,0xbf00bf00bf00bf00,0xbeabbec9bee6bf00,0xbd8ebe0dbe52be8b,0x3f323f273f173f00,0x3f173f273f323f35,0xbd8e3e0d3eab3f00,0xbf2dbf17bee6be8b
.quad 0xbf27bf35bf27bf00,0x3e8ba670be8bbf00,0x3ee63e0dbe52bf00,0x3eab3f173f343f27,0x3ec93f273f323f00,0xbf32bf27bec92688,0xbf2dbec93d8e3f00,0x3f0c3e0dbeabbf27
.quad 0xa698bf00bf35bf00,0x26a83f003f353f00,0x3f2d3f173d8ebf00,0xbf0cbf32beab3e8b,0xbec93e8b3f323f00,0x3f323e8bbec9bf35,0xbee6bf32be523f00,0xbeab3ec93f343e8b
.quad 0x3f27a6a8bf27bf00,0xbe8bbf35be8b3f00,0x3d8e3f323eabbf00,0x3f2d3ec9bee6bf27,0xbf32be8b3f173f00,0xbf173e8b3f32a6c8,0x3eabbf17bee63f00,0x3d8ebf32be523f27
.quad 0xbf00bf00bf00bf00,0xbf00bf00bf00bf00,0x3e523e0d3d8ea480,0x3ee63ec93eab3e8b,0x3e0d3e8b3ec93f00,0xbec9be8bbe0d2540,0xbee6bf17bf2dbf35,0x3eab3e0dbd8ebe8b
.quad 0x3f273f353f273f00,0xbe8b26883e8b3f00,0xbf34bf17beab2688,0x3e52be0dbee6bf27,0x3f173e8bbe0dbf00,0xbe0d3e8b3f173f35,0xbeab3e0d3f0c3f35,0x3d8ebec9bf2dbf27
.quad 0xa6a8bf00bf35bf00,0x26b83f003f353f00,0x3eab3f323f0ca6a8,0xbd8ebf17bf2dbe8b,0xbf17bf27be0d3f00,0x3e0d3f273f17a6c8,0x3f343ec9beabbf35,0xbe52bf32bee63e8b
.quad 0xbf27a6983f273f00,0x3e8b3f353e8bbf00,0x3ee6bec9bf2d26d8,0xbeabbf32bd8e3f27,0xbe0d3f273ec9bf00,0x3ec93f27be0dbf35,0xbe52bf323d8e3f35,0xbee6bf173eab3f27
.quad 0xbf00bf00bf00bf00,0xbf00bf00bf00bf00,0x3f203f173f0c3f00,0x3f343f323f2d3f27,0xbf32bf27bf17bf00,0xbf17bf27bf32bf35,0x3f343f323f203f00,0x3e523ec93f0c3f27
.quad 0xbf27bf35bf27bf00,0x3e8ba698be8bbf00,0x3f0c3f323f2d3f00,0xbf20bec9bd8e3e8b,0xbec9bf27bf32bf00,0x3f323f273ec9a6a8,0x3e523f173f343f00,0xbee6bf32bf20be8b
.quad 0xa6c8bf00bf35bf00,0x26d83f003f353f00,0xbe523ec93f343f00,0x3ee6be0dbf20bf27,0x3ec9be8bbf32bf00,0xbf32be8b3ec93f35,0xbf0c3e0d3f2d3f00,0x3f203f17bd8ebf27
.quad 0x3f27276cbf27bf00,0xbe8bbf35be8b3f00,0xbf34be0d3f203f00,0xbe523f173f0cbe8b,0x3f323e8bbf17bf00,0x3f17be8bbf32a610,0xbf20bec93f0c3f00,0xbf34be0d3f2d3e8b
.quad 0xbf00bf00bf00bf00,0xbf00bf00bf00bf00,0x3f2d3f323f343f35,0x3f0c3f173f203f27,0xbe0dbe8bbec9bf00,0x3ec93e8b3e0da670,0xbf0cbec9be522688,0xbf20bf32bf34bf27
.quad 0x3f273f353f273f00,0xbe8b26a83e8b3f00,0xbd8ebec9bf20bf35,0x3f2d3f323f0c3e8b,0xbf17be8b3e0d3f00,0x3e0dbe8bbf17bf35,0x3f203f323ee6a6c8,0xbf34bf17be523e8b
.quad 0xa6e0bf00bf35bf00,0xa6703f003f353f00,0xbf20be0d3ee63f35,0x3f343ec9be52bf27,0x3f173f273e0dbf00,0xbe0dbf27bf17279c,0x3d8ebf17bf20a650,0xbf2dbe0d3f0c3f27
.quad 0xbf27a6103f273f00,0x3e8b3f353e8bbf00,0x3f0c3f17be52bf35,0x3f20be0dbf34be8b,0x3e0dbf27bec93f00,0xbec9bf273e0d3f35,0xbf2d3e0d3f34a724,0xbf0c3ec93f20be8b
.quad 0xbf00bf00bf00bf00,0xbf00bf00bf00bf00,0x3eab3ec93ee63f00,0x3d8e3e0d3e523e8b,0x3f323f273f173f00,0x3f173f273f323f35,0x3d8ebe0dbeabbf00,0x3f2d3f173ee63e8b
.quad 0xbf27bf35bf27bf00,0x3e8ba6a8be8bbf00,0xbee6be0d3e523f00,0xbeabbf17bf34bf27,0x3ec93f273f323f00,0xbf32bf27bec9a698,0x3f2d3ec9bd8ebf00,0xbf0cbe0d3eab3f27
.quad 0xa6f8bf00bf35bf00,0xa6503f003f353f00,0xbf2dbf17bd8e3f00,0x3f0c3f323eabbe8b,0xbec93e8b3f323f00,0x3f323e8bbec9bf35,0x3ee63f323e52bf00,0x3eabbec9bf34be8b
.quad 0x3f27a724bf27bf00,0xbe8bbf35be8b3f00,0xbd8ebf32beab3f00,0xbf2dbec93ee63f27,0xbf32be8b3f173f00,0xbf173e8b3f322807,0xbeab3f173ee6bf00,0xbd8e3f323e52bf27
.quad 0xbf00bf00bf00bf00,0xbf00bf00bf00bf00,0xbe52be0dbd8e2540,0xbee6bec9beabbe8b,0x3e0d3e8b3ec93f00,0xbec9be8bbe0d2688,0x3ee63f173f2d3f35,0xbeabbe0d3d8e3e8b
.quad 0x3f273f353f273f00,0xbe8b26b83e8b3f00,0x3f343f173eaba6c8,0xbe523e0d3ee63f27,0x3f173e8bbe0dbf00,0xbe0d3e8b3f173f35,0x3eabbe0dbf0cbf35,0xbd8e3ec93f2d3f27
.quad 0xa70cbf00bf35bf00,0xa6103f003f353f00,0xbeabbf32bf0ca610,0x3d8e3f173f2d3e8b,0xbf17bf27be0d3f00,0x3e0d3f273f17a724,0xbf34bec93eab3f35,0x3e523f323ee6be8b
.quad 0xbf2727b63f273f00,0x3e8b3f353e8bbf00,0xbee63ec93f2da73c,0x3eab3f323d8ebf27,0xbe0d3f273ec9bf00,0x3ec93f27be0dbf35,0x3e523f32bd8ebf35,0x3ee63f17beabbf27
.quad 0x3f00bf00bf003f00,0x3f00bf00bf003f00,0x3f20bec9bf0c3f00,0x3f34be0dbf2d3e8b,0x3f32be8bbf173f00,0x3f173e8bbf322540,0x3f34be0dbf203f00,0x3e523f17bf0cbe8b
.quad 0x3f27a500bf273f00,0xbe8b3f35be8bbf00,0x3f0c3e0dbf2d3f00,0xbf203f173d8ebf27,0x3ec93e8bbf323f00,0xbf323e8b3ec9bf35,0x3e523ec9bf343f00,0xbee6be0d3f20bf27
.quad 0x25403f00bf353f00,0x2540bf003f35bf00,0xbe523f17bf343f00,0x3ee6bf323f20be8b,0xbec93f27bf323f00,0x3f32bf273ec925e0,0xbf0c3f32bf2d3f00,0x3f20bec93d8e3e8b
.quad 0xbf273f35bf273f00,0x3e8b2540be8b3f00,0xbf343f32bf203f00,0xbe523ec9bf0c3f27,0xbf323f27bf173f00,0xbf173f27bf323f35,0xbf203f17bf0c3f00,0xbf343f32bf2d3f27
.quad 0x3f00bf00bf003f00,0x3f00bf00bf003f00,0x3f2d3e0dbf34a5a0,0x3f0c3ec9bf20be8b,0x3e0d3f27bec9bf00,0xbec93f273e0dbf35,0xbf0c3f173e52bf35,0xbf20be0d3f34be8b
.quad 0xbf27a4803f27bf00,0x3e8bbf353e8b3f00,0xbd8ebf173f202540,0x3f2dbe0dbf0c3f27,0x3f17bf273e0d3f00,0xbe0d3f27bf172480,0x3f20be0dbee63f35,0xbf343ec93e52bf27
.quad 0x273c3f00bf353f00,0xa7c2bf003f35bf00,0xbf203f32bee6a480,0x3f34bf173e523e8b,0xbf173e8b3e0dbf00,0x3e0d3e8bbf173f35,0x3d8ebec93f20bf35,0xbf2d3f32bf0c3e8b
.quad 0x3f27bf353f27bf00,0xbe8b27543e8bbf00,0x3f0cbec93e520000,0x3f20bf323f34bf27,0xbe0d3e8bbec93f00,0x3ec9be8b3e0da5e0,0xbf2d3f32bf343f35,0xbf0c3f17bf203f27
.quad 0x3f00bf00bf003f00,0x3f00bf00bf003f00,0x3eab3f17bee6bf00,0x3d8e3f32be52bf27,0xbf323e8b3f17bf00,0xbf17be8b3f32a5e0,0x3d8ebf323eab3f00,0x3f2dbec9bee63f27
.quad 0x3f27a5e0bf273f00,0xbe8b3f35be8bbf00,0xbee63f32be52bf00,0xbeabbec93f34be8b,0xbec9be8b3f32bf00,0x3f32be8bbec93f35,0x3f2dbf173d8e3f00,0xbf0c3f32beabbe8b
.quad 0x27643f00bf353f00,0xa670bf003f35bf00,0xbf2d3ec93d8ebf00,0x3f0cbe0dbeab3f27,0x3ec9bf273f32bf00,0xbf323f27bec9276c,0x3ee6be0dbe523f00,0x3eabbf173f34bf27
.quad 0xbf273f35bf273f00,0x3e8ba7dabe8b3f00,0xbd8ebe0d3eabbf00,0xbf2d3f17bee63e8b,0x3f32bf273f17bf00,0x3f17bf273f32bf35,0xbeab3ec9bee63f00,0xbd8e3e0dbe523e8b
.quad 0x3f00bf00bf003f00,0x3f00bf00bf003f00,0xbe523f323d8ebf35,0xbee63f173eabbf27,0xbe0dbf273ec93f00,0x3ec9bf27be0d3f35,0x3ee63ec9bf2d2764,0xbeab3f32bd8ebf27
.quad 0xbf27a6f83f27bf00,0x3e8bbf353e8b3f00,0x3f34bec9beab3f35,0xbe523f32bee6be8b,0xbf173f27be0dbf00,0x3e0dbf273f17a698,0x3eabbf323f0ca670,0xbd8e3f17bf2d3e8b
.quad 0x27823f00bf353f00,0xa7e6bf003f35bf00,0xbeabbe0d3f0cbf35,0x3d8e3ec9bf2d3f27,0x3f17be8bbe0d3f00,0xbe0dbe8b3f17bf35,0xbf343f17beab2782,0x3e523e0dbee63f27
.quad 0x3f27bf353f27bf00,0xbe8b28253e8bbf00,0xbee63f17bf2d3f35,0x3eabbe0dbd8e3e8b,0x3e0dbe8b3ec9bf00,0xbec93e8bbe0da670,0x3e52be0d3d8ea7e6,0x3ee6bec93eabbe8b
.quad 0x3f00bf00bf003f00,0x3f00bf00bf003f00,0xbf203ec93f0cbf00,0xbf343e0d3f2dbe8b,0x3f32be8bbf173f00,0x3f173e8bbf322782,0xbf343e0d3f20bf00,0xbe52bf173f0c3e8b
.quad 0x3f27a6a8bf273f00,0xbe8b3f35be8bbf00,0xbf0cbe0d3f2dbf00,0x3f20bf17bd8e3f27,0x3ec93e8bbf323f00,0xbf323e8b3ec9bf35,0xbe52bec93f34bf00,0x3ee63e0dbf203f27
.quad 0xa6703f00bf353f00,0xa70cbf003f35bf00,0x3e52bf173f34bf00,0xbee63f32bf203e8b,0xbec93f27bf323f00,0x3f32bf273ec9a70c,0x3f0cbf323f2dbf00,0xbf203ec9bd8ebe8b
.quad 0xbf273f35bf273f00,0x3e8ba85dbe8b3f00,0x3f34bf323f20bf00,0x3e52bec93f0cbf27,0xbf323f27bf173f00,0xbf173f27bf323f35,0x3f20bf173f0cbf00,0x3f34bf323f2dbf27
.quad 0x3f00bf00bf003f00,0x3f00bf00bf003f00,0xbf2dbe0d3f34a6a8,0xbf0cbec93f203e8b,0x3e0d3f27bec9bf00,0xbec93f273e0dbf35,0x3f0cbf17be523f35,0x3f203e0dbf343e8b
.quad 0xbf27a6703f27bf00,0x3e8bbf353e8b3f00,0x3d8e3f17bf20a670,0xbf2d3e0d3f0cbf27,0x3f17bf273e0d3f00,0xbe0d3f27bf17282b,0xbf203e0d3ee6bf35,0x3f34bec9be523f27
.quad 0x27aa3f00bf353f00,0x273cbf003f35bf00,0x3f20bf323ee6a800,0xbf343f17be52be8b,0xbf173e8b3e0dbf00,0x3e0d3e8bbf173f35,0xbd8e3ec9bf203f35,0x3f2dbf323f0cbe8b
.quad 0x3f27bf353f27bf00,0xbe8b27c23e8bbf00,0xbf0c3ec9be5227b6,0xbf203f32bf343f27,0xbe0d3e8bbec93f00,0x3ec9be8b3e0da86a,0x3f2dbf323f34bf35,0x3f0cbf173f20bf27
.quad 0x3f00bf00bf003f00,0x3f00bf00bf003f00,0xbeabbf173ee63f00,0xbd8ebf323e523f27,0xbf323e8b3f17bf00,0xbf17be8b3f32a70c,0xbd8e3f32beabbf00,0xbf2d3ec93ee6bf27
.quad 0x3f272754bf273f00,0xbe8b3f35be8bbf00,0x3ee6bf323e523f00,0x3eab3ec9bf343e8b,0xbec9be8b3f32bf00,0x3f32be8bbec93f35,0xbf2d3f17bd8ebf00,0x3f0cbf323eab3e8b
.quad 0x28383f00bf353f00,0x2800bf003f35bf00,0x3f2dbec9bd8e3f00,0xbf0c3e0d3eabbf27,0x3ec9bf273f32bf00,0xbf323f27bec92610,0xbee63e0d3e52bf00,0xbeab3f17bf343f27
.quad 0xbf273f35bf273f00,0x3e8ba8a7be8b3f00,0x3d8e3e0dbeab3f00,0x3f2dbf173ee6be8b,0x3f32bf273f17bf00,0x3f17bf273f32bf35,0x3eabbec93ee6bf00,0x3d8ebe0d3e52be8b
.quad 0x3f00bf00bf003f00,0x3f00bf00bf003f00,0x3e52bf32bd8e3f35,0x3ee6bf17beab3f27,0xbe0dbf273ec93f00,0x3ec9bf27be0d3f35,0xbee6bec93f2da724,0x3eabbf323d8e3f27
.quad 0xbf27a7b63f27bf00,0x3e8bbf353e8b3f00,0xbf343ec93eabbf35,0x3e52bf323ee63e8b,0xbf173f27be0dbf00,0x3e0dbf273f17a86a,0xbeab3f32bf0c27c2,0x3d8ebf173f2dbe8b
.quad 0xa79c3f00bf353f00,0x26e0bf003f35bf00,0x3eab3e0dbf0c3f35,0xbd8ebec93f2dbf27,0x3f17be8bbe0d3f00,0xbe0dbe8b3f17bf35,0x3f34bf173eab26e0,0xbe52be0d3ee6bf27
.quad 0x3f27bf353f27bf00,0xbe8b28513e8bbf00,0x3ee6bf173f2dbf35,0xbeab3e0d3d8ebe8b,0x3e0dbe8b3ec9bf00,0xbec93e8bbe0d27f2,0xbe523e0dbd8e2851,0xbee63ec9beab3e8b
.quad 0xbf00bf003f003f00,0xbf00bf003f003f00,0xbeabbf173ee63f00,0xbd8ebf323e523f27,0xbe0dbf273ec93f00,0x3ec9bf27be0d3f35,0x3d8ebf323eab3f00,0x3f2dbec9bee63f27
.quad 0x3e8bbf353e8b3f00,0x3f27a688bf273f00,0x3ee6bf323e523f00,0x3eab3ec9bf343e8b,0x3f17bf273e0d3f00,0xbe0d3f27bf172670,0x3f2dbf173d8e3f00,0xbf0c3f32beabbe8b
.quad 0x3f35bf0024803f00,0xbf353f00a688bf00,0x3f2dbec9bd8e3f00,0xbf0c3e0d3eabbf27,0x3f17be8bbe0d3f00,0xbe0dbe8b3f17bf35,0x3ee6be0dbe523f00,0x3eabbf173f34bf27
.quad 0x3e8ba540be8b3f00,0x3f27bf353f27bf00,0x3d8e3e0dbeab3f00,0x3f2dbf173ee6be8b,0xbe0d3e8bbec93f00,0x3ec9be8b3e0da688,0xbeab3ec9bee63f00,0xbd8e3e0dbe523e8b
.quad 0xbf00bf003f003f00,0xbf00bf003f003f00,0x3e52bf32bd8e3f35,0x3ee6bf17beab3f27,0x3f32be8bbf173f00,0x3f173e8bbf3226a8,0x3ee63ec9bf2d2698,0xbeab3f32bd8ebf27
.quad 0xbe8b3f35be8bbf00,0xbf2726c83f27bf00,0xbf343ec93eabbf35,0x3e52bf323ee63e8b,0xbec9be8b3f32bf00,0x3f32be8bbec93f35,0x3eabbf323f0ca6a8,0xbd8e3f17bf2d3e8b
.quad 0x3f35bf0026a83f00,0xbf353f002698bf00,0x3eab3e0dbf0c3f35,0xbd8ebec93f2dbf27,0xbec93f27bf323f00,0x3f32bf273ec9a6d8,0xbf343f17beab26a8,0x3e523e0dbee63f27
.quad 0xbe8b26c83e8bbf00,0xbf273f35bf273f00,0x3ee6bf173f2dbf35,0xbeab3e0d3d8ebe8b,0x3f32bf273f17bf00,0x3f17bf273f32bf35,0x3e52be0d3d8ea6b8,0x3ee6bec93eabbe8b
.quad 0xbf00bf003f003f00,0xbf00bf003f003f00,0x3f20bec9bf0c3f00,0x3f34be0dbf2d3e8b,0x3e0d3f27bec9bf00,0xbec93f273e0dbf35,0xbf343e0d3f20bf00,0xbe52bf173f0c3e8b
.quad 0x3e8bbf353e8b3f00,0x3f27a79cbf273f00,0x3f0c3e0dbf2d3f00,0xbf203f173d8ebf27,0xbf173f27be0dbf00,0x3e0dbf273f172650,0xbe52bec93f34bf00,0x3ee63e0dbf203f27
.quad 0x3f35bf00a76c3f00,0xbf353f002610bf00,0xbe523f17bf343f00,0x3ee6bf323f20be8b,0xbf173e8b3e0dbf00,0x3e0d3e8bbf173f35,0x3f0cbf323f2dbf00,0xbf203ec9bd8ebe8b
.quad 0x3e8b2610be8b3f00,0x3f27bf353f27bf00,0xbf343f32bf203f00,0xbe523ec9bf0c3f27,0x3e0dbe8b3ec9bf00,0xbec93e8bbe0d2724,0x3f20bf173f0cbf00,0x3f34bf323f2dbf27
.quad 0xbf00bf003f003f00,0xbf00bf003f003f00,0x3f2d3e0dbf3426f8,0x3f0c3ec9bf20be8b,0xbf323e8b3f17bf00,0xbf17be8b3f322610,0x3f0cbf17be523f35,0x3f203e0dbf343e8b
.quad 0xbe8b3f35be8bbf00,0xbf2727243f27bf00,0xbd8ebf173f202610,0x3f2dbe0dbf0c3f27,0x3ec93e8bbf323f00,0xbf323e8b3ec9bf35,0xbf203e0d3ee6bf35,0x3f34bec9be523f27
.quad 0x3f35bf0027243f00,0xbf353f00a7b6bf00,0xbf203f32bee62724,0x3f34bf173e523e8b,0x3ec9bf273f32bf00,0xbf323f27bec9273c,0xbd8e3ec9bf203f35,0x3f2dbf323f0cbe8b
.quad 0xbe8ba8073e8bbf00,0xbf273f35bf273f00,0x3f0cbec93e52a7b6,0x3f20bf323f34bf27,0xbf323f27bf173f00,0xbf173f27bf323f35,0x3f2dbf323f34bf35,0x3f0cbf173f20bf27
.quad 0xbf00bf003f003f00,0xbf00bf003f003f00,0x3eab3f17bee6bf00,0x3d8e3f32be52bf27,0xbe0dbf273ec93f00,0x3ec9bf27be0d3f35,0xbd8e3f32beabbf00,0xbf2d3ec93ee6bf27
.quad 0x3e8bbf353e8b3f00,0x3f27a540bf273f00,0xbee63f32be52bf00,0xbeabbec93f34be8b,0x3f17bf273e0d3f00,0xbe0d3f27bf17a724,0xbf2d3f17bd8ebf00,0x3f0cbf323eab3e8b
.quad 0x3f35bf00a7243f00,0xbf353f00a610bf00,0xbf2d3ec93d8ebf00,0x3f0cbe0dbeab3f27,0x3f17be8bbe0d3f00,0xbe0dbe8b3f17bf35,0xbee63e0d3e52bf00,0xbeab3f17bf343f27
.quad 0x3e8b279cbe8b3f00,0x3f27bf353f27bf00,0xbd8ebe0d3eabbf00,0xbf2d3f17bee63e8b,0xbe0d3e8bbec93f00,0x3ec9be8b3e0da7da,0x3eabbec93ee6bf00,0x3d8ebe0d3e52be8b
.quad 0xbf00bf003f003f00,0xbf00bf003f003f00,0xbe523f323d8ebf35,0xbee63f173eabbf27,0x3f32be8bbf173f00,0x3f173e8bbf32280d,0xbee6bec93f2da540,0x3eabbf323d8e3f27
.quad 0xbe8b3f35be8bbf00,0xbf2728133f27bf00,0x3f34bec9beab3f35,0xbe523f32bee6be8b,0xbec9be8b3f32bf00,0x3f32be8bbec93f35,0xbeab3f32bf0ca70c,0x3d8ebf173f2dbe8b
.quad 0x3f35bf0028713f00,0xbf353f00278ebf00,0xbeabbe0d3f0cbf35,0x3d8e3ec9bf2d3f27,0xbec93f27bf323f00,0x3f32bf273ec9a84b,0x3f34bf173eaba7da,0xbe52be0d3ee6bf27
.quad 0xbe8ba6a83e8bbf00,0xbf273f35bf273f00,0xbee63f17bf2d3f35,0x3eabbe0dbd8e3e8b,0x3f32bf273f17bf00,0x3f17bf273f32bf35,0xbe523e0dbd8e278e,0xbee63ec9beab3e8b
.quad 0xbf00bf003f003f00,0xbf00bf003f003f00,0xbf203ec93f0cbf00,0xbf343e0d3f2dbe8b,0x3e0d3f27bec9bf00,0xbec93f273e0dbf35,0x3f34be0dbf203f00,0x3e523f17bf0cbe8b
.quad 0x3e8bbf353e8b3f00,0x3f27a7dabf273f00,0xbf0cbe0d3f2dbf00,0x3f20bf17bd8e3f27,0xbf173f27be0dbf00,0x3e0dbf273f17281f,0x3e523ec9bf343f00,0xbee6be0d3f20bf27
.quad 0x3f35bf00281f3f00,0xbf353f00a6e0bf00,0x3e52bf173f34bf00,0xbee63f32bf203e8b,0xbf173e8b3e0dbf00,0x3e0d3e8bbf173f35,0xbf0c3f32bf2d3f00,0x3f20bec93d8e3e8b
.quad 0x3e8b2813be8b3f00,0x3f27bf353f27bf00,0x3f34bf323f20bf00,0x3e52bec93f0cbf27,0x3e0dbe8b3ec9bf00,0xbec93e8bbe0da839,0xbf203f17bf0c3f00,0xbf343f32bf2d3f27
.quad 0xbf00bf003f003f00,0xbf00bf003f003f00,0xbf2dbe0d3f34a7ce,0xbf0cbec93f203e8b,0xbf323e8b3f17bf00,0xbf17be8b3f32a7da,0xbf0c3f173e52bf35,0xbf20be0d3f34be8b
.quad 0xbe8b3f35be8bbf00,0xbf27278e3f27bf00,0x3d8e3f17bf20a6a8,0xbf2d3e0d3f0cbf27,0x3ec93e8bbf323f00,0xbf323e8b3ec9bf35,0x3f20be0dbee63f35,0xbf343ec93e52bf27
.quad 0x3f35bf00279c3f00,0xbf353f00a800bf00,0x3f20bf323ee6a857,0xbf343f17be52be8b,0x3ec9bf273f32bf00,0xbf323f27bec92832,0x3d8ebec93f20bf35,0xbf2d3f32bf0c3e8b
.quad 0xbe8b27b63e8bbf00,0xbf273f35bf273f00,0xbf0c3ec9be5227b6,0xbf203f32bf343f27,0xbf323f27bf173f00,0xbf173f27bf323f35,0xbf2d3f32bf343f35,0xbf0c3f17bf203f27
.quad 0x3f003f00bf00bf00,0x3f003f00bf00bf00,0x3eab3f17bee6bf00,0x3d8e3f32be52bf27,0x3e0d3f27bec9bf00,0xbec93f273e0dbf35,0xbd8e3f32beabbf00,0xbf2d3ec93ee6bf27
.quad 0xbe8b3f35be8bbf00,0xbf2726883f27bf00,0xbee63f32be52bf00,0xbeabbec93f34be8b,0xbf173f27be0dbf00,0x3e0dbf273f17a670,0xbf2d3f17bd8ebf00,0x3f0cbf323eab3e8b
.quad 0xbf353f00a480bf00,0x3f35bf0026883f00,0xbf2d3ec93d8ebf00,0x3f0cbe0dbeab3f27,0xbf173e8b3e0dbf00,0x3e0d3e8bbf173f35,0xbee63e0d3e52bf00,0xbeab3f17bf343f27
.quad 0xbe8b25403e8bbf00,0xbf273f35bf273f00,0xbd8ebe0d3eabbf00,0xbf2d3f17bee63e8b,0x3e0dbe8b3ec9bf00,0xbec93e8bbe0d2688,0x3eabbec93ee6bf00,0x3d8ebe0d3e52be8b
.quad 0x3f003f00bf00bf00,0x3f003f00bf00bf00,0xbe523f323d8ebf35,0xbee63f173eabbf27,0xbf323e8b3f17bf00,0xbf17be8b3f32a6a8,0xbee6bec93f2da698,0x3eabbf323d8e3f27
.quad 0x3e8bbf353e8b3f00,0x3f27a6c8bf273f00,0x3f34bec9beab3f35,0xbe523f32bee6be8b,0x3ec93e8bbf323f00,0xbf323e8b3ec9bf35,0xbeab3f32bf0c26a8,0x3d8ebf173f2dbe8b
.quad 0xbf353f00a6a8bf00,0x3f35bf00a6983f00,0xbeabbe0d3f0cbf35,0x3d8e3ec9bf2d3f27,0x3ec9bf273f32bf00,0xbf323f27bec926d8,0x3f34bf173eaba6a8,0xbe52be0d3ee6bf27
.quad 0x3e8ba6c8be8b3f00,0x3f27bf353f27bf00,0xbee63f17bf2d3f35,0x3eabbe0dbd8e3e8b,0xbf323f27bf173f00,0xbf173f27bf323f35,0xbe523e0dbd8e26b8,0xbee63ec9beab3e8b
.quad 0x3f003f00bf00bf00,0x3f003f00bf00bf00,0xbf203ec93f0cbf00,0xbf343e0d3f2dbe8b,0xbe0dbf273ec93f00,0x3ec9bf27be0d3f35,0x3f34be0dbf203f00,0x3e523f17bf0cbe8b
.quad 0xbe8b3f35be8bbf00,0xbf27279c3f27bf00,0xbf0cbe0d3f2dbf00,0x3f20bf17bd8e3f27,0x3f17bf273e0d3f00,0xbe0d3f27bf17a650,0x3e523ec9bf343f00,0xbee6be0d3f20bf27
.quad 0xbf353f00276cbf00,0x3f35bf00a6103f00,0x3e52bf173f34bf00,0xbee63f32bf203e8b,0x3f17be8bbe0d3f00,0xbe0dbe8b3f17bf35,0xbf0c3f32bf2d3f00,0x3f20bec93d8e3e8b
.quad 0xbe8ba6103e8bbf00,0xbf273f35bf273f00,0x3f34bf323f20bf00,0x3e52bec93f0cbf27,0xbe0d3e8bbec93f00,0x3ec9be8b3e0da724,0xbf203f17bf0c3f00,0xbf343f32bf2d3f27
.quad 0x3f003f00bf00bf00,0x3f003f00bf00bf00,0xbf2dbe0d3f34a6f8,0xbf0cbec93f203e8b,0x3f32be8bbf173f00,0x3f173e8bbf32a610,0xbf0c3f173e52bf35,0xbf20be0d3f34be8b
.quad 0x3e8bbf353e8b3f00,0x3f27a724bf273f00,0x3d8e3f17bf20a610,0xbf2d3e0d3f0cbf27,0xbec9be8b3f32bf00,0x3f32be8bbec93f35,0x3f20be0dbee63f35,0xbf343ec93e52bf27
.quad 0xbf353f00a724bf00,0x3f35bf0027b63f00,0x3f20bf323ee6a724,0xbf343f17be52be8b,0xbec93f27bf323f00,0x3f32bf273ec9a73c,0x3d8ebec93f20bf35,0xbf2d3f32bf0c3e8b
.quad 0x3e8b2807be8b3f00,0x3f27bf353f27bf00,0xbf0c3ec9be5227b6,0xbf203f32bf343f27,0x3f32bf273f17bf00,0x3f17bf273f32bf35,0xbf2d3f32bf343f35,0xbf0c3f17bf203f27
.quad 0x3f003f00bf00bf00,0x3f003f00bf00bf00,0xbeabbf173ee63f00,0xbd8ebf323e523f27,0x3e0d3f27bec9bf00,0xbec93f273e0dbf35,0x3d8ebf323eab3f00,0x3f2dbec9bee63f27
.quad 0xbe8b3f35be8bbf00,0xbf2725403f27bf00,0x3ee6bf323e523f00,0x3eab3ec9bf343e8b,0xbf173f27be0dbf00,0x3e0dbf273f172724,0x3f2dbf173d8e3f00,0xbf0c3f32beabbe8b
.quad 0xbf353f002724bf00,0x3f35bf0026103f00,0x3f2dbec9bd8e3f00,0xbf0c3e0d3eabbf27,0xbf173e8b3e0dbf00,0x3e0d3e8bbf173f35,0x3ee6be0dbe523f00,0x3eabbf173f34bf27
.quad 0xbe8ba79c3e8bbf00,0xbf273f35bf273f00,0x3d8e3e0dbeab3f00,0x3f2dbf173ee6be8b,0x3e0dbe8b3ec9bf00,0xbec93e8bbe0d27da,0xbeab3ec9bee63f00,0xbd8e3e0dbe523e8b
.quad 0x3f003f00bf00bf00,0x3f003f00bf00bf00,0x3e52bf32bd8e3f35,0x3ee6bf17beab3f27,0xbf323e8b3f17bf00,0xbf17be8b3f32a80d,0x3ee63ec9bf2d2540,0xbeab3f32bd8ebf27
.quad 0x3e8bbf353e8b3f00,0x3f27a813bf273f00,0xbf343ec93eabbf35,0x3e52bf323ee63e8b,0x3ec93e8bbf323f00,0xbf323e8b3ec9bf35,0x3eabbf323f0c270c,0xbd8e3f17bf2d3e8b
.quad 0xbf353f00a871bf00,0x3f35bf00a78e3f00,0x3eab3e0dbf0c3f35,0xbd8ebec93f2dbf27,0x3ec9bf273f32bf00,0xbf323f27bec9284b,0xbf343f17beab27da,0x3e523e0dbee63f27
.quad 0x3e8b26a8be8b3f00,0x3f27bf353f27bf00,0x3ee6bf173f2dbf35,0xbeab3e0d3d8ebe8b,0xbf323f27bf173f00,0xbf173f27bf323f35,0x3e52be0d3d8ea78e,0x3ee6bec93eabbe8b
.quad 0x3f003f00bf00bf00,0x3f003f00bf00bf00,0x3f20bec9bf0c3f00,0x3f34be0dbf2d3e8b,0xbe0dbf273ec93f00,0x3ec9bf27be0d3f35,0xbf343e0d3f20bf00,0xbe52bf173f0c3e8b
.quad 0xbe8b3f35be8bbf00,0xbf2727da3f27bf00,0x3f0c3e0dbf2d3f00,0xbf203f173d8ebf27,0x3f17bf273e0d3f00,0xbe0d3f27bf17a81f,0xbe52bec93f34bf00,0x3ee63e0dbf203f27
.quad 0xbf353f00a81fbf00,0x3f35bf0026e03f00,0xbe523f17bf343f00,0x3ee6bf323f20be8b,0x3f17be8bbe0d3f00,0xbe0dbe8b3f17bf35,0x3f0cbf323f2dbf00,0xbf203ec9bd8ebe8b
.quad 0xbe8ba8133e8bbf00,0xbf273f35bf273f00,0xbf343f32bf203f00,0xbe523ec9bf0c3f27,0xbe0d3e8bbec93f00,0x3ec9be8b3e0d2839,0x3f20bf173f0cbf00,0x3f34bf323f2dbf27
.quad 0x3f003f00bf00bf00,0x3f003f00bf00bf00,0x3f2d3e0dbf3427ce,0x3f0c3ec9bf20be8b,0x3f32be8bbf173f00,0x3f173e8bbf3227da,0x3f0cbf17be523f35,0x3f203e0dbf343e8b
.quad 0x3e8bbf353e8b3f00,0x3f27a78ebf273f00,0xbd8ebf173f2026a8,0x3f2dbe0dbf0c3f27,0xbec9be8b3f32bf00,0x3f32be8bbec93f35,0xbf203e0d3ee6bf35,0x3f34bec9be523f27
.quad 0xbf353f00a79cbf00,0x3f35bf0028003f00,0xbf203f32bee62857,0x3f34bf173e523e8b,0xbec93f27bf323f00,0x3f32bf273ec9a832,0xbd8e3ec9bf203f35,0x3f2dbf323f0cbe8b
.quad 0x3e8ba7b6be8b3f00,0x3f27bf353f27bf00,0x3f0cbec93e52a7b6,0x3f20bf323f34bf27,0x3f32bf273f17bf00,0x3f17bf273f32bf35,0x3f2dbf323f34bf35,0x3f0cbf173f20bf27
.quad 0xbf003f00bf003f00,0xbf003f00bf003f00,0xbeab3ec9bee63f00,0xbd8e3e0dbe523e8b,0xbe0d3e8bbec93f00,0x3ec9be8b3e0da5a0,0x3d8e3e0dbeab3f00,0x3f2dbf173ee6be8b
.quad 0x3e8b2540be8b3f00,0x3f27bf353f27bf00,0x3ee6be0dbe523f00,0x3eabbf173f34bf27,0x3f17be8bbe0d3f00,0xbe0dbe8b3f17bf35,0x3f2dbec9bd8e3f00,0xbf0c3e0d3eabbf27
.quad 0x3f35bf00a5003f00,0xbf353f00a480bf00,0x3f2dbf173d8e3f00,0xbf0c3f32beabbe8b,0x3f17bf273e0d3f00,0xbe0d3f27bf172540,0x3ee6bf323e523f00,0x3eab3ec9bf343e8b
.quad 0x3e8bbf353e8b3f00,0x3f272480bf273f00,0x3d8ebf323eab3f00,0x3f2dbec9bee63f27,0xbe0dbf273ec93f00,0x3ec9bf27be0d3f35,0xbeabbf173ee63f00,0xbd8ebf323e523f27
.quad 0xbf003f00bf003f00,0xbf003f00bf003f00,0x3e52be0d3d8e2480,0x3ee6bec93eabbe8b,0x3f32bf273f17bf00,0x3f17bf273f32bf35,0x3ee6bf173f2dbf35,0xbeab3e0d3d8ebe8b
.quad 0xbe8ba5e03e8bbf00,0xbf273f35bf273f00,0xbf343f17beaba540,0x3e523e0dbee63f27,0xbec93f27bf323f00,0x3f32bf273ec92764,0x3eab3e0dbf0c3f35,0xbd8ebec93f2dbf27
.quad 0x3f35bf00a5e03f00,0xbf353f00a6f8bf00,0x3eabbf323f0c2748,0xbd8e3f17bf2d3e8b,0xbec9be8b3f32bf00,0x3f32be8bbec93f35,0xbf343ec93eabbf35,0x3e52bf323ee63e8b
.quad 0xbe8b3f35be8bbf00,0xbf27a6983f27bf00,0x3ee63ec9bf2da5e0,0xbeab3f32bd8ebf27,0x3f32be8bbf173f00,0x3f173e8bbf32a670,0x3e52bf32bd8e3f35,0x3ee6bf17beab3f27
.quad 0xbf003f00bf003f00,0xbf003f00bf003f00,0x3f20bf173f0cbf00,0x3f34bf323f2dbf27,0x3e0dbe8b3ec9bf00,0xbec93e8bbe0da6a8,0xbf343f32bf203f00,0xbe523ec9bf0c3f27
.quad 0x3e8b2782be8b3f00,0x3f27bf353f27bf00,0x3f0cbf323f2dbf00,0xbf203ec9bd8ebe8b,0xbf173e8b3e0dbf00,0x3e0d3e8bbf173f35,0xbe523f17bf343f00,0x3ee6bf323f20be8b
.quad 0x3f35bf00a6a83f00,0xbf353f00a670bf00,0xbe52bec93f34bf00,0x3ee63e0dbf203f27,0xbf173f27be0dbf00,0x3e0dbf273f17a670,0x3f0c3e0dbf2d3f00,0xbf203f173d8ebf27
.quad 0x3e8bbf353e8b3f00,0x3f27282bbf273f00,0xbf343e0d3f20bf00,0xbe52bf173f0c3e8b,0x3e0d3f27bec9bf00,0xbec93f273e0dbf35,0x3f20bec9bf0c3f00,0x3f34be0dbf2d3e8b
.quad 0xbf003f00bf003f00,0xbf003f00bf003f00,0x3f2dbf323f34bf35,0x3f0cbf173f20bf27,0xbf323f27bf173f00,0xbf173f27bf323f35,0x3f0cbec93e52a670,0x3f20bf323f34bf27
.quad 0xbe8ba70c3e8bbf00,0xbf273f35bf273f00,0xbd8e3ec9bf203f35,0x3f2dbf323f0cbe8b,0x3ec9bf273f32bf00,0xbf323f27bec9a724,0xbf203f32bee6a70c,0x3f34bf173e523e8b
.quad 0x3f35bf0027543f00,0xbf353f00a7b6bf00,0xbf203e0d3ee6bf35,0x3f34bec9be523f27,0x3ec93e8bbf323f00,0xbf323e8b3ec9bf35,0xbd8ebf173f2027aa,0x3f2dbe0dbf0c3f27
.quad 0xbe8b3f35be8bbf00,0xbf27a86a3f27bf00,0x3f0cbf17be523f35,0x3f203e0dbf343e8b,0xbf323e8b3f17bf00,0xbf17be8b3f3227c2,0x3f2d3e0dbf34a807,0x3f0c3ec9bf20be8b
.quad 0xbf003f00bf003f00,0xbf003f00bf003f00,0x3eabbec93ee6bf00,0x3d8ebe0d3e52be8b,0xbe0d3e8bbec93f00,0x3ec9be8b3e0d2540,0xbd8ebe0d3eabbf00,0xbf2d3f17bee63e8b
.quad 0x3e8b2540be8b3f00,0x3f27bf353f27bf00,0xbee63e0d3e52bf00,0xbeab3f17bf343f27,0x3f17be8bbe0d3f00,0xbe0dbe8b3f17bf35,0xbf2d3ec93d8ebf00,0x3f0cbe0dbeab3f27
.quad 0x3f35bf0028003f00,0xbf353f002845bf00,0xbf2d3f17bd8ebf00,0x3f0cbf323eab3e8b,0x3f17bf273e0d3f00,0xbe0d3f27bf1726e0,0xbee63f32be52bf00,0xbeabbec93f34be8b
.quad 0x3e8bbf353e8b3f00,0x3f272894bf273f00,0xbd8e3f32beabbf00,0xbf2d3ec93ee6bf27,0xbe0dbf273ec93f00,0x3ec9bf27be0d3f35,0x3eab3f17bee6bf00,0x3d8e3f32be52bf27
.quad 0xbf003f00bf003f00,0xbf003f00bf003f00,0xbe523e0dbd8ea86a,0xbee63ec9beab3e8b,0x3f32bf273f17bf00,0x3f17bf273f32bf35,0xbee63f17bf2d3f35,0x3eabbe0dbd8e3e8b
.quad 0xbe8b26e03e8bbf00,0xbf273f35bf273f00,0x3f34bf173eab2845,0xbe52be0d3ee6bf27,0xbec93f27bf323f00,0x3f32bf273ec92894,0xbeabbe0d3f0cbf35,0x3d8e3ec9bf2d3f27
.quad 0x3f35bf00a81f3f00,0xbf353f0027f2bf00,0xbeab3f32bf0ca81f,0x3d8ebf173f2dbe8b,0xbec9be8b3f32bf00,0x3f32be8bbec93f35,0x3f34bec9beab3f35,0xbe523f32bee6be8b
.quad 0xbe8b3f35be8bbf00,0xbf27a8b43f27bf00,0xbee6bec93f2d27f2,0x3eabbf323d8e3f27,0x3f32be8bbf173f00,0x3f173e8bbf32a8b4,0xbe523f323d8ebf35,0xbee63f173eabbf27
.quad 0xbf003f00bf003f00,0xbf003f00bf003f00,0xbf203f17bf0c3f00,0xbf343f32bf2d3f27,0x3e0dbe8b3ec9bf00,0xbec93e8bbe0d2670,0x3f34bf323f20bf00,0x3e52bec93f0cbf27
.quad 0x3e8b27f2be8b3f00,0x3f27bf353f27bf00,0xbf0c3f32bf2d3f00,0x3f20bec93d8e3e8b,0xbf173e8b3e0dbf00,0x3e0d3e8bbf173f35,0x3e52bf173f34bf00,0xbee63f32bf203e8b
.quad 0x3f35bf00a7aa3f00,0xbf353f00273cbf00,0x3e523ec9bf343f00,0xbee6be0d3f20bf27,0xbf173f27be0dbf00,0x3e0dbf273f17a724,0xbf0cbe0d3f2dbf00,0x3f20bf17bd8e3f27
.quad 0x3e8bbf353e8b3f00,0x3f2728d2bf273f00,0x3f34be0dbf203f00,0x3e523f17bf0cbe8b,0x3e0d3f27bec9bf00,0xbec93f273e0dbf35,0xbf203ec93f0cbf00,0xbf343e0d3f2dbe8b
.quad 0xbf003f00bf003f00,0xbf003f00bf003f00,0xbf2d3f32bf343f35,0xbf0c3f17bf203f27,0xbf323f27bf173f00,0xbf173f27bf323f35,0xbf0c3ec9be52a7aa,0xbf203f32bf343f27
.quad 0xbe8b27b63e8bbf00,0xbf273f35bf273f00,0x3d8ebec93f20bf35,0xbf2d3f32bf0c3e8b,0x3ec9bf273f32bf00,0xbf323f27bec9a8ba,0x3f20bf323ee6a724,0xbf343f17be52be8b
.quad 0x3f35bf00a8ba3f00,0xbf353f00a6e8bf00,0x3f20be0dbee63f35,0xbf343ec93e52bf27,0x3ec93e8bbf323f00,0xbf323e8b3ec9bf35,0x3d8e3f17bf20a845,0xbf2d3e0d3f0cbf27
.quad 0xbe8b3f35be8bbf00,0xbf27a8f23f27bf00,0xbf0c3f173e52bf35,0xbf20be0d3f34be8b,0xbf323e8b3f17bf00,0xbf17be8b3f32291b,0xbf2dbe0d3f34278e,0xbf0cbec93f203e8b
.quad 0xbf003f00bf003f00,0xbf003f00bf003f00,0xbf203f17bf0c3f00,0xbf343f32bf2d3f27,0xbf323f27bf173f00,0xbf173f27bf323f35,0xbf343f32bf203f00,0xbe523ec9bf0c3f27
.quad 0xbf273f35bf273f00,0x3e8b26a8be8b3f00,0xbf0c3f32bf2d3f00,0x3f20bec93d8e3e8b,0xbec93f27bf323f00,0x3f32bf273ec92698,0xbe523f17bf343f00,0x3ee6bf323f20be8b
.quad 0xa6883f00bf353f00,0x26c8bf003f35bf00,0x3e523ec9bf343f00,0xbee6be0d3f20bf27,0x3ec93e8bbf323f00,0xbf323e8b3ec9bf35,0x3f0c3e0dbf2d3f00,0xbf203f173d8ebf27
.quad 0x3f272670bf273f00,0xbe8b3f35be8bbf00,0x3f34be0dbf203f00,0x3e523f17bf0cbe8b,0x3f32be8bbf173f00,0x3f173e8bbf32a6a8,0x3f20bec9bf0c3f00,0x3f34be0dbf2d3e8b
.quad 0xbf003f00bf003f00,0xbf003f00bf003f00,0xbf2d3f32bf343f35,0xbf0c3f17bf203f27,0xbe0d3e8bbec93f00,0x3ec9be8b3e0d26f8,0x3f0cbec93e5226c8,0x3f20bf323f34bf27
.quad 0x3f27bf353f27bf00,0xbe8b26103e8bbf00,0x3d8ebec93f20bf35,0xbf2d3f32bf0c3e8b,0xbf173e8b3e0dbf00,0x3e0d3e8bbf173f35,0xbf203f32bee6a6d8,0x3f34bf173e523e8b
.quad 0xa79c3f00bf353f00,0x2724bf003f35bf00,0x3f20be0dbee63f35,0xbf343ec93e52bf27,0x3f17bf273e0d3f00,0xbe0d3f27bf172610,0xbd8ebf173f2026e0,0x3f2dbe0dbf0c3f27
.quad 0xbf2726503f27bf00,0x3e8bbf353e8b3f00,0xbf0c3f173e52bf35,0xbf20be0d3f34be8b,0x3e0d3f27bec9bf00,0xbec93f273e0dbf35,0x3f2d3e0dbf342670,0x3f0c3ec9bf20be8b
.quad 0xbf003f00bf003f00,0xbf003f00bf003f00,0xbeab3ec9bee63f00,0xbd8e3e0dbe523e8b,0x3f32bf273f17bf00,0x3f17bf273f32bf35,0xbd8ebe0d3eabbf00,0xbf2d3f17bee63e8b
.quad 0xbf273f35bf273f00,0x3e8b280dbe8b3f00,0x3ee6be0dbe523f00,0x3eabbf173f34bf27,0x3ec9bf273f32bf00,0xbf323f27bec9a540,0xbf2d3ec93d8ebf00,0x3f0cbe0dbeab3f27
.quad 0xa5403f00bf353f00,0x2813bf003f35bf00,0x3f2dbf173d8e3f00,0xbf0c3f32beabbe8b,0xbec9be8b3f32bf00,0x3f32be8bbec93f35,0xbee63f32be52bf00,0xbeabbec93f34be8b
.quad 0x3f27a724bf273f00,0xbe8b3f35be8bbf00,0x3d8ebf323eab3f00,0x3f2dbec9bee63f27,0xbf323e8b3f17bf00,0xbf17be8b3f32a70c,0x3eab3f17bee6bf00,0x3d8e3f32be52bf27
.quad 0xbf003f00bf003f00,0xbf003f00bf003f00,0x3e52be0d3d8ea724,0x3ee6bec93eabbe8b,0x3e0dbe8b3ec9bf00,0xbec93e8bbe0da7ce,0xbee63f17bf2d3f35,0x3eabbe0dbd8e3e8b
.quad 0x3f27bf353f27bf00,0xbe8ba7da3e8bbf00,0xbf343f17beaba610,0x3e523e0dbee63f27,0x3f17be8bbe0d3f00,0xbe0dbe8b3f17bf35,0xbeabbe0d3f0cbf35,0x3d8e3ec9bf2d3f27
.quad 0xa7da3f00bf353f00,0x278ebf003f35bf00,0x3eabbf323f0c276c,0xbd8e3f17bf2d3e8b,0xbf173f27be0dbf00,0x3e0dbf273f17a6a8,0x3f34bec9beab3f35,0xbe523f32bee6be8b
.quad 0xbf27281f3f27bf00,0x3e8bbf353e8b3f00,0x3ee63ec9bf2da7da,0xbeab3f32bd8ebf27,0xbe0dbf273ec93f00,0x3ec9bf27be0d3f35,0xbe523f323d8ebf35,0xbee63f173eabbf27
.quad 0xbf003f00bf003f00,0xbf003f00bf003f00,0x3f20bf173f0cbf00,0x3f34bf323f2dbf27,0xbf323f27bf173f00,0xbf173f27bf323f35,0x3f34bf323f20bf00,0x3e52bec93f0cbf27
.quad 0xbf273f35bf273f00,0x3e8b279cbe8b3f00,0x3f0cbf323f2dbf00,0xbf203ec9bd8ebe8b,0xbec93f27bf323f00,0x3f32bf273ec9279c,0x3e52bf173f34bf00,0xbee63f32bf203e8b
.quad 0xa8573f00bf353f00,0x2832bf003f35bf00,0xbe52bec93f34bf00,0x3ee63e0dbf203f27,0x3ec93e8bbf323f00,0xbf323e8b3ec9bf35,0xbf0cbe0d3f2dbf00,0x3f20bf17bd8e3f27
.quad 0x3f27a7c2bf273f00,0xbe8b3f35be8bbf00,0xbf343e0d3f20bf00,0xbe52bf173f0c3e8b,0x3f32be8bbf173f00,0x3f173e8bbf32a863,0xbf203ec93f0cbf00,0xbf343e0d3f2dbe8b
.quad 0xbf003f00bf003f00,0xbf003f00bf003f00,0x3f2dbf323f34bf35,0x3f0cbf173f20bf27,0xbe0d3e8bbec93f00,0x3ec9be8b3e0d2884,0xbf0c3ec9be52a857,0xbf203f32bf343f27
.quad 0x3f27bf353f27bf00,0xbe8ba8633e8bbf00,0xbd8e3ec9bf203f35,0x3f2dbf323f0cbe8b,0xbf173e8b3e0dbf00,0x3e0d3e8bbf173f35,0x3f20bf323ee62832,0xbf343f17be52be8b
.quad 0xa80d3f00bf353f00,0xa882bf003f35bf00,0xbf203e0d3ee6bf35,0x3f34bec9be523f27,0x3f17bf273e0d3f00,0xbe0d3f27bf17a8a4,0x3d8e3f17bf20a80d,0xbf2d3e0d3f0cbf27
.quad 0xbf27270c3f27bf00,0x3e8bbf353e8b3f00,0x3f0cbf17be523f35,0x3f203e0dbf343e8b,0x3e0d3f27bec9bf00,0xbec93f273e0dbf35,0xbf2dbe0d3f3427ce,0xbf0cbec93f203e8b
.quad 0xbf003f00bf003f00,0xbf003f00bf003f00,0x3eabbec93ee6bf00,0x3d8ebe0d3e52be8b,0x3f32bf273f17bf00,0x3f17bf273f32bf35,0x3d8e3e0dbeab3f00,0x3f2dbf173ee6be8b
.quad 0xbf273f35bf273f00,0x3e8b2670be8b3f00,0xbee63e0d3e52bf00,0xbeab3f17bf343f27,0x3ec9bf273f32bf00,0xbf323f27bec92851,0x3f2dbec9bd8e3f00,0xbf0c3e0d3eabbf27
.quad 0xa7823f00bf353f00,0x26e0bf003f35bf00,0xbf2d3f17bd8ebf00,0x3f0cbf323eab3e8b,0xbec9be8b3f32bf00,0x3f32be8bbec93f35,0x3ee6bf323e523f00,0x3eab3ec9bf343e8b
.quad 0x3f2726e0bf273f00,0xbe8b3f35be8bbf00,0xbd8e3f32beabbf00,0xbf2d3ec93ee6bf27,0xbf323e8b3f17bf00,0xbf17be8b3f32a86a,0xbeabbf173ee63f00,0xbd8ebf323e523f27
.quad 0xbf003f00bf003f00,0xbf003f00bf003f00,0xbe523e0dbd8e270c,0xbee63ec9beab3e8b,0x3e0dbe8b3ec9bf00,0xbec93e8bbe0da8d6,0x3ee6bf173f2dbf35,0xbeab3e0d3d8ebe8b
.quad 0x3f27bf353f27bf00,0xbe8ba8253e8bbf00,0x3f34bf173eab284b,0xbe52be0d3ee6bf27,0x3f17be8bbe0d3f00,0xbe0dbe8b3f17bf35,0x3eab3e0dbf0c3f35,0xbd8ebec93f2dbf27
.quad 0xa8b03f00bf353f00,0xa73cbf003f35bf00,0xbeab3f32bf0ca79c,0x3d8ebf173f2dbe8b,0xbf173f27be0dbf00,0x3e0dbf273f17289e,0xbf343ec93eabbf35,0x3e52bf323ee63e8b
.quad 0xbf27a7b63f27bf00,0x3e8bbf353e8b3f00,0xbee6bec93f2da73c,0x3eabbf323d8e3f27,0xbe0dbf273ec93f00,0x3ec9bf27be0d3f35,0x3e52bf32bd8e3f35,0x3ee6bf17beab3f27
.quad 0x3f00bf003f00bf00,0x3f00bf003f00bf00,0x3f20bf173f0cbf00,0x3f34bf323f2dbf27,0x3f32bf273f17bf00,0x3f17bf273f32bf35,0x3f34bf323f20bf00,0x3e52bec93f0cbf27
.quad 0x3f27bf353f27bf00,0xbe8ba6a83e8bbf00,0x3f0cbf323f2dbf00,0xbf203ec9bd8ebe8b,0x3ec9bf273f32bf00,0xbf323f27bec9a698,0x3e52bf173f34bf00,0xbee63f32bf203e8b
.quad 0x2688bf003f35bf00,0xa6c83f00bf353f00,0xbe52bec93f34bf00,0x3ee63e0dbf203f27,0xbec9be8b3f32bf00,0x3f32be8bbec93f35,0xbf0cbe0d3f2dbf00,0x3f20bf17bd8e3f27
.quad 0xbf27a6703f27bf00,0x3e8bbf353e8b3f00,0xbf343e0d3f20bf00,0xbe52bf173f0c3e8b,0xbf323e8b3f17bf00,0xbf17be8b3f3226a8,0xbf203ec93f0cbf00,0xbf343e0d3f2dbe8b
.quad 0x3f00bf003f00bf00,0x3f00bf003f00bf00,0x3f2dbf323f34bf35,0x3f0cbf173f20bf27,0x3e0dbe8b3ec9bf00,0xbec93e8bbe0da6f8,0xbf0c3ec9be52a6c8,0xbf203f32bf343f27
.quad 0xbf273f35bf273f00,0x3e8ba610be8b3f00,0xbd8e3ec9bf203f35,0x3f2dbf323f0cbe8b,0x3f17be8bbe0d3f00,0xbe0dbe8b3f17bf35,0x3f20bf323ee626d8,0xbf343f17be52be8b
.quad 0x279cbf003f35bf00,0xa7243f00bf353f00,0xbf203e0d3ee6bf35,0x3f34bec9be523f27,0xbf173f27be0dbf00,0x3e0dbf273f17a610,0x3d8e3f17bf20a6e0,0xbf2d3e0d3f0cbf27
.quad 0x3f27a650bf273f00,0xbe8b3f35be8bbf00,0x3f0cbf17be523f35,0x3f203e0dbf343e8b,0xbe0dbf273ec93f00,0x3ec9bf27be0d3f35,0xbf2dbe0d3f34a670,0xbf0cbec93f203e8b
.quad 0x3f00bf003f00bf00,0x3f00bf003f00bf00,0x3eabbec93ee6bf00,0x3d8ebe0d3e52be8b,0xbf323f27bf173f00,0xbf173f27bf323f35,0x3d8e3e0dbeab3f00,0x3f2dbf173ee6be8b
.quad 0x3f27bf353f27bf00,0xbe8ba80d3e8bbf00,0xbee63e0d3e52bf00,0xbeab3f17bf343f27,0xbec93f27bf323f00,0x3f32bf273ec92540,0x3f2dbec9bd8e3f00,0xbf0c3e0d3eabbf27
.quad 0x2540bf003f35bf00,0xa8133f00bf353f00,0xbf2d3f17bd8ebf00,0x3f0cbf323eab3e8b,0x3ec93e8bbf323f00,0xbf323e8b3ec9bf35,0x3ee6bf323e523f00,0x3eab3ec9bf343e8b
.quad 0xbf2727243f27bf00,0x3e8bbf353e8b3f00,0xbd8e3f32beabbf00,0xbf2d3ec93ee6bf27,0x3f32be8bbf173f00,0x3f173e8bbf32270c,0xbeabbf173ee63f00,0xbd8ebf323e523f27
.quad 0x3f00bf003f00bf00,0x3f00bf003f00bf00,0xbe523e0dbd8e2724,0xbee63ec9beab3e8b,0xbe0d3e8bbec93f00,0x3ec9be8b3e0d27ce,0x3ee6bf173f2dbf35,0xbeab3e0d3d8ebe8b
.quad 0xbf273f35bf273f00,0x3e8b27dabe8b3f00,0x3f34bf173eab2610,0xbe52be0d3ee6bf27,0xbf173e8b3e0dbf00,0x3e0d3e8bbf173f35,0x3eab3e0dbf0c3f35,0xbd8ebec93f2dbf27
.quad 0x27dabf003f35bf00,0xa78e3f00bf353f00,0xbeab3f32bf0ca76c,0x3d8ebf173f2dbe8b,0x3f17bf273e0d3f00,0xbe0d3f27bf1726a8,0xbf343ec93eabbf35,0x3e52bf323ee63e8b
.quad 0x3f27a81fbf273f00,0xbe8b3f35be8bbf00,0xbee6bec93f2d27da,0x3eabbf323d8e3f27,0x3e0d3f27bec9bf00,0xbec93f273e0dbf35,0x3e52bf32bd8e3f35,0x3ee6bf17beab3f27
.quad 0x3f00bf003f00bf00,0x3f00bf003f00bf00,0xbf203f17bf0c3f00,0xbf343f32bf2d3f27,0x3f32bf273f17bf00,0x3f17bf273f32bf35,0xbf343f32bf203f00,0xbe523ec9bf0c3f27
.quad 0x3f27bf353f27bf00,0xbe8ba79c3e8bbf00,0xbf0c3f32bf2d3f00,0x3f20bec93d8e3e8b,0x3ec9bf273f32bf00,0xbf323f27bec9a79c,0xbe523f17bf343f00,0x3ee6bf323f20be8b
.quad 0x2857bf003f35bf00,0xa8323f00bf353f00,0x3e523ec9bf343f00,0xbee6be0d3f20bf27,0xbec9be8b3f32bf00,0x3f32be8bbec93f35,0x3f0c3e0dbf2d3f00,0xbf203f173d8ebf27
.quad 0xbf2727c23f27bf00,0x3e8bbf353e8b3f00,0x3f34be0dbf203f00,0x3e523f17bf0cbe8b,0xbf323e8b3f17bf00,0xbf17be8b3f322863,0x3f20bec9bf0c3f00,0x3f34be0dbf2d3e8b
.quad 0x3f00bf003f00bf00,0x3f00bf003f00bf00,0xbf2d3f32bf343f35,0xbf0c3f17bf203f27,0x3e0dbe8b3ec9bf00,0xbec93e8bbe0da884,0x3f0cbec93e522857,0x3f20bf323f34bf27
.quad 0xbf273f35bf273f00,0x3e8b2863be8b3f00,0x3d8ebec93f20bf35,0xbf2d3f32bf0c3e8b,0x3f17be8bbe0d3f00,0xbe0dbe8b3f17bf35,0xbf203f32bee6a832,0x3f34bf173e523e8b
.quad 0x280dbf003f35bf00,0x28823f00bf353f00,0x3f20be0dbee63f35,0xbf343ec93e52bf27,0xbf173f27be0dbf00,0x3e0dbf273f1728a4,0xbd8ebf173f20280d,0x3f2dbe0dbf0c3f27
.quad 0x3f27a70cbf273f00,0xbe8b3f35be8bbf00,0xbf0c3f173e52bf35,0xbf20be0d3f34be8b,0xbe0dbf273ec93f00,0x3ec9bf27be0d3f35,0x3f2d3e0dbf34a7ce,0x3f0c3ec9bf20be8b
.quad 0x3f00bf003f00bf00,0x3f00bf003f00bf00,0xbeab3ec9bee63f00,0xbd8e3e0dbe523e8b,0xbf323f27bf173f00,0xbf173f27bf323f35,0xbd8ebe0d3eabbf00,0xbf2d3f17bee63e8b
.quad 0x3f27bf353f27bf00,0xbe8ba6703e8bbf00,0x3ee6be0dbe523f00,0x3eabbf173f34bf27,0xbec93f27bf323f00,0x3f32bf273ec9a851,0xbf2d3ec93d8ebf00,0x3f0cbe0dbeab3f27
.quad 0x2782bf003f35bf00,0xa6e03f00bf353f00,0x3f2dbf173d8e3f00,0xbf0c3f32beabbe8b,0x3ec93e8bbf323f00,0xbf323e8b3ec9bf35,0xbee63f32be52bf00,0xbeabbec93f34be8b
.quad 0xbf27a6e03f27bf00,0x3e8bbf353e8b3f00,0x3d8ebf323eab3f00,0x3f2dbec9bee63f27,0x3f32be8bbf173f00,0x3f173e8bbf32286a,0x3eab3f17bee6bf00,0x3d8e3f32be52bf27
.quad 0x3f00bf003f00bf00,0x3f00bf003f00bf00,0x3e52be0d3d8ea70c,0x3ee6bec93eabbe8b,0xbe0d3e8bbec93f00,0x3ec9be8b3e0d28d6,0xbee63f17bf2d3f35,0x3eabbe0dbd8e3e8b
.quad 0xbf273f35bf273f00,0x3e8b2825be8b3f00,0xbf343f17beaba84b,0x3e523e0dbee63f27,0xbf173e8b3e0dbf00,0x3e0d3e8bbf173f35,0xbeabbe0d3f0cbf35,0x3d8e3ec9bf2d3f27
.quad 0x28b0bf003f35bf00,0x273c3f00bf353f00,0x3eabbf323f0c279c,0xbd8e3f17bf2d3e8b,0x3f17bf273e0d3f00,0xbe0d3f27bf17a89e,0x3f34bec9beab3f35,0xbe523f32bee6be8b
.quad 0x3f2727b6bf273f00,0xbe8b3f35be8bbf00,0x3ee63ec9bf2d273c,0xbeab3f32bd8ebf27,0x3e0d3f27bec9bf00,0xbec93f273e0dbf35,0xbe523f323d8ebf35,0xbee63f173eabbf27
.quad 0xbf00bf003f003f00,0xbf00bf003f003f00,0xbf20bec93f0c3f00,0xbf34be0d3f2d3e8b,0xbf32be8b3f173f00,0xbf173e8b3f32a480,0xbf34be0d3f203f00,0xbe523f173f0cbe8b
.quad 0xbf2725e03f273f00,0x3e8b3f353e8bbf00,0xbf0c3e0d3f2d3f00,0x3f203f17bd8ebf27,0xbec93e8b3f323f00,0x3f323e8bbec9bf35,0xbe523ec93f343f00,0x3ee6be0dbf20bf27
.quad 0x25403f003f353f00,0x2754bf00bf35bf00,0x3e523f173f343f00,0xbee6bf32bf20be8b,0x3ec93f273f323f00,0xbf32bf27bec90000,0x3f0c3f323f2d3f00,0xbf20bec9bd8e3e8b
.quad 0x3f273f353f273f00,0xbe8ba5e03e8b3f00,0x3f343f323f203f00,0x3e523ec93f0c3f27,0x3f323f273f173f00,0x3f173f273f323f35,0x3f203f173f0c3f00,0x3f343f323f2d3f27
.quad 0xbf00bf003f003f00,0xbf00bf003f003f00,0xbf2d3e0d3f342754,0xbf0c3ec93f20be8b,0xbe0d3f273ec9bf00,0x3ec93f27be0dbf35,0x3f0c3f17be52bf35,0x3f20be0dbf34be8b
.quad 0x3f27276cbf27bf00,0xbe8bbf35be8b3f00,0x3d8ebf17bf20a610,0xbf2dbe0d3f0c3f27,0xbf17bf27be0d3f00,0x3e0d3f273f172782,0xbf20be0d3ee63f35,0x3f343ec9be52bf27
.quad 0xa7da3f003f353f00,0x2825bf00bf35bf00,0x3f203f323ee62764,0xbf34bf17be523e8b,0x3f173e8bbe0dbf00,0xbe0d3e8b3f173f35,0xbd8ebec9bf20bf35,0x3f2d3f323f0c3e8b
.quad 0xbf27bf35bf27bf00,0x3e8ba670be8bbf00,0xbf0cbec9be52a650,0xbf20bf32bf34bf27,0x3e0d3e8b3ec93f00,0xbec9be8bbe0da7e6,0x3f2d3f323f343f35,0x3f0c3f173f203f27
.quad 0xbf00bf003f003f00,0xbf00bf003f003f00,0xbeab3f173ee6bf00,0xbd8e3f323e52bf27,0x3f323e8bbf17bf00,0x3f17be8bbf32a800,0xbd8ebf32beab3f00,0xbf2dbec93ee63f27
.quad 0xbf27a70c3f273f00,0x3e8b3f353e8bbf00,0x3ee63f323e52bf00,0x3eabbec9bf34be8b,0x3ec9be8bbf32bf00,0xbf32be8b3ec93f35,0xbf2dbf17bd8e3f00,0x3f0c3f323eabbe8b
.quad 0xa85d3f003f353f00,0x27c2bf00bf35bf00,0x3f2d3ec9bd8ebf00,0xbf0cbe0d3eab3f27,0xbec9bf27bf32bf00,0x3f323f273ec927b6,0xbee6be0d3e523f00,0xbeabbf17bf34bf27
.quad 0x3f273f353f273f00,0xbe8ba86a3e8b3f00,0x3d8ebe0dbeabbf00,0x3f2d3f173ee63e8b,0xbf32bf27bf17bf00,0xbf17bf27bf32bf35,0x3eab3ec93ee63f00,0x3d8e3e0d3e523e8b
.quad 0xbf00bf003f003f00,0xbf00bf003f003f00,0x3e523f32bd8ebf35,0x3ee63f17beabbf27,0x3e0dbf27bec93f00,0xbec9bf273e0d3f35,0xbee63ec93f2d2540,0x3eab3f323d8ebf27
.quad 0x3f272610bf27bf00,0xbe8bbf35be8b3f00,0xbf34bec93eab3f35,0x3e523f323ee6be8b,0x3f173f273e0dbf00,0xbe0dbf27bf1726e0,0xbeabbf32bf0ca86a,0x3d8e3f173f2d3e8b
.quad 0xa8a73f003f353f00,0x2851bf00bf35bf00,0x3eabbe0dbf0cbf35,0xbd8e3ec93f2d3f27,0xbf17be8b3e0d3f00,0x3e0dbe8bbf17bf35,0x3f343f173eaba79c,0xbe523e0d3ee63f27
.quad 0xbf27bf35bf27bf00,0x3e8b27f2be8bbf00,0x3ee63f173f2d3f35,0xbeabbe0d3d8e3e8b,0xbe0dbe8bbec9bf00,0x3ec93e8b3e0d2851,0xbe52be0dbd8e26e0,0xbee6bec9beabbe8b
.quad 0xbf00bf003f003f00,0xbf00bf003f003f00,0x3f203ec9bf0cbf00,0x3f343e0dbf2dbe8b,0xbf32be8b3f173f00,0xbf173e8b3f3227f2,0x3f343e0dbf20bf00,0x3e52bf17bf0c3e8b
.quad 0xbf2726703f273f00,0x3e8b3f353e8bbf00,0x3f0cbe0dbf2dbf00,0xbf20bf173d8e3f27,0xbec93e8b3f323f00,0x3f323e8bbec9bf35,0x3e52bec9bf34bf00,0xbee63e0d3f203f27
.quad 0xa7aa3f003f353f00,0x28a0bf00bf35bf00,0xbe52bf17bf34bf00,0x3ee63f323f203e8b,0x3ec93f273f323f00,0xbf32bf27bec9a888,0xbf0cbf32bf2dbf00,0x3f203ec93d8ebe8b
.quad 0x3f273f353f273f00,0xbe8ba8ba3e8b3f00,0xbf34bf32bf20bf00,0xbe52bec9bf0cbf27,0x3f323f273f173f00,0x3f173f273f323f35,0xbf20bf17bf0cbf00,0xbf34bf32bf2dbf27
.quad 0xbf00bf003f003f00,0xbf00bf003f003f00,0x3f2dbe0dbf34a7aa,0x3f0cbec9bf203e8b,0xbe0d3f273ec9bf00,0x3ec93f27be0dbf35,0xbf0cbf173e523f35,0xbf203e0d3f343e8b
.quad 0x3f27a724bf27bf00,0xbe8bbf35be8b3f00,0xbd8e3f173f20273c,0x3f2d3e0dbf0cbf27,0xbf17bf27be0d3f00,0x3e0d3f273f1728d2,0x3f203e0dbee6bf35,0xbf34bec93e523f27
.quad 0xa8453f003f353f00,0x278ebf00bf35bf00,0xbf20bf32bee6a610,0x3f343f173e52be8b,0x3f173e8bbe0dbf00,0xbe0d3e8b3f173f35,0x3d8e3ec93f203f35,0xbf2dbf32bf0cbe8b
.quad 0xbf27bf35bf27bf00,0x3e8b291bbe8bbf00,0x3f0c3ec93e52a6e8,0x3f203f323f343f27,0x3e0d3e8b3ec93f00,0xbec9be8bbe0da8f2,0xbf2dbf32bf34bf35,0xbf0cbf17bf20bf27
.quad 0xbf00bf003f003f00,0xbf00bf003f003f00,0x3eabbf17bee63f00,0x3d8ebf32be523f27,0x3f323e8bbf17bf00,0x3f17be8bbf322782,0x3d8e3f323eabbf00,0x3f2d3ec9bee6bf27
.quad 0xbf2727823f273f00,0x3e8b3f353e8bbf00,0xbee6bf32be523f00,0xbeab3ec93f343e8b,0x3ec9be8bbf32bf00,0xbf32be8b3ec93f35,0x3f2d3f173d8ebf00,0xbf0cbf32beab3e8b
.quad 0xa89a3f003f353f00,0xa832bf00bf35bf00,0xbf2dbec93d8e3f00,0x3f0c3e0dbeabbf27,0xbec9bf27bf32bf00,0x3f323f273ec9a8e2,0x3ee63e0dbe52bf00,0x3eab3f173f343f27
.quad 0x3f273f353f273f00,0xbe8ba8fe3e8b3f00,0xbd8e3e0d3eab3f00,0xbf2dbf17bee6be8b,0xbf32bf27bf17bf00,0xbf17bf27bf32bf35,0xbeabbec9bee6bf00,0xbd8ebe0dbe52be8b
.quad 0xbf00bf003f003f00,0xbf00bf003f003f00,0xbe52bf323d8e3f35,0xbee6bf173eab3f27,0x3e0dbf27bec93f00,0xbec9bf273e0d3f35,0x3ee6bec9bf2da89a,0xbeabbf32bd8e3f27
.quad 0x3f272888bf27bf00,0xbe8bbf35be8b3f00,0x3f343ec9beabbf35,0xbe52bf32bee63e8b,0x3f173f273e0dbf00,0xbe0dbf27bf17a8fe,0x3eab3f323f0ca832,0xbd8ebf17bf2dbe8b
.quad 0xa76c3f003f353f00,0xa8d6bf00bf35bf00,0xbeab3e0d3f0c3f35,0x3d8ebec9bf2dbf27,0xbf17be8b3e0d3f00,0x3e0dbe8bbf17bf35,0xbf34bf17beaba76c,0x3e52be0dbee6bf27
.quad 0xbf27bf35bf27bf00,0x3e8b28c6be8bbf00,0xbee6bf17bf2dbf35,0x3eab3e0dbd8ebe8b,0xbe0dbe8bbec9bf00,0x3ec93e8b3e0d28c6,0x3e523e0d3d8e2894,0x3ee63ec93eab3e8b
.quad 0x3f00bf00bf003f00,0x3f00bf00bf003f00,0x3eabbf17bee63f00,0x3d8ebf32be523f27,0x3e0dbf27bec93f00,0xbec9bf273e0d3f35,0xbd8ebf32beab3f00,0xbf2dbec93ee63f27
.quad 0xbe8bbf35be8b3f00,0xbf27a6d83f273f00,0xbee6bf32be523f00,0xbeab3ec93f343e8b,0xbf17bf27be0d3f00,0x3e0d3f273f1726a8,0xbf2dbf17bd8e3f00,0x3f0c3f323eabbe8b
.quad 0xbf35bf00a5403f00,0x3f353f0026c8bf00,0xbf2dbec93d8e3f00,0x3f0c3e0dbeabbf27,0xbf17be8b3e0d3f00,0x3e0dbe8bbf17bf35,0xbee6be0d3e523f00,0xbeabbf17bf34bf27
.quad 0xbe8ba6883e8b3f00,0xbf27bf35bf27bf00,0xbd8e3e0d3eab3f00,0xbf2dbf17bee6be8b,0x3e0d3e8b3ec93f00,0xbec9be8bbe0da6b8,0x3eab3ec93ee63f00,0x3d8e3e0d3e523e8b
.quad 0x3f00bf00bf003f00,0x3f00bf00bf003f00,0xbe52bf323d8e3f35,0xbee6bf173eab3f27,0xbf32be8b3f173f00,0xbf173e8b3f322724,0xbee63ec93f2d26f8,0x3eab3f323d8ebf27
.quad 0x3e8b3f353e8bbf00,0x3f27273cbf27bf00,0x3f343ec9beabbf35,0xbe52bf32bee63e8b,0x3ec9be8bbf32bf00,0xbf32be8b3ec93f35,0xbeabbf32bf0c2650,0x3d8e3f173f2d3e8b
.quad 0xbf35bf0026103f00,0x3f353f00a807bf00,0xbeab3e0d3f0c3f35,0x3d8ebec9bf2dbf27,0x3ec93f273f323f00,0xbf32bf27bec9a7b6,0x3f343f173eab270c,0xbe523e0d3ee63f27
.quad 0x3e8b2724be8bbf00,0x3f273f353f273f00,0xbee6bf17bf2dbf35,0x3eab3e0dbd8ebe8b,0xbf32bf27bf17bf00,0xbf17bf27bf32bf35,0xbe52be0dbd8e2610,0xbee6bec9beabbe8b
.quad 0x3f00bf00bf003f00,0x3f00bf00bf003f00,0xbf20bec93f0c3f00,0xbf34be0d3f2d3e8b,0xbe0d3f273ec9bf00,0x3ec93f27be0dbf35,0x3f343e0dbf20bf00,0x3e52bf17bf0c3e8b
.quad 0xbe8bbf35be8b3f00,0xbf27a84b3f273f00,0xbf0c3e0d3f2d3f00,0x3f203f17bd8ebf27,0x3f173f273e0dbf00,0xbe0dbf27bf17a7da,0x3e52bec9bf34bf00,0xbee63e0d3f203f27
.quad 0xbf35bf00279c3f00,0x3f353f00a6a8bf00,0x3e523f173f343f00,0xbee6bf32bf20be8b,0x3f173e8bbe0dbf00,0xbe0d3e8b3f173f35,0xbf0cbf32bf2dbf00,0x3f203ec93d8ebe8b
.quad 0xbe8ba7da3e8b3f00,0xbf27bf35bf27bf00,0x3f343f323f203f00,0x3e523ec93f0c3f27,0xbe0dbe8bbec9bf00,0x3ec93e8b3e0d278e,0xbf20bf17bf0cbf00,0xbf34bf32bf2dbf27
.quad 0x3f00bf00bf003f00,0x3f00bf00bf003f00,0xbf2d3e0d3f34a6a8,0xbf0c3ec93f20be8b,0x3f323e8bbf17bf00,0x3f17be8bbf32a857,0xbf0cbf173e523f35,0xbf203e0d3f343e8b
.quad 0x3e8b3f353e8bbf00,0x3f272832bf27bf00,0x3d8ebf17bf20a6e0,0xbf2dbe0d3f0c3f27,0xbec93e8b3f323f00,0x3f323e8bbec9bf35,0x3f203e0dbee6bf35,0xbf34bec93e523f27
.quad 0xbf35bf0028133f00,0x3f353f0027b6bf00,0x3f203f323ee6279c,0xbf34bf17be523e8b,0xbec9bf27bf32bf00,0x3f323f273ec927b6,0x3d8e3ec93f203f35,0xbf2dbf32bf0cbe8b
.quad 0x3e8ba839be8bbf00,0x3f273f353f273f00,0xbf0cbec9be52a800,0xbf20bf32bf34bf27,0x3f323f273f173f00,0x3f173f273f323f35,0xbf2dbf32bf34bf35,0xbf0cbf17bf20bf27
.quad 0x3f00bf00bf003f00,0x3f00bf00bf003f00,0xbeab3f173ee6bf00,0xbd8e3f323e52bf27,0x3e0dbf27bec93f00,0xbec9bf273e0d3f35,0x3d8e3f323eabbf00,0x3f2d3ec9bee6bf27
.quad 0xbe8bbf35be8b3f00,0xbf27a8193f273f00,0x3ee63f323e52bf00,0x3eabbec9bf34be8b,0xbf17bf27be0d3f00,0x3e0d3f273f172670,0x3f2d3f173d8ebf00,0xbf0cbf32beab3e8b
.quad 0xbf35bf00270c3f00,0x3f353f00a81fbf00,0x3f2d3ec9bd8ebf00,0xbf0cbe0d3eab3f27,0xbf17be8b3e0d3f00,0x3e0dbe8bbf17bf35,0x3ee63e0dbe52bf00,0x3eab3f173f343f27
.quad 0xbe8ba7823e8b3f00,0xbf27bf35bf27bf00,0x3d8ebe0dbeabbf00,0x3f2d3f173ee63e8b,0x3e0d3e8b3ec93f00,0xbec9be8bbe0da825,0xbeabbec9bee6bf00,0xbd8ebe0dbe52be8b
.quad 0x3f00bf00bf003f00,0x3f00bf00bf003f00,0x3e523f32bd8ebf35,0x3ee63f17beabbf27,0xbf32be8b3f173f00,0xbf173e8b3f3228c3,0x3ee6bec9bf2da782,0xbeabbf32bd8e3f27
.quad 0x3e8b3f353e8bbf00,0x3f272800bf27bf00,0xbf34bec93eab3f35,0x3e523f323ee6be8b,0x3ec9be8bbf32bf00,0xbf32be8b3ec93f35,0x3eab3f323f0c26e0,0xbd8ebf17bf2dbe8b
.quad 0xbf35bf00a8dc3f00,0x3f353f00a73cbf00,0x3eabbe0dbf0cbf35,0xbd8e3ec93f2d3f27,0x3ec93f273f323f00,0xbf32bf27bec9a8e2,0xbf34bf17beab2610,0x3e52be0dbee6bf27
.quad 0x3e8ba73cbe8bbf00,0x3f273f353f273f00,0x3ee63f173f2d3f35,0xbeabbe0d3d8e3e8b,0xbf32bf27bf17bf00,0xbf17bf27bf32bf35,0x3e523e0d3d8ea73c,0x3ee63ec93eab3e8b
.quad 0x3f00bf00bf003f00,0x3f00bf00bf003f00,0x3f203ec9bf0cbf00,0x3f343e0dbf2dbe8b,0xbe0d3f273ec9bf00,0x3ec93f27be0dbf35,0xbf34be0d3f203f00,0xbe523f173f0cbe8b
.quad 0xbe8bbf35be8b3f00,0xbf27a7ce3f273f00,0x3f0cbe0dbf2dbf00,0xbf20bf173d8e3f27,0x3f173f273e0dbf00,0xbe0dbf27bf17a7ce,0xbe523ec93f343f00,0x3ee6be0dbf20bf27
.quad 0xbf35bf00a90a3f00,0x3f353f002782bf00,0xbe52bf17bf34bf00,0x3ee63f323f203e8b,0x3f173e8bbe0dbf00,0xbe0d3e8b3f173f35,0x3f0c3f323f2d3f00,0xbf20bec9bd8e3e8b
.quad 0xbe8ba84b3e8b3f00,0xbf27bf35bf27bf00,0xbf34bf32bf20bf00,0xbe52bec9bf0cbf27,0xbe0dbe8bbec9bf00,0x3ec93e8b3e0da88e,0x3f203f173f0c3f00,0x3f343f323f2d3f27
.quad 0x3f00bf00bf003f00,0x3f00bf00bf003f00,0x3f2dbe0dbf34282b,0x3f0cbec9bf203e8b,0x3f323e8bbf17bf00,0x3f17be8bbf32a84b,0x3f0c3f17be52bf35,0x3f20be0dbf34be8b
.quad 0x3e8b3f353e8bbf00,0x3f2728dcbf27bf00,0xbd8e3f173f202782,0x3f2d3e0dbf0cbf27,0xbec93e8b3f323f00,0x3f323e8bbec9bf35,0xbf20be0d3ee63f35,0x3f343ec9be52bf27
.quad 0xbf35bf00a8983f00,0x3f353f00a839bf00,0xbf20bf32bee6a898,0x3f343f173e52be8b,0xbec9bf27bf32bf00,0x3f323f273ec9294c,0xbd8ebec9bf20bf35,0x3f2d3f323f0c3e8b
.quad 0x3e8b27b6be8bbf00,0x3f273f353f273f00,0x3f0c3ec93e52a839,0x3f203f323f343f27,0x3f323f273f173f00,0x3f173f273f323f35,0x3f2d3f323f343f35,0x3f0c3f173f203f27
.quad 0xbf003f003f00bf00,0xbf003f003f00bf00,0xbeab3f173ee6bf00,0xbd8e3f323e52bf27,0xbe0d3f273ec9bf00,0x3ec93f27be0dbf35,0x3d8e3f323eabbf00,0x3f2d3ec9bee6bf27
.quad 0x3e8b3f353e8bbf00,0x3f2726d8bf27bf00,0x3ee63f323e52bf00,0x3eabbec9bf34be8b,0x3f173f273e0dbf00,0xbe0dbf27bf17a6a8,0x3f2d3f173d8ebf00,0xbf0cbf32beab3e8b
.quad 0x3f353f002540bf00,0xbf35bf00a6c83f00,0x3f2d3ec9bd8ebf00,0xbf0cbe0d3eab3f27,0x3f173e8bbe0dbf00,0xbe0d3e8b3f173f35,0x3ee63e0dbe52bf00,0x3eab3f173f343f27
.quad 0x3e8b2688be8bbf00,0x3f273f353f273f00,0x3d8ebe0dbeabbf00,0x3f2d3f173ee63e8b,0xbe0dbe8bbec9bf00,0x3ec93e8b3e0d26b8,0xbeabbec9bee6bf00,0xbd8ebe0dbe52be8b
.quad 0xbf003f003f00bf00,0xbf003f003f00bf00,0x3e523f32bd8ebf35,0x3ee63f17beabbf27,0x3f323e8bbf17bf00,0x3f17be8bbf32a724,0x3ee6bec9bf2da6f8,0xbeabbf32bd8e3f27
.quad 0xbe8bbf35be8b3f00,0xbf27a73c3f273f00,0xbf34bec93eab3f35,0x3e523f323ee6be8b,0xbec93e8b3f323f00,0x3f323e8bbec9bf35,0x3eab3f323f0ca650,0xbd8ebf17bf2dbe8b
.quad 0x3f353f00a610bf00,0xbf35bf0028073f00,0x3eabbe0dbf0cbf35,0xbd8e3ec93f2d3f27,0xbec9bf27bf32bf00,0x3f323f273ec927b6,0xbf34bf17beaba70c,0x3e52be0dbee6bf27
.quad 0xbe8ba7243e8b3f00,0xbf27bf35bf27bf00,0x3ee63f173f2d3f35,0xbeabbe0d3d8e3e8b,0x3f323f273f173f00,0x3f173f273f323f35,0x3e523e0d3d8ea610,0x3ee63ec93eab3e8b
.quad 0xbf003f003f00bf00,0xbf003f003f00bf00,0x3f203ec9bf0cbf00,0x3f343e0dbf2dbe8b,0x3e0dbf27bec93f00,0xbec9bf273e0d3f35,0xbf34be0d3f203f00,0xbe523f173f0cbe8b
.quad 0x3e8b3f353e8bbf00,0x3f27284bbf27bf00,0x3f0cbe0dbf2dbf00,0xbf20bf173d8e3f27,0xbf17bf27be0d3f00,0x3e0d3f273f1727da,0xbe523ec93f343f00,0x3ee6be0dbf20bf27
.quad 0x3f353f00a79cbf00,0xbf35bf0026a83f00,0xbe52bf17bf34bf00,0x3ee63f323f203e8b,0xbf17be8b3e0d3f00,0x3e0dbe8bbf17bf35,0x3f0c3f323f2d3f00,0xbf20bec9bd8e3e8b
.quad 0x3e8b27dabe8bbf00,0x3f273f353f273f00,0xbf34bf32bf20bf00,0xbe52bec9bf0cbf27,0x3e0d3e8b3ec93f00,0xbec9be8bbe0da78e,0x3f203f173f0c3f00,0x3f343f323f2d3f27
.quad 0xbf003f003f00bf00,0xbf003f003f00bf00,0x3f2dbe0dbf3426a8,0x3f0cbec9bf203e8b,0xbf32be8b3f173f00,0xbf173e8b3f322857,0x3f0c3f17be52bf35,0x3f20be0dbf34be8b
.quad 0xbe8bbf35be8b3f00,0xbf27a8323f273f00,0xbd8e3f173f2026e0,0x3f2d3e0dbf0cbf27,0x3ec9be8bbf32bf00,0xbf32be8b3ec93f35,0xbf20be0d3ee63f35,0x3f343ec9be52bf27
.quad 0x3f353f00a813bf00,0xbf35bf00a7b63f00,0xbf20bf32bee6a79c,0x3f343f173e52be8b,0x3ec93f273f323f00,0xbf32bf27bec9a7b6,0xbd8ebec9bf20bf35,0x3f2d3f323f0c3e8b
.quad 0xbe8b28393e8b3f00,0xbf27bf35bf27bf00,0x3f0c3ec93e522800,0x3f203f323f343f27,0xbf32bf27bf17bf00,0xbf17bf27bf32bf35,0x3f2d3f323f343f35,0x3f0c3f173f203f27
.quad 0xbf003f003f00bf00,0xbf003f003f00bf00,0x3eabbf17bee63f00,0x3d8ebf32be523f27,0xbe0d3f273ec9bf00,0x3ec93f27be0dbf35,0xbd8ebf32beab3f00,0xbf2dbec93ee63f27
.quad 0x3e8b3f353e8bbf00,0x3f272819bf27bf00,0xbee6bf32be523f00,0xbeab3ec93f343e8b,0x3f173f273e0dbf00,0xbe0dbf27bf17a670,0xbf2dbf17bd8e3f00,0x3f0c3f323eabbe8b
.quad 0x3f353f00a70cbf00,0xbf35bf00281f3f00,0xbf2dbec93d8e3f00,0x3f0c3e0dbeabbf27,0x3f173e8bbe0dbf00,0xbe0d3e8b3f173f35,0xbee6be0d3e523f00,0xbeabbf17bf34bf27
.quad 0x3e8b2782be8bbf00,0x3f273f353f273f00,0xbd8e3e0d3eab3f00,0xbf2dbf17bee6be8b,0xbe0dbe8bbec9bf00,0x3ec93e8b3e0d2825,0x3eab3ec93ee63f00,0x3d8e3e0d3e523e8b
.quad 0xbf003f003f00bf00,0xbf003f003f00bf00,0xbe52bf323d8e3f35,0xbee6bf173eab3f27,0x3f323e8bbf17bf00,0x3f17be8bbf32a8c3,0xbee63ec93f2d2782,0x3eab3f323d8ebf27
.quad 0xbe8bbf35be8b3f00,0xbf27a8003f273f00,0x3f343ec9beabbf35,0xbe52bf32bee63e8b,0xbec93e8b3f323f00,0x3f323e8bbec9bf35,0xbeabbf32bf0ca6e0,0x3d8e3f173f2d3e8b
.quad 0x3f353f0028dcbf00,0xbf35bf00273c3f00,0xbeab3e0d3f0c3f35,0x3d8ebec9bf2dbf27,0xbec9bf27bf32bf00,0x3f323f273ec928e2,0x3f343f173eaba610,0xbe523e0d3ee63f27
.quad 0xbe8b273c3e8b3f00,0xbf27bf35bf27bf00,0xbee6bf17bf2dbf35,0x3eab3e0dbd8ebe8b,0x3f323f273f173f00,0x3f173f273f323f35,0xbe52be0dbd8e273c,0xbee6bec9beabbe8b
.quad 0xbf003f003f00bf00,0xbf003f003f00bf00,0xbf20bec93f0c3f00,0xbf34be0d3f2d3e8b,0x3e0dbf27bec93f00,0xbec9bf273e0d3f35,0x3f343e0dbf20bf00,0x3e52bf17bf0c3e8b
.quad 0x3e8b3f353e8bbf00,0x3f2727cebf27bf00,0xbf0c3e0d3f2d3f00,0x3f203f17bd8ebf27,0xbf17bf27be0d3f00,0x3e0d3f273f1727ce,0x3e52bec9bf34bf00,0xbee63e0d3f203f27
.quad 0x3f353f00290abf00,0xbf35bf00a7823f00,0x3e523f173f343f00,0xbee6bf32bf20be8b,0xbf17be8b3e0d3f00,0x3e0dbe8bbf17bf35,0xbf0cbf32bf2dbf00,0x3f203ec93d8ebe8b
.quad 0x3e8b284bbe8bbf00,0x3f273f353f273f00,0x3f343f323f203f00,0x3e523ec93f0c3f27,0x3e0d3e8b3ec93f00,0xbec9be8bbe0d288e,0xbf20bf17bf0cbf00,0xbf34bf32bf2dbf27
.quad 0xbf003f003f00bf00,0xbf003f003f00bf00,0xbf2d3e0d3f34a82b,0xbf0c3ec93f20be8b,0xbf32be8b3f173f00,0xbf173e8b3f32284b,0xbf0cbf173e523f35,0xbf203e0d3f343e8b
.quad 0xbe8bbf35be8b3f00,0xbf27a8dc3f273f00,0x3d8ebf17bf20a782,0xbf2dbe0d3f0c3f27,0x3ec9be8bbf32bf00,0xbf32be8b3ec93f35,0x3f203e0dbee6bf35,0xbf34bec93e523f27
.quad 0x3f353f002898bf00,0xbf35bf0028393f00,0x3f203f323ee62898,0xbf34bf17be523e8b,0x3ec93f273f323f00,0xbf32bf27bec9a94c,0x3d8e3ec93f203f35,0xbf2dbf32bf0cbe8b
.quad 0xbe8ba7b63e8b3f00,0xbf27bf35bf27bf00,0xbf0cbec9be522839,0xbf20bf32bf34bf27,0xbf32bf27bf17bf00,0xbf17bf27bf32bf35,0xbf2dbf32bf34bf35,0xbf0cbf17bf20bf27
.quad 0x3f803f803f803f80,0x3f803f803f803f80,0x3f553f6d3f7b3f80,0xbf55bf6dbf7bbf80,0x3ec43f353f6d3f80,0x3ec43f353f6d3f80,0xbe483ec43f553f80,0x3e48bec4bf55bf80
.quad 0xbf35248d3f353f80,0xbf35261f3f353f80,0xbf7bbec43f0e3f80,0x3f7b3ec4bf0ebf80,0xbf6dbf353ec43f80,0xbf6dbf353ec43f80,0xbf0ebf6d3e483f80,0x3f0e3f6dbe48bf80
.quad 0xa554bf80248d3f80,0xa754bf80a6543f80,0x3f0ebf6dbe483f80,0xbf0e3f6d3e48bf80,0x3f6dbf35bec43f80,0x3f6dbf35bec43f80,0x3f7bbec4bf0e3f80,0xbf7b3ec43f0ebf80
.quad 0x3f35a554bf353f80,0x3f35a777bf353f80,0x3e483ec4bf553f80,0xbe48bec43f55bf80,0xbec43f35bf6d3f80,0xbec43f35bf6d3f80,0xbf553f6dbf7b3f80,0x3f55bf6d3f7bbf80
.quad 0x3f803f803f803f80,0x3f803f803f803f80,0x3e483ec43f0e3f35,0xbe48bec4bf0ebf35,0xbf6dbf35bec4248d,0xbf6dbf35bec425b0,0xbf0ebf6dbf7bbf35,0x3f0e3f6d3f7b3f35
.quad 0x3f35a554bf35bf80,0x3f35a731bf35bf80,0x3f553f6d3e48bf35,0xbf55bf6dbe483f35,0xbec43f353f6da554,0xbec43f353f6da742,0xbf7bbec43f553f35,0x3f7b3ec4bf55bf35
.quad 0xa5f7bf8025b03f80,0xa765bf80a60d3f80,0x3f7bbec4bf553f35,0xbf7b3ec43f55bf35,0x3ec43f35bf6d25b0,0x3ec43f35bf6da58e,0xbf553f6dbe48bf35,0x3f55bf6d3e483f35
.quad 0xbf35261f3f35bf80,0xbf35258d3f35bf80,0x3f0ebf6d3f7bbf35,0xbf0e3f6dbf7b3f35,0x3f6dbf353ec4a5f7,0x3f6dbf353ec4a78d,0xbe483ec4bf0e3f35,0x3e48bec43f0ebf35
.quad 0x3f803f803f803f80,0x3f803f803f803f80,0xbf0ebec4be48248d,0x3f0e3ec43e48a554,0xbec4bf35bf6dbf80,0xbec4bf35bf6dbf80,0x3f7b3f6d3f0ea554,0xbf7bbf6dbf0e261f
.quad 0xbf3525b03f353f80,0xbf35a68d3f353f80,0xbe48bf6dbf5525b0,0x3e483f6d3f55a742,0x3f6d3f35bec4bf80,0x3f6d3f35bec4bf80,0xbf553ec43f7ba5f7,0x3f55bec4bf7ba60d
.quad 0xa731bf80261f3f80,0xa777bf80a58e3f80,0x3f553ec4bf7b261f,0xbf55bec43f7ba777,0xbf6d3f353ec4bf80,0xbf6d3f353ec4bf80,0x3e48bf6d3f55a731,0xbe483f6dbf552804
.quad 0x3f35a742bf353f80,0x3f35a796bf353f80,0xbf7b3f6dbf0ea68d,0x3f7bbf6d3f0e2754,0x3ec4bf353f6dbf80,0x3ec4bf353f6dbf80,0x3f0ebec43e48a742,0xbf0e3ec4be482889
.quad 0x3f803f803f803f80,0x3f803f803f803f80,0xbf7bbf6dbf55bf35,0x3f7b3f6d3f553f35,0x3f6d3f353ec4a554,0x3f6d3f353ec4a5f7,0xbf55bec43e483f35,0x3f553ec4be48bf35
.quad 0x3f35a5f7bf35bf80,0x3f35a742bf35bf80,0xbf0e3ec43f7b3f35,0x3f0ebec4bf7bbf35,0x3ec4bf35bf6d261f,0x3ec4bf35bf6da60d,0xbe483f6d3f0ebf35,0x3e48bf6dbf0e3f35
.quad 0xa742bf80a68d3f80,0xa784bf80a1373f80,0x3e483f6dbf0ebf35,0xbe48bf6d3f0e3f35,0xbec4bf353f6da742,0xbec4bf353f6da78d,0x3f0e3ec4bf7b3f35,0xbf0ebec43f7bbf35
.quad 0xbf35a60d3f35bf80,0xbf35268d3f35bf80,0x3f55bec4be483f35,0xbf553ec43e48bf35,0xbf6d3f35bec4a60d,0xbf6d3f35bec42816,0x3f7bbf6d3f55bf35,0xbf7b3f6dbf553f35
.quad 0xbf803f80bf803f80,0xbf803f80bf803f80,0xbf553f6dbf7b3f80,0x3f55bf6d3f7bbf80,0xbec43f35bf6d3f80,0xbec43f35bf6d3f80,0x3e483ec4bf553f80,0xbe48bec43f55bf80
.quad 0x3f3525b0bf353f80,0x3f35268dbf353f80,0x3f7bbec4bf0e3f80,0xbf7b3ec43f0ebf80,0x3f6dbf35bec43f80,0x3f6dbf35bec43f80,0x3f0ebf6dbe483f80,0xbf0e3f6d3e48bf80
.quad 0x261fbf80a5543f80,0x281fbf80a7b13f80,0xbf0ebf6d3e483f80,0x3f0e3f6dbe48bf80,0xbf6dbf353ec43f80,0xbf6dbf353ec43f80,0xbf7bbec43f0e3f80,0x3f7b3ec4bf0ebf80
.quad 0xbf35a5f73f353f80,0xbf3526d43f353f80,0xbe483ec43f553f80,0x3e48bec4bf55bf80,0x3ec43f353f6d3f80,0x3ec43f353f6d3f80,0x3f553f6d3f7b3f80,0xbf55bf6dbf7bbf80
.quad 0xbf803f80bf803f80,0xbf803f80bf803f80,0xbe483ec4bf0e3f35,0x3e48bec43f0ebf35,0x3f6dbf353ec4261f,0x3f6dbf353ec4268d,0x3f0ebf6d3f7bbf35,0xbf0e3f6dbf7b3f35
.quad 0xbf35a7423f35bf80,0xbf35270d3f35bf80,0xbf553f6dbe48bf35,0x3f55bf6d3e483f35,0x3ec43f35bf6da731,0x3ec43f35bf6da85d,0x3f7bbec4bf553f35,0xbf7b3ec43f55bf35
.quad 0xa60dbf80a7423f80,0x2730bf8026d43f80,0xbf7bbec43f553f35,0x3f7b3ec4bf55bf35,0xbec43f353f6da68d,0xbec43f353f6da7b1,0x3f553f6d3e48bf35,0xbf55bf6dbe483f35
.quad 0x3f35a60dbf35bf80,0x3f352754bf35bf80,0xbf0ebf6dbf7bbf35,0x3f0e3f6d3f7b3f35,0xbf6dbf35bec4a742,0xbf6dbf35bec4a7e5,0x3e483ec43f0e3f35,0xbe48bec4bf0ebf35
.quad 0xbf803f80bf803f80,0xbf803f80bf803f80,0x3f0ebec43e48a654,0xbf0e3ec4be482828,0x3ec4bf353f6dbf80,0x3ec4bf353f6dbf80,0xbf7b3f6dbf0ea754,0x3f7bbf6d3f0e281f
.quad 0x3f35a58ebf353f80,0x3f352828bf353f80,0x3e48bf6d3f55a60d,0xbe483f6dbf5526d4,0xbf6d3f353ec4bf80,0xbf6d3f353ec4bf80,0x3f553ec4bf7ba765,0xbf55bec43f7b2730
.quad 0x258dbf80a7773f80,0x2839bf80a7e53f80,0xbf553ec43f7ba58e,0x3f55bec4bf7ba7e5,0x3f6d3f35bec4bf80,0x3f6d3f35bec4bf80,0xbe48bf6dbf55a777,0x3e483f6d3f552839
.quad 0xbf35a78d3f353f80,0xbf35a8043f353f80,0x3f7b3f6d3f0ea137,0xbf7bbf6dbf0ea880,0xbec4bf35bf6dbf80,0xbec4bf35bf6dbf80,0xbf0ebec4be48a784,0x3f0e3ec43e4828a3
.quad 0xbf803f80bf803f80,0xbf803f80bf803f80,0x3f7bbf6d3f55bf35,0xbf7b3f6dbf553f35,0xbf6d3f35bec4a777,0xbf6d3f35bec426d4,0x3f55bec4be483f35,0xbf553ec43e48bf35
.quad 0xbf35a78d3f35bf80,0xbf35a7e53f35bf80,0x3f0e3ec4bf7b3f35,0xbf0ebec43f7bbf35,0xbec4bf353f6d2804,0xbec4bf353f6d289a,0x3e483f6dbf0ebf35,0xbe48bf6d3f0e3f35
.quad 0x268dbf80a7963f80,0x28a3bf80a8803f80,0xbe483f6d3f0ebf35,0x3e48bf6dbf0e3f35,0x3ec4bf35bf6d2754,0x3ec4bf35bf6d28be,0xbf0e3ec43f7b3f35,0x3f0ebec4bf7bbf35
.quad 0x3f352816bf35bf80,0x3f35a731bf35bf80,0xbf55bec43e483f35,0x3f553ec4be48bf35,0x3f6d3f353ec42889,0x3f6d3f353ec428ea,0xbf7bbf6dbf55bf35,0x3f7b3f6d3f553f35
.quad 0x8000800080008000,0x8000800080008000,0xbf0ebec4be488000,0x3f0e3ec43e48a50d,0xbf6dbf35bec48000,0xbf6dbf35bec4258d,0xbf7bbf6dbf0e8000,0x3f7b3f6d3f0ea5d4
.quad 0xbf35bf80bf358000,0xbf35bf80bf35260d,0xbe48bf6dbf558000,0x3e483f6d3f55a630,0x3ec4bf35bf6d8000,0x3ec4bf35bf6d2654,0x3f55bec4bf7b8000,0xbf553ec43f7ba677
.quad 0x3f80a50dbf808000,0x3f80a69fbf80268d,0x3f553ec4bf7b8000,0xbf55bec43f7ba69f,0x3ec43f35bf6d8000,0x3ec43f35bf6d26b0,0xbe483f6dbf558000,0x3e48bf6d3f55a7b1
.quad 0xbf353f80bf358000,0xbf353f80bf3526d4,0xbf7b3f6dbf0e8000,0x3f7bbf6d3f0e270d,0xbf6d3f35bec48000,0xbf6d3f35bec426f7,0xbf0e3ec4be488000,0x3f0ebec43e48a7c2
.quad 0x8000800080008000,0x8000800080008000,0xbf7bbf6dbf55bf35,0x3f7b3f6d3f553f35,0xbec4bf35bf6dbf80,0xbec4bf35bf6dbf80,0x3f553ec4be48bf35,0xbf55bec43e483f35
.quad 0x3f353f803f35a50d,0x3f353f803f35a630,0xbf0e3ec43f7b3f35,0x3f0ebec4bf7bbf35,0xbf6dbf353ec43f80,0xbf6dbf353ec43f80,0x3e48bf6dbf0e3f35,0xbe483f6d3f0ebf35
.quad 0x3f80a5d4bf80258d,0x3f80a7b1bf8026b0,0x3e483f6dbf0ebf35,0xbe48bf6d3f0e3f35,0xbf6d3f353ec4bf80,0xbf6d3f353ec4bf80,0xbf0ebec43f7bbf35,0x3f0e3ec4bf7b3f35
.quad 0x3f35bf803f35a5d4,0x3f35bf803f35a7c2,0x3f55bec4be483f35,0xbf553ec43e48bf35,0xbec43f35bf6d3f80,0xbec43f35bf6d3f80,0xbf7b3f6dbf553f35,0x3f7bbf6d3f55bf35
.quad 0x8000800080008000,0x8000800080008000,0xbf55bf6dbf7bbf80,0x3f553f6d3f7b3f80,0x3f6d3f353ec4a50d,0x3f6d3f353ec4a5d4,0xbe483ec43f553f80,0x3e48bec4bf55bf80
.quad 0xbf35bf80bf35258d,0xbf35bf80bf352654,0x3f7b3ec4bf0ebf80,0xbf7bbec43f0e3f80,0xbec43f353f6da5d4,0xbec43f353f6da69f,0xbf0ebf6d3e483f80,0x3f0e3f6dbe48bf80
.quad 0x3f80a630bf80260d,0x3f80270dbf8026d4,0xbf0e3f6d3e48bf80,0x3f0ebf6dbe483f80,0xbec4bf353f6da630,0xbec4bf353f6da7c2,0x3f7bbec4bf0e3f80,0xbf7b3ec43f0ebf80
.quad 0xbf353f80bf352654,0xbf353f80bf35271f,0xbe48bec43f55bf80,0x3e483ec4bf553f80,0x3f6dbf353ec4a677,0x3f6dbf353ec4268d,0xbf553f6dbf7b3f80,0x3f55bf6d3f7bbf80
.quad 0x8000800080008000,0x8000800080008000,0xbe48bec4bf0ebf35,0x3e483ec43f0e3f35,0x3ec43f353f6d3f80,0x3ec43f353f6d3f80,0xbf0ebf6dbf7bbf35,0x3f0e3f6d3f7b3f35
.quad 0x3f353f803f35a5d4,0x3f353f803f35a677,0xbf55bf6dbe483f35,0x3f553f6d3e48bf35,0x3f6d3f35bec4bf80,0x3f6d3f35bec4bf80,0xbf7bbec43f553f35,0x3f7b3ec4bf55bf35
.quad 0x3f80a677bf802654,0x3f80a7c2bf8026f7,0xbf7b3ec43f55bf35,0x3f7bbec4bf553f35,0x3f6dbf35bec43f80,0x3f6dbf35bec43f80,0xbf553f6dbe48bf35,0x3f55bf6d3e483f35
.quad 0x3f35bf803f35a69f,0x3f35bf803f35268d,0xbf0e3f6dbf7b3f35,0x3f0ebf6d3f7bbf35,0x3ec4bf353f6dbf80,0x3ec4bf353f6dbf80,0xbe483ec4bf0e3f35,0x3e48bec43f0ebf35
.quad 0xa5d4258da50d8000,0xa7d4271f26d4270d,0x3f0ebec43e488000,0xbf0e3ec4be4826d4,0x3f6dbf353ec48000,0x3f6dbf353ec4271f,0x3f7bbf6d3f0e8000,0xbf7b3f6dbf0ea7d4
.quad 0x3f35bf803f358000,0x3f35bf803f352730,0x3e48bf6d3f558000,0xbe483f6dbf55268d,0xbec4bf353f6d8000,0xbec4bf353f6d2831,0xbf55bec43f7b8000,0x3f553ec4bf7ba7e5
.quad 0xbf80a5d43f808000,0xbf80a7f73f802754,0xbf553ec43f7b8000,0x3f55bec4bf7b260e,0xbec43f353f6d8000,0xbec43f353f6da78d,0x3e483f6d3f558000,0xbe48bf6dbf55a7f7
.quad 0x3f353f803f358000,0x3f353f803f352777,0x3f7b3f6d3f0e8000,0xbf7bbf6dbf0e21b7,0x3f6d3f353ec48000,0x3f6d3f353ec42842,0x3f0e3ec43e488000,0xbf0ebec4be48a804
.quad 0xa6772654a630260d,0xa7e52831268d2730,0x3f7bbf6d3f55bf35,0xbf7b3f6dbf553f35,0x3ec4bf353f6dbf80,0x3ec4bf353f6dbf80,0xbf553ec43e48bf35,0x3f55bec4be483f35
.quad 0xbf353f80bf35a630,0xbf353f80bf35260e,0x3f0e3ec4bf7b3f35,0xbf0ebec43f7bbf35,0x3f6dbf35bec43f80,0x3f6dbf35bec43f80,0xbe48bf6d3f0e3f35,0x3e483f6dbf0ebf35
.quad 0xbf80a69f3f802654,0xbf80a60d3f802842,0xbe483f6d3f0ebf35,0x3e48bf6dbf0e3f35,0x3f6d3f35bec4bf80,0x3f6d3f35bec4bf80,0x3f0ebec4bf7bbf35,0xbf0e3ec43f7b3f35
.quad 0xbf35bf80bf35a677,0xbf35bf80bf35a80d,0xbf55bec43e483f35,0x3f553ec4be48bf35,0x3ec43f353f6d3f80,0x3ec43f353f6d3f80,0x3f7b3f6d3f553f35,0xbf7bbf6dbf55bf35
.quad 0xa7b126b0a69f268d,0xa7f7a78d260e2754,0x3f55bf6d3f7bbf80,0xbf553f6dbf7b3f80,0xbf6d3f35bec4a69f,0xbf6d3f35bec4a7f7,0x3e483ec4bf553f80,0xbe48bec43f55bf80
.quad 0x3f35bf803f3526b0,0x3f35bf803f352842,0xbf7b3ec43f0ebf80,0x3f7bbec4bf0e3f80,0x3ec43f35bf6da7b1,0x3ec43f35bf6da884,0x3f0ebf6dbe483f80,0xbf0e3f6d3e48bf80
.quad 0xbf80a7c23f8026d4,0xbf80a8163f80279f,0x3f0e3f6dbe48bf80,0xbf0ebf6d3e483f80,0x3ec4bf35bf6d270d,0x3ec4bf35bf6d27d4,0xbf7bbec43f0e3f80,0x3f7b3ec4bf0ebf80
.quad 0x3f353f803f3526f7,0x3f353f803f35a70d,0x3e48bec4bf55bf80,0xbe483ec43f553f80,0xbf6dbf35bec4a7c2,0xbf6dbf35bec4a909,0x3f553f6d3f7b3f80,0xbf55bf6dbf7bbf80
.quad 0xa7c226f7270d26d4,0xa804284221b72777,0x3e48bec43f0ebf35,0xbe483ec4bf0e3f35,0xbec43f35bf6d3f80,0xbec43f35bf6d3f80,0x3f0ebf6d3f7bbf35,0xbf0e3f6dbf7b3f35
.quad 0xbf353f80bf35a7c2,0xbf353f80bf35a80d,0x3f55bf6d3e483f35,0xbf553f6dbe48bf35,0xbf6d3f353ec4bf80,0xbf6d3f353ec4bf80,0x3f7bbec4bf553f35,0xbf7b3ec43f55bf35
.quad 0xbf80268d3f80271f,0xbf80a70d3f80a70d,0x3f7b3ec4bf55bf35,0xbf7bbec43f553f35,0xbf6dbf353ec43f80,0xbf6dbf353ec43f80,0x3f553f6d3e48bf35,0xbf55bf6dbe483f35
.quad 0xbf35bf80bf35268d,0xbf35bf80bf35a896,0x3f0e3f6d3f7b3f35,0xbf0ebf6dbf7bbf35,0xbec4bf35bf6dbf80,0xbec4bf35bf6dbf80,0x3e483ec43f0e3f35,0xbe48bec4bf0ebf35
.quad 0x0,0x0,0x3f0e3ec43e480000,0xbf0ebec4be48250d,0x3f6d3f353ec40000,0x3f6d3f353ec4a58d,0x3f7b3f6d3f0e0000,0xbf7bbf6dbf0e25d4
.quad 0x3f353f803f350000,0x3f353f803f35a60d,0x3e483f6d3f550000,0xbe48bf6dbf552630,0xbec43f353f6d0000,0xbec43f353f6da654,0xbf553ec43f7b0000,0x3f55bec4bf7b2677
.quad 0xbf80250d3f800000,0xbf80269f3f80a68d,0xbf55bec43f7b0000,0x3f553ec4bf7b269f,0xbec4bf353f6d0000,0xbec4bf353f6da6b0,0x3e48bf6d3f550000,0xbe483f6dbf5527b1
.quad 0x3f35bf803f350000,0x3f35bf803f35a6d4,0x3f7bbf6d3f0e0000,0xbf7b3f6dbf0ea70d,0x3f6dbf353ec40000,0x3f6dbf353ec4a6f7,0x3f0ebec43e480000,0xbf0e3ec4be4827c2
.quad 0x0,0x0,0x3f7b3f6d3f553f35,0xbf7bbf6dbf55bf35,0x3ec43f353f6d3f80,0x3ec43f353f6d3f80,0xbf55bec43e483f35,0x3f553ec4be48bf35
.quad 0xbf35bf80bf35250d,0xbf35bf80bf352630,0x3f0ebec4bf7bbf35,0xbf0e3ec43f7b3f35,0x3f6d3f35bec4bf80,0x3f6d3f35bec4bf80,0xbe483f6d3f0ebf35,0x3e48bf6dbf0e3f35
.quad 0xbf8025d43f80a58d,0xbf8027b13f80a6b0,0xbe48bf6d3f0e3f35,0x3e483f6dbf0ebf35,0x3f6dbf35bec43f80,0x3f6dbf35bec43f80,0x3f0e3ec4bf7b3f35,0xbf0ebec43f7bbf35
.quad 0xbf353f80bf3525d4,0xbf353f80bf3527c2,0xbf553ec43e48bf35,0x3f55bec4be483f35,0x3ec4bf353f6dbf80,0x3ec4bf353f6dbf80,0x3f7bbf6d3f55bf35,0xbf7b3f6dbf553f35
.quad 0x0,0x0,0x3f553f6d3f7b3f80,0xbf55bf6dbf7bbf80,0xbf6dbf35bec4250d,0xbf6dbf35bec425d4,0x3e48bec4bf55bf80,0xbe483ec43f553f80
.quad 0x3f353f803f35a58d,0x3f353f803f35a654,0xbf7bbec43f0e3f80,0x3f7b3ec4bf0ebf80,0x3ec4bf35bf6d25d4,0x3ec4bf35bf6d269f,0x3f0e3f6dbe48bf80,0xbf0ebf6d3e483f80
.quad 0xbf8026303f80a60d,0xbf80a70d3f80a6d4,0x3f0ebf6dbe483f80,0xbf0e3f6d3e48bf80,0x3ec43f35bf6d2630,0x3ec43f35bf6d27c2,0xbf7b3ec43f0ebf80,0x3f7bbec4bf0e3f80
.quad 0x3f35bf803f35a654,0x3f35bf803f35a71f,0x3e483ec4bf553f80,0xbe48bec43f55bf80,0xbf6d3f35bec42677,0xbf6d3f35bec4a68d,0x3f55bf6d3f7bbf80,0xbf553f6dbf7b3f80
.quad 0x0,0x0,0x3e483ec43f0e3f35,0xbe48bec4bf0ebf35,0xbec4bf35bf6dbf80,0xbec4bf35bf6dbf80,0x3f0e3f6d3f7b3f35,0xbf0ebf6dbf7bbf35
.quad 0xbf35bf80bf3525d4,0xbf35bf80bf352677,0x3f553f6d3e48bf35,0xbf55bf6dbe483f35,0xbf6dbf353ec43f80,0xbf6dbf353ec43f80,0x3f7b3ec4bf55bf35,0xbf7bbec43f553f35
.quad 0xbf8026773f80a654,0xbf8027c23f80a6f7,0x3f7bbec4bf553f35,0xbf7b3ec43f55bf35,0xbf6d3f353ec4bf80,0xbf6d3f353ec4bf80,0x3f55bf6d3e483f35,0xbf553f6dbe48bf35
.quad 0xbf353f80bf35269f,0xbf353f80bf35a68d,0x3f0ebf6d3f7bbf35,0xbf0e3f6dbf7b3f35,0xbec43f35bf6d3f80,0xbec43f35bf6d3f80,0x3e48bec43f0ebf35,0xbe483ec4bf0e3f35
.quad 0x25d4a58d250d0000,0x27d4a71fa6d4a70d,0xbf0e3ec4be480000,0x3f0ebec43e48a6d4,0xbf6d3f35bec40000,0xbf6d3f35bec4a71f,0xbf7b3f6dbf0e0000,0x3f7bbf6d3f0e27d4
.quad 0xbf353f80bf350000,0xbf353f80bf35a730,0xbe483f6dbf550000,0x3e48bf6d3f55a68d,0x3ec43f35bf6d0000,0x3ec43f35bf6da831,0x3f553ec4bf7b0000,0xbf55bec43f7b27e5
.quad 0x3f8025d4bf800000,0x3f8027f7bf80a754,0x3f55bec4bf7b0000,0xbf553ec43f7ba60e,0x3ec4bf35bf6d0000,0x3ec4bf35bf6d278d,0xbe48bf6dbf550000,0x3e483f6d3f5527f7
.quad 0xbf35bf80bf350000,0xbf35bf80bf35a777,0xbf7bbf6dbf0e0000,0x3f7b3f6d3f0ea1b7,0xbf6dbf35bec40000,0xbf6dbf35bec4a842,0xbf0ebec4be480000,0x3f0e3ec43e482804
.quad 0x2677a6542630a60d,0x27e5a831a68da730,0xbf7b3f6dbf553f35,0x3f7bbf6d3f55bf35,0xbec43f35bf6d3f80,0xbec43f35bf6d3f80,0x3f55bec4be483f35,0xbf553ec43e48bf35
.quad 0x3f35bf803f352630,0x3f35bf803f35a60e,0xbf0ebec43f7bbf35,0x3f0e3ec4bf7b3f35,0xbf6d3f353ec4bf80,0xbf6d3f353ec4bf80,0x3e483f6dbf0ebf35,0xbe48bf6d3f0e3f35
.quad 0x3f80269fbf80a654,0x3f80260dbf80a842,0x3e48bf6dbf0e3f35,0xbe483f6d3f0ebf35,0xbf6dbf353ec43f80,0xbf6dbf353ec43f80,0xbf0e3ec43f7b3f35,0x3f0ebec4bf7bbf35
.quad 0x3f353f803f352677,0x3f353f803f35280d,0x3f553ec4be48bf35,0xbf55bec43e483f35,0xbec4bf35bf6dbf80,0xbec4bf35bf6dbf80,0xbf7bbf6dbf55bf35,0x3f7b3f6d3f553f35
.quad 0x27b1a6b0269fa68d,0x27f7278da60ea754,0xbf553f6dbf7b3f80,0x3f55bf6d3f7bbf80,0x3f6dbf353ec4269f,0x3f6dbf353ec427f7,0xbe48bec43f55bf80,0x3e483ec4bf553f80
.quad 0xbf353f80bf35a6b0,0xbf353f80bf35a842,0x3f7bbec4bf0e3f80,0xbf7b3ec43f0ebf80,0xbec4bf353f6d27b1,0xbec4bf353f6d2884,0xbf0e3f6d3e48bf80,0x3f0ebf6dbe483f80
.quad 0x3f8027c2bf80a6d4,0x3f802816bf80a79f,0xbf0ebf6d3e483f80,0x3f0e3f6dbe48bf80,0xbec43f353f6da70d,0xbec43f353f6da7d4,0x3f7b3ec4bf0ebf80,0xbf7bbec43f0e3f80
.quad 0xbf35bf80bf35a6f7,0xbf35bf80bf35270d,0xbe483ec43f553f80,0x3e48bec4bf55bf80,0x3f6d3f353ec427c2,0x3f6d3f353ec42909,0xbf55bf6dbf7bbf80,0x3f553f6d3f7b3f80
.quad 0x27c2a6f7a70da6d4,0x2804a842a1b7a777,0xbe483ec4bf0e3f35,0x3e48bec43f0ebf35,0x3ec4bf353f6dbf80,0x3ec4bf353f6dbf80,0xbf0e3f6dbf7b3f35,0x3f0ebf6d3f7bbf35
.quad 0x3f35bf803f3527c2,0x3f35bf803f35280d,0xbf553f6dbe48bf35,0x3f55bf6d3e483f35,0x3f6dbf35bec43f80,0x3f6dbf35bec43f80,0xbf7b3ec43f55bf35,0x3f7bbec4bf553f35
.quad 0x3f80a68dbf80a71f,0x3f80270dbf80270d,0xbf7bbec43f553f35,0x3f7b3ec4bf55bf35,0x3f6d3f35bec4bf80,0x3f6d3f35bec4bf80,0xbf55bf6dbe483f35,0x3f553f6d3e48bf35
.quad 0x3f353f803f35a68d,0x3f353f803f352896,0xbf0ebf6dbf7bbf35,0x3f0e3f6d3f7b3f35,0x3ec43f353f6d3f80,0x3ec43f353f6d3f80,0xbe48bec4bf0ebf35,0x3e483ec43f0e3f35
.quad 0x3f8000003f800000,0x3f8000003f800000,0x3f7fffb13f800000,0x3f7ffd393f7ffec4,0x3f7ffec43f800000,0x3f7ff4e63f7ffb11,0x3f7ffd393f800000,0x3f7fe7053f7ff4e6
.quad 0x3f7ffb113f800000,0x3f7fd3973f7fec43,0x3f7ff84a3f800000,0x3f7fba9e3f7fe129,0x3f7ff4e63f800000,0x3f7f9c183f7fd397,0x3f7ff0e33f800000,0x3f7f78083f7fc38f
.quad 0x3f7fec433f800000,0x3f7f4e6d3f7fb10f,0x3f7fe7053f800000,0x3f7f1f493f7f9c18,0x3f7fe1293f800000,0x3f7eea9d3f7f84ab,0x3f7fdaaf3f800000,0x3f7eb0693f7f6ac7
.quad 0x3f7fd3973f800000,0x3f7e70b03f7f4e6d,0x3f7fcbe23f800000,0x3f7e2b723f7f2f9d,0x3f7fc38f3f800000,0x3f7de0b13f7f0e58,0x3f7fba9e3f800000,0x3f7d906e3f7eea9d
.quad 0x3f8000003f800000,0x3f8000003f800000,0x3f7ff84a3f7ffb11,0x3f7ff0e33f7ff4e6,0x3f7fe1293f7fec43,0x3f7fc38f3f7fd397,0x3f7fba9e3f7fd397,0x3f7f78083f7f9c18
.quad 0x3f7f84ab3f7fb10f,0x3f7f0e583f7f4e6d,0x3f7f3f543f7f84ab,0x3f7e868b3f7eea9d,0x3f7eea9d3f7f4e6d,0x3f7de0b13f7e70b0,0x3f7e868b3f7f0e58,0x3f7d1cdd3f7de0b1
.quad 0x3f7e13243f7ec46d,0x3f7c3b283f7d3aac,0x3f7d906e3f7e70b0,0x3f7b3bab3f7c7eb0,0x3f7cfe733f7e1324,0x3f7a1e843f7baccd,0x3f7c5d3a3f7dabcc,0x3f78e3d63f7ac516
.quad 0x3f7baccd3f7d3aac,0x3f778bc53f79c79d,0x3f7aed373f7cbfc9,0x3f76167a3f78b47b,0x3f7a1e843f7c3b28,0x3f7484223f778bc5,0x3f7940c03f7baccd,0x3f72d4eb3f764d97
.quad 0x3f8000003f800000,0x3f8000003f800000,0x3f7fe7053f7fec43,0x3f7fdaaf3f7fe129,0x3f7f9c183f7fb10f,0x3f7f6ac73f7f84ab,0x3f7f1f493f7f4e6d,0x3f7eb0693f7eea9d
.quad 0x3f7e70b03f7ec46d,0x3f7dabcc3f7e1324,0x3f7d906e3f7e1324,0x3f7c5d3a3f7cfe73,0x3f7c7eb03f7d3aac,0x3f7ac5163f7baccd,0x3f7b3bab3f7c3b28,0x3f78e3d63f7a1e84
.quad 0x3f79c79d3f7b14be,0x3f76ba073f7853f8,0x3f7822d13f79c79d,0x3f74484b3f764d97,0x3f764d973f7853f8,0x3f718f573f740bdd,0x3f74484b3f76ba07,0x3f6e8ff83f718f57
.quad 0x3f7213523f74fa0b,0x3f6b4b0c3f6ed89e,0x3f6faf1b3f731447,0x3f67c1873f6be858,0x3f6d1c1d3f710908,0x3f63f4733f68bf3c,0x3f6a5ad93f6ed89e,0x3f5fe4e93f655e0b
.quad 0x3f8000003f800000,0x3f8000003f800000,0x3f7fcbe23f7fd397,0x3f7fba9e3f7fc38f,0x3f7f2f9d3f7f4e6d,0x3f7eea9d3f7f0e58,0x3f7e2b723f7e70b0,0x3f7d906e3f7de0b1
.quad 0x3f7cbfc93f7d3aac,0x3f7baccd3f7c3b28,0x3f7aed373f7baccd,0x3f7940c03f7a1e84,0x3f78b47b3f79c79d,0x3f764d973f778bc5,0x3f76167a3f778bc5,0x3f72d4eb3f748422
.quad 0x3f7314473f74fa0b,0x3f6ed89e3f710908,0x3f6faf1b3f721352,0x3f6a5ad93f6d1c1d,0x3f6be8583f6ed89e,0x3f655e0b3f68bf3c,0x3f67c1873f6b4b0c,0x3f5fe4e93f63f473
.quad 0x3f633c5a3f676bd8,0x3f59f26a3f5ebe05,0x3f5e5aa63f633c5a,0x3f5389c73f591e6a,0x3f591e6a3f5ebe05,0x3f4cae793f531849,0x3f5389c73f59f26a,0x3f4564393f4cae79
.quad 0x8000000080000000,0x8000000080000000,0xbb490fc680000000,0xbc16cb58bbc90f88,0xbbc90f8880000000,0xbc96c9b6bc490e90,0xbc16cb5880000000,0xbce22a7abc96c9b6
.quad 0xbc490e9080000000,0xbd16c32cbcc90ab0,0xbc7b514b80000000,0xbd3c6dd5bcfb49ba,0xbc96c9b680000000,0xbd621469bd16c32c,0xbcafea6980000000,0xbd83db0abd2fe007
.quad 0xbcc90ab080000000,0xbd96a905bd48fb30,0xbce22a7a80000000,0xbda973babd621469,0xbcfb49ba80000000,0xbdbc3ac3bd7b2b74,0xbd0a342f80000000,0xbdcefdb7bd8a200a
.quad 0xbd16c32c80000000,0xbde1bc2ebd96a905,0xbd2351cb80000000,0xbdf475c0bda3308c,0xbd2fe00780000000,0xbe039502bdafb680,0xbd3c6dd580000000,0xbe0cec4abdbc3ac3
.quad 0x8000000080000000,0x8000000080000000,0xbc7b514bbc490e90,0xbcafea69bc96c9b6,0xbcfb49babcc90ab0,0xbd2fe007bd16c32c,0xbd3c6dd5bd16c32c,0xbd83db0abd621469
.quad 0xbd7b2b74bd48fb30,0xbdafb680bd96a905,0xbd9cecf9bd7b2b74,0xbddb7d37bdbc3ac3,0xbdbc3ac3bd96a905,0xbe039502bde1bc2e,0xbddb7d37bdafb680,0xbe195be0be039502
.quad 0xbdfab273bdc8bd36,0xbe2f10a2be164083,0xbe0cec4abde1bc2e,0xbe44b0b9be28defc,0xbe1c76debdfab273,0xbe5a3997be3b6ecf,0xbe2bf804be09cf86,0xbe6fa8b2be4dee60
.quad 0xbe3b6ecfbe164083,0xbe827dc0be605c13,0xbe4ada4fbe22abb6,0xbe8d17c0be72b651,0xbe5a3997be2f10a2,0xbe97a117be827dc0,0xbe698bbabe3b6ecf,0xbea21887be8b9507
.quad 0x8000000080000000,0x8000000080000000,0xbce22a7abcc90ab0,0xbd0a342fbcfb49ba,0xbd621469bd48fb30,0xbd8a200abd7b2b74,0xbda973babd96a905,0xbdcefdb7bdbc3ac3
.quad 0xbde1bc2ebdc8bd36,0xbe09cf86bdfab273,0xbe0cec4abdfab273,0xbe2bf804be1c76de,0xbe28defcbe164083,0xbe4dee60be3b6ecf,0xbe44b0b9be2f10a2,0xbe6fa8b2be5a3997
.quad 0xbe605c13be47c5c2,0xbe888e93be78cfcc,0xbe7bdba4be605c13,0xbe9920febe8b9507,0xbe8b9507be78cfcc,0xbea986c4be9aa086,0xbe9920febe888e93,0xbeb9bb1ebea986c4
.quad 0xbea68f12be94a031,0xbec9b953beb8442a,0xbeb3dca5bea09ae5,0xbed97cb9bec6d529,0xbec1071ebeac7cd4,0xbee900b7bed53641,0xbece0beabeb8442a,0xbef840c8bee363fa
.quad 0x8000000080000000,0x8000000080000000,0xbd2351cbbd16c32c,0xbd3c6dd5bd2fe007,0xbda3308cbd96a905,0xbdbc3ac3bdafb680,0xbdf475c0bde1bc2e,0xbe0cec4abe039502
.quad 0xbe22abb6be164083,0xbe3b6ecfbe2f10a2,0xbe4ada4fbe3b6ecf,0xbe698bbabe5a3997,0xbe72b651be605c13,0xbe8b9507be827dc0,0xbe8d17c0be827dc0,0xbea21887be97a117
.quad 0xbea09ae5be94a031,0xbeb8442abeac7cd4,0xbeb3dca5bea68f12,0xbece0beabec1071e,0xbec6d529beb8442a,0xbee363fabed53641,0xbed97cb9bec9b953,0xbef840c8bee900b7
.quad 0xbeebcbbbbedae880,0xbf064b82befc5d27,0xbefdbabbbeebcbbb,0xbf102dd5bf07a136,0xbf07a136befc5d27,0xbf19c200bf10d3cd,0xbf102dd5bf064b82,0xbf2302d3bf19c200
.quad 0x3f8000003f800000,0x3f8000003f800000,0x3f7fa6e33f7fb10f,0x3f7f90b13f7f9c18,0x3f7e9bc93f7ec46d,0x3f7e43233f7e70b0,0x3f7cdf6c3f7d3aac,0x3f7c187a3f7c7eb0
.quad 0x3f7a73023f7b14be,0x3f7912983f79c79d,0x3f77583a3f7853f8,0x3f75341d3f764d97,0x3f73913f3f74fa0b,0x3f7080663f721352,0x3f6f20b03f710908,0x3f6afb8c3f6d1c1d
.quad 0x3f6a09a73f6c835e,0x3f64aa593f676bd8,0x3f644fac3f676bd8,0x3f5d924d3f6106f2,0x3f5df6be3f61c598,0x3f55b9933f59f26a,0x3f5703483f5b941a,0x3f4d26fd3f5233c6
.quad 0x3f4f7a1f3f54db31,0x3f43e2003f49d112,0x3f4760853f4d9f02,0x3f39f2ac3f40d0da,0x3f3ebc1b3f45e403,0x3f2f61a53f373a23,0x3f3592e73f3daef9,0x3f24381a3f2d1469
.quad 0x3f8000003f800000,0x3f8000003f800000,0x3f7f78083f7f84ab,0x3f7f5ce93f7f6ac7,0x3f7de0b13f7e1324,0x3f7d74743f7dabcc,0x3f7b3bab3f7baccd,0x3f7a49103f7ac516
.quad 0x3f778bc53f7853f8,0x3f75dec63f76ba07,0x3f72d4eb3f740bdd,0x3f703b373f718f57,0x3f6d1c1d3f6ed89e,0x3f6965913f6b4b0c,0x3f6667713f68bf3c,0x3f61668a3f63f473
.quad 0x3f5ebe053f61c598,0x3f5848533f5b941a,0x3f5627fe3f59f26a,0x3f4e16893f5233c6,0x3f4cae793f514d3d,0x3f42de293f47de65,0x3f425b893f47de65,0x3f36ad7f3f3ca003
.quad 0x3f373a233f3daef9,0x3f2994153f3085bb,0x3f2b561b3f32c8c9,0x3f1ba2993f239da9,0x3f1ebc123f273656,0x3f0cead03f15f6d9,0x3f11796b3f1b02c6,0x3efafef73f07a136
.quad 0x3f8000003f800000,0x3f8000003f800000,0x3f7f3f543f7f4e6d,0x3f7f1f493f7f2f9d,0x3f7cfe733f7d3aac,0x3f7c7eb03f7cbfc9,0x3f7940c03f79c79d,0x3f7822d13f78b47b
.quad 0x3f740bdd3f74fa0b,0x3f7213523f731447,0x3f6d67a13f6ed89e,0x3f6a5ad93f6be858,0x3f655e0b3f676bd8,0x3f6106f23f633c5a,0x3f5bfb343f5ebe05,0x3f5627fe3f591e6a
.quad 0x3f514d3d3f54db31,0x3f49d1123f4d9f02,0x3f4564393f49d112,0x3f3c17d93f40d0da,0x3f3852163f3daef9,0x3f2d14693f32c8c9,0x3f2a2a803f3085bb,0x3f1ce11f3f239da9
.quad 0x3f1b02c63f226799,0x3f0b9a6b3f13682a,0x3f0af1b73f13682a,0x3ef2bd433f0242b1,0x3ef41f073f039c3d,0x3ecc9b8b3ee0924f,0x3ed0eb2a3ee63375,0x3ea5129f3ebb31a0
.quad 0x3f8000003f800000,0x3f8000003f800000,0x3f7efcc93f7f0e58,0x3f7ed7d43f7eea9d,0x3f7bf5313f7c3b28,0x3f7b61fc3f7baccd,0x3f76ef5b3f778bc5,0x3f75a67b3f764d97
.quad 0x3f6ff5733f710908,0x3f6db2933f6ed89e,0x3f6715993f68bf3c,0x3f6398ac3f655e0b,0x3f5c61c73f5ebe05,0x3f5770263f59f26a,0x3f4fefa83f531849,0x3f4955213f4cae79
.quad 0x3f41d8703f45e403,0x3f3968423f3daef9,0x3f3238aa3f373a23,0x3f27ce613f2d1469,0x3f212ff93f273656,0x3f14b0393f1b02c6,0x3f0ee0db3f15f6d9,0x3f003a063f07a136
.quad 0x3ef6e0cb3f039c3d,0x3ed536413ee63375,0x3ece0bea3ee0924f,0x3ea80b1f3ebb31a0,0x3ea395c53eb8442a,0x3e72b6513e8e9a22,0x3e6fa8b23e8e9a22,0x3e1324ca3e419b37
.quad 0x8000000080000000,0x8000000080000000,0xbd55880ebd48fb30,0xbd6ea038bd621469,0xbdd53db9bdc8bd36,0xbdee3876bde1bc2e,0xbe1f917bbe164083,0xbe3228d4be28defc
.quad 0xbe541501be47c5c2,0xbe6c9a7fbe605c13,0xbe840270be78cfcc,0xbe931f35be8b9507,0xbe9d9e78be94a031,0xbeaf713abea68f12,0xbeb6ccc3beac7cd4,0xbecb2aaebec1071e
.quad 0xbecf7bcabec3ef15,0xbee63375bedae880,0xbee79a5dbedae880,0xbf003a06bef41f07,0xbeff17b2bef15aea,0xbf0cead0bf064b82,0xbf0af1b7bf039c3d,0xbf19210fbf121eb0
.quad 0xbf15f6d9bf0e39da,0xbf24d225bf1d7fd1,0xbf209393bf187fc0,0xbf2ff3e6bf286605,0xbf2ac082bf226799,0xbf3a7ca4bf32c8c9,0xbf34768fbf2beb4a,0xbf446337bf3ca003
.quad 0x8000000080000000,0x8000000080000000,0xbd83db0abd7b2b74,0xbd9064b4bd8a200a,0xbe039502bdfab273,0xbe1008b7be09cf86,0xbe44b0b9be3b6ecf,0xbe57278fbe4dee60
.quad 0xbe827dc0be78cfcc,0xbe8e9a22be888e93,0xbea21887be9aa086,0xbeb0eacbbea986c4,0xbec1071ebeb8442a,0xbed25a09bec9b953,0xbedf28a9bed53641,0xbef2bd43bee900b7
.quad 0xbefc5d27bef15aea,0xbf08f59bbf039c3d,0xbf0c42c9bf064b82,0xbf17de12bf121eb0,0xbf19c200bf13682a,0xbf26050abf1ff6cb,0xbf269de3bf1ff6cb,0xbf33587abf2d1469
.quad 0xbf32c8c9bf2beb4a,0xbf3fc767bf396842,0xbf3e35c5bf373a23,0xbf4b41fabf44e3f5,0xbf48d8b3bf41d870,0xbf55b993bf4f7a1f,0xbf52a649bf4bbbf8,0xbf5f20dbbf591e6a
.quad 0x8000000080000000,0x8000000080000000,0xbd9cecf9bd96a905,0xbda973babda3308c,0xbe1c76debe164083,0xbe28defcbe22abb6,0xbe698bbabe605c13,0xbe7bdba4be72b651
.quad 0xbe9aa086be94a031,0xbea68f12bea09ae5,0xbebf926fbeb8442a,0xbece0beabec6d529,0xbee363fabedae880,0xbef41f07beebcbbb,0xbf02ef9fbefc5d27,0xbf0c42c9bf07a136
.quad 0xbf13682abf0e39da,0xbf1d7fd1bf187fc0,0xbf2302d3bf1d7fd1,0xbf2da859bf286605,0xbf31a81dbf2beb4a,0xbf3ca003bf373a23,0xbf3f41fcbf396842,0xbf4a4c87bf44e3f5
.quad 0xbf4bbbf8bf45e403,0xbf5695e5bf514d3d,0xbf570348bf514d3d,0xbf61668abf5c61c7,0xbf6106f2bf5b941a,0xbf6aab7bbf660f88,0xbf69b7e4bf64aa59,0xbf725470bf6e46be
.quad 0x8000000080000000,0x8000000080000000,0xbdb5f8dabdafb680,0xbdc27c39bdbc3ac3,0xbe354098be2f10a2,0xbe419b37be3b6ecf,0xbe870adabe827dc0,0xbe901c2cbe8b9507
.quad 0xbeb263efbeac7cd4,0xbebe1d4abeb8442a,0xbedc53c1bed53641,0xbeea6681bee363fa,0xbf0242b1befc5d27,0xbf0a48adbf064b82,0xbf1553b7bf10d3cd,0xbf1e1e22bf19c200
.quad 0xbf273656bf226799,0xbf3085bbbf2beb4a,0xbf37c655bf32c8c9,0xbf4154e1bf3ca003,0xbf46e22abf41d870,0xbf5064afbf4bbbf8,0xbf546b3bbf4f7a1f,0xbf5d924dbf591e6a
.quad 0xbf604621bf5b941a,0xbf68bf3cbf64aa59,0xbf6a5ad9bf660f88,0xbf71d19fbf6e46be,0xbf7294f8bf6ed89e,0xbf78b47bbf75dec6,0xbf78e3d6bf75dec6,0xbf7d57debf7b61fc
.quad 0x3f7fb10f3f800000,0x3f7d3aac3f7ec46d,0x3f7fa6e33f800000,0x3f7cdf6c3f7e9bc9,0x3f7f9c183f800000,0x3f7c7eb03f7e70b0,0x3f7f90b13f800000,0x3f7c187a3f7e4323
.quad 0x3f7f84ab3f800000,0x3f7baccd3f7e1324,0x3f7f78083f800000,0x3f7b3bab3f7de0b1,0x3f7f6ac73f800000,0x3f7ac5163f7dabcc,0x3f7f5ce93f800000,0x3f7a49103f7d7474
.quad 0x3f7f4e6d3f800000,0x3f79c79d3f7d3aac,0x3f7f3f543f800000,0x3f7940c03f7cfe73,0x3f7f2f9d3f800000,0x3f78b47b3f7cbfc9,0x3f7f1f493f800000,0x3f7822d13f7c7eb0
.quad 0x3f7f0e583f800000,0x3f778bc53f7c3b28,0x3f7efcc93f800000,0x3f76ef5b3f7bf531,0x3f7eea9d3f800000,0x3f764d973f7baccd,0x3f7ed7d43f800000,0x3f75a67b3f7b61fc
.quad 0x3f7853f83f7b14be,0x3f7109083f74fa0b,0x3f77583a3f7a7302,0x3f6f20b03f73913f,0x3f764d973f79c79d,0x3f6d1c1d3f721352,0x3f75341d3f791298,0x3f6afb8c3f708066
.quad 0x3f740bdd3f7853f8,0x3f68bf3c3f6ed89e,0x3f72d4eb3f778bc5,0x3f6667713f6d1c1d,0x3f718f573f76ba07,0x3f63f4733f6b4b0c,0x3f703b373f75dec6,0x3f61668a3f696591
.quad 0x3f6ed89e3f74fa0b,0x3f5ebe053f676bd8,0x3f6d67a13f740bdd,0x3f5bfb343f655e0b,0x3f6be8583f731447,0x3f591e6a3f633c5a,0x3f6a5ad93f721352,0x3f5627fe3f6106f2
.quad 0x3f68bf3c3f710908,0x3f5318493f5ebe05,0x3f6715993f6ff573,0x3f4fefa83f5c61c7,0x3f655e0b3f6ed89e,0x3f4cae793f59f26a,0x3f6398ac3f6db293,0x3f4955213f577026
.quad 0x3f676bd83f6c835e,0x3f5b941a3f61c598,0x3f644fac3f6a09a7,0x3f5703483f5df6be,0x3f6106f23f676bd8,0x3f5233c63f59f26a,0x3f5d924d3f64aa59,0x3f4d26fd3f55b993
.quad 0x3f59f26a3f61c598,0x3f47de653f514d3d,0x3f5627fe3f5ebe05,0x3f425b893f4cae79,0x3f5233c63f5b941a,0x3f3ca0033f47de65,0x3f4e16893f584853,0x3f36ad7f3f42de29
.quad 0x3f49d1123f54db31,0x3f3085bb3f3daef9,0x3f4564393f514d3d,0x3f2a2a803f385216,0x3f40d0da3f4d9f02,0x3f239da93f32c8c9,0x3f3c17d93f49d112,0x3f1ce11f3f2d1469
.quad 0x3f373a233f45e403,0x3f15f6d93f273656,0x3f3238aa3f41d870,0x3f0ee0db3f212ff9,0x3f2d14693f3daef9,0x3f07a1363f1b02c6,0x3f27ce613f396842,0x3f003a063f14b039
.quad 0x3f4d9f023f54db31,0x3f3daef93f45e403,0x3f4760853f4f7a1f,0x3f3592e73f3ebc1b,0x3f40d0da3f49d112,0x3f2d14693f373a23,0x3f39f2ac3f43e200,0x3f24381a3f2f61a5
.quad 0x3f32c8c93f3daef9,0x3f1b02c63f273656,0x3f2b561b3f373a23,0x3f11796b3f1ebc12,0x3f239da93f3085bb,0x3f07a1363f15f6d9,0x3f1ba2993f299415,0x3efafef73f0cead0
.quad 0x3f13682a3f226799,0x3ee633753f039c3d,0x3f0af1b73f1b02c6,0x3ed0eb2a3ef41f07,0x3f0242b13f13682a,0x3ebb31a03ee0924f,0x3ef2bd433f0b9a6b,0x3ea5129f3ecc9b8b
.quad 0x3ee0924f3f039c3d,0x3e8e9a223eb8442a,0x3ece0bea3ef6e0cb,0x3e6fa8b23ea395c5,0x3ebb31a03ee63375,0x3e419b373e8e9a22,0x3ea80b1f3ed53641,0x3e1324ca3e72b651
.quad 0xbd48fb3080000000,0xbe164083bdc8bd36,0xbd55880e80000000,0xbe1f917bbdd53db9,0xbd62146980000000,0xbe28defcbde1bc2e,0xbd6ea03880000000,0xbe3228d4bdee3876
.quad 0xbd7b2b7480000000,0xbe3b6ecfbdfab273,0xbd83db0a80000000,0xbe44b0b9be039502,0xbd8a200a80000000,0xbe4dee60be09cf86,0xbd9064b480000000,0xbe57278fbe1008b7
.quad 0xbd96a90580000000,0xbe605c13be164083,0xbd9cecf980000000,0xbe698bbabe1c76de,0xbda3308c80000000,0xbe72b651be22abb6,0xbda973ba80000000,0xbe7bdba4be28defc
.quad 0xbdafb68080000000,0xbe827dc0be2f10a2,0xbdb5f8da80000000,0xbe870adabe354098,0xbdbc3ac380000000,0xbe8b9507be3b6ecf,0xbdc27c3980000000,0xbe901c2cbe419b37
.quad 0xbe78cfccbe47c5c2,0xbeac7cd4be94a031,0xbe840270be541501,0xbeb6ccc3be9d9e78,0xbe8b9507be605c13,0xbec1071ebea68f12,0xbe931f35be6c9a7f,0xbecb2aaebeaf713a
.quad 0xbe9aa086be78cfcc,0xbed53641beb8442a,0xbea21887be827dc0,0xbedf28a9bec1071e,0xbea986c4be888e93,0xbee900b7bec9b953,0xbeb0eacbbe8e9a22,0xbef2bd43bed25a09
.quad 0xbeb8442abe94a031,0xbefc5d27bedae880,0xbebf926fbe9aa086,0xbf02ef9fbee363fa,0xbec6d529bea09ae5,0xbf07a136beebcbbb,0xbece0beabea68f12,0xbf0c42c9bef41f07
.quad 0xbed53641beac7cd4,0xbf10d3cdbefc5d27,0xbedc53c1beb263ef,0xbf1553b7bf0242b1,0xbee363fabeb8442a,0xbf19c200bf064b82,0xbeea6681bebe1d4a,0xbf1e1e22bf0a48ad
.quad 0xbedae880bec3ef15,0xbf039c3dbef15aea,0xbee79a5dbecf7bca,0xbf0af1b7beff17b2,0xbef41f07bedae880,0xbf121eb0bf064b82,0xbf003a06bee63375,0xbf19210fbf0cead0
.quad 0xbf064b82bef15aea,0xbf1ff6cbbf13682a,0xbf0c42c9befc5d27,0xbf269de3bf19c200,0xbf121eb0bf039c3d,0xbf2d1469bf1ff6cb,0xbf17de12bf08f59b,0xbf33587abf26050a
.quad 0xbf1d7fd1bf0e39da,0xbf396842bf2beb4a,0xbf2302d3bf13682a,0xbf3f41fcbf31a81d,0xbf286605bf187fc0,0xbf44e3f5bf373a23,0xbf2da859bf1d7fd1,0xbf4a4c87bf3ca003
.quad 0xbf32c8c9bf226799,0xbf4f7a1fbf41d870,0xbf37c655bf273656,0xbf546b3bbf46e22a,0xbf3ca003bf2beb4a,0xbf591e6abf4bbbf8,0xbf4154e1bf3085bb,0xbf5d924dbf5064af
.quad 0xbf187fc0bf0e39da,0xbf2beb4abf226799,0xbf209393bf15f6d9,0xbf34768fbf2ac082,0xbf286605bf1d7fd1,0xbf3ca003bf32c8c9,0xbf2ff3e6bf24d225,0xbf446337bf3a7ca4
.quad 0xbf373a23bf2beb4a,0xbf4bbbf8bf41d870,0xbf3e35c5bf32c8c9,0xbf52a649bf48d8b3,0xbf44e3f5bf396842,0xbf591e6abf4f7a1f,0xbf4b41fabf3fc767,0xbf5f20dbbf55b993
.quad 0xbf514d3dbf45e403,0xbf64aa59bf5b941a,0xbf570348bf4bbbf8,0xbf69b7e4bf6106f2,0xbf5c61c7bf514d3d,0xbf6e46bebf660f88,0xbf61668abf5695e5,0xbf725470bf6aab7b
.quad 0xbf660f88bf5b941a,0xbf75dec6bf6ed89e,0xbf6a5ad9bf604621,0xbf78e3d6bf7294f8,0xbf6e46bebf64aa59,0xbf7b61fcbf75dec6,0xbf71d19fbf68bf3c,0xbf7d57debf78b47b
.quad 0x3f2beb4a3f3504f3,0x3f187fc03f226799,0x3f21cbfb3f2beb4a,0x3f0c42c93f173c07,0x3f173c073f226799,0x3eff17b23f0b9a6b,0x3f0c42c93f187fc0,0x3ee4cbfe3eff17b2
.quad 0x3f00e7e43f0e39da,0x3ec9b9533ee63375,0x3eea66813f039c3d,0x3eadf73c3ecc9b8b,0x3ed25a093ef15aea,0x3e919ddd3eb263ef,0x3eb9bb1e3edae880,0x3e698bba3e97a117
.quad 0x3ea09ae53ec3ef15,0x3e2f10a23e78cfcc,0x3e870ada3eac7cd4,0x3de7fa9a3e419b37,0x3e5a39973e94a031,0x3d6214693e09cf86,0x3e25c58c3e78cfcc,0xbb490fc63da3308c
.quad 0x3de1bc2e3e47c5c2,0xbd7b2b743cc90ab0,0x3d6ea0383e164083,0xbdf475c0bcfb49ba,0x3bc90f883dc8bd36,0xbe354098bdafb680,0xbd3c6dd53d48fb30,0xbe6fa8b2be1008b7
.quad 0x3f039c3d3f0e39da,0x3edae8803ef15aea,0x3eea66813f00e7e4,0x3eb9bb1e3ed25a09,0x3ecc9b8b3ee63375,0x3e97a1173eb263ef,0x3eadf73c3ec9b953,0x3e698bba3e919ddd
.quad 0x3e8e9a223eac7cd4,0x3e22abb63e605c13,0x3e5d4b1a3e8e9a22,0x3db5f8da3e1c76de,0x3e1c76de3e605c13,0x3c96c9b63dafb680,0x3db5f8da3e22abb6,0xbd55880e3c96c9b6
.quad 0x3cc90ab03dc8bd36,0xbdfab273bd48fb30,0xbd2351cb3d16c32c,0xbe44b0b9bdee3876,0xbdd53db9bcc90ab0,0xbe8586cebe3b6ecf,0xbe2bf804bdafb680,0xbea80b1fbe7ee6e1
.quad 0xbe6c9a7fbe164083,0xbec9b953bea09ae5,0xbe9620d2be541501,0xbeea6681bec1071e,0xbeb554ecbe888e93,0xbf04f484bee0924f,0xbed3c867bea68f12,0xbf140c5fbeff17b2
.quad 0x3eac7cd43ec3ef15,0x3e78cfcc3e94a031,0x3e870ada3ea09ae5,0x3e25c58c3e5a3997,0x3e419b373e78cfcc,0x3da3308c3e09cf86,0x3de7fa9a3e2f10a2,0xbb490fc63d621469
.quad 0x3d16c32c3dc8bd36,0xbdafb680bcc90ab0,0xbd2351cb3cc90ab0,0xbe2bf804bdd53db9,0xbdee3876bd48fb30,0xbe7ee6e1be3b6ecf,0xbe44b0b9bdfab273,0xbea80b1fbe8586ce
.quad 0xbe888e93be47c5c2,0xbecf7bcabeac7cd4,0xbeadf73cbe888e93,0xbef58035bed25a09,0xbed25a09beac7cd4,0xbf0cead0bef6e0cb,0xbef58035becf7bca,0xbf1e1e22bf0cead0
.quad 0xbf0b9a6bbef15aea,0xbf2e3bdebf1d7fd1,0xbf1ba299bf08f59b,0xbf3d27b8bf2d1469,0xbf2ac082bf187fc0,0xbf4ac77fbf3b8f3b,0xbf38dd65bf273656,0xbf570348bf48d8b3
.quad 0x3e1640833e47c5c2,0x3d48fb303dc8bd36,0x3d6ea0383de1bc2e,0xbd3c6dd53bc90f88,0xbcfb49ba3cc90ab0,0xbe1008b7bdafb680,0xbdf475c0bd7b2b74,0xbe6fa8b2be354098
.quad 0xbe541501be164083,0xbea68f12be888e93,0xbe9620d2be6c9a7f,0xbed3c867beb554ec,0xbec1071ebea09ae5,0xbeff17b2bee0924f,0xbeea6681bec9b953,0xbf140c5fbf04f484
.quad 0xbf08f59bbef15aea,0xbf273656bf187fc0,0xbf1ba299bf0b9a6b,0xbf38dd65bf2ac082,0xbf2d1469bf1d7fd1,0xbf48d8b3bf3b8f3b,0xbf3d27b8bf2e3bde,0xbf570348bf4ac77f
.quad 0xbf4bbbf8bf3daef9,0xbf633c5abf584853,0xbf58b3a1bf4bbbf8,0xbf6d67a1bf63f473,0xbf63f473bf584853,0xbf756d97bf6db293,0xbf6d67a1bf633c5a,0xbf7b3babbf756d97
.quad 0xbf3daef9bf3504f3,0xbf4d9f02bf45e403,0xbf466354bf3daef9,0xbf5627febf4e8d90,0xbf4e8d90bf45e403,0xbf5df6bebf5695e5,0xbf5627febf4d9f02,0xbf650479bf5df6be
.quad 0xbf5d2d53bf54db31,0xbf6b4b0cbf64aa59,0xbf6398acbf5b941a,0xbf70c501bf6aab7b,0xbf696591bf61c598,0xbf756d97bf6ff573,0xbf6e8ff8bf676bd8,0xbf7940c0bf748422
.quad 0xbf731447bf6c835e,0xbf7c3b28bf7853f8,0xbf76ef5bbf710908,0xbf7e5a38bf7b61fc,0xbf7a1e84bf74fa0b,0xbf7f9c18bf7dabcc,0xbf7c9f8abf7853f8,0xbf7fffb1bf7f2f9d
.quad 0xbf7e70b0bf7b14be,0xbf7f84abbf7fec43,0xbf7f90b1bf7d3aac,0xbf7e2b72bf7fe129,0xbf7ffec4bf7ec46d,0xbf7bf531bf7f0e58,0xbf7fba9ebf7fb10f,0xbf78e3d6bf7d7474
.quad 0xbf5b941abf54db31,0xbf676bd8bf61c598,0xbf6398acbf5d2d53,0xbf6e8ff8bf696591,0xbf6aab7bbf64aa59,0xbf748422bf6ff573,0xbf70c501bf6b4b0c,0xbf7940c0bf756d97
.quad 0xbf75dec6bf710908,0xbf7cbfc9bf79c79d,0xbf79f35ebf75dec6,0xbf7efcc9bf7cfe73,0xbf7cfe73bf79c79d,0xbf7ff4e6bf7f0e58,0xbf7efcc9bf7cbfc9,0xbf7fa6e3bf7ff4e6
.quad 0xbf7fec43bf7ec46d,0xbf7e1324bf7fb10f,0xbf7fcbe2bf7fd397,0xbf7b3babbf7e4323,0xbf7e9bc9bf7fec43,0xbf772417bf7baccd,0xbf7c5d3abf7f0e58,0xbf71d19fbf77f110
.quad 0xbf791298bf7d3aac,0xbf6b4b0cbf731447,0xbf74bf62bf7a7302,0xbf6398acbf6d1c1d,0xbf6f6830bf76ba07,0xbf5ac450bf660f88,0xbf6912aebf721352,0xbf50d937bf5df6be
.quad 0xbf710908bf6c835e,0xbf7853f8bf74fa0b,0xbf76ef5bbf731447,0xbf7c9f8abf7a1e84,0xbf7b61fcbf7853f8,0xbf7f2f9dbf7dabcc,0xbf7e5a38bf7c3b28,0xbf7fffb1bf7f9c18
.quad 0xbf7fd397bf7ec46d,0xbf7f0e58bf7fec43,0xbf7fcbe2bf7fec43,0xbf7c5d3abf7e9bc9,0xbf7e4323bf7fb10f,0xbf77f110bf7baccd,0xbf7b3babbf7e1324,0xbf71d19fbf772417
.quad 0xbf76ba07bf7b14be,0xbf6a09a7bf710908,0xbf70c501bf76ba07,0xbf60a6cfbf696591,0xbf696591bf710908,0xbf55b993bf604621,0xbf60a6cfbf6a09a7,0xbf495521bf55b993
.quad 0xbf5695e5bf61c598,0xbf3b8f3bbf49d112,0xbf4b41fabf584853,0xbf2c800fbf3ca003,0xbf3ebc1bbf4d9f02,0xbf1c420cbf2e3bde,0xbf311722bf41d870,0xbf0af1b7bf1ebc12
.quad 0xbf7d3aacbf7b14be,0xbf7fb10fbf7ec46d,0xbf7f90b1bf7e70b0,0xbf7fba9ebf7ffec4,0xbf7fe129bf7fec43,0xbf7d7474bf7f0e58,0xbf7e2b72bf7f84ab,0xbf78e3d6bf7bf531
.quad 0xbf7a7302bf7d3aac,0xbf721352bf76ba07,0xbf74bf62bf791298,0xbf6912aebf6f6830,0xbf6d1c1dbf731447,0xbf5df6bebf660f88,0xbf6398acbf6b4b0c,0xbf50d937bf5ac450
.quad 0xbf584853bf61c598,0xbf41d870bf4d9f02,0xbf4b41fabf5695e5,0xbf311722bf3ebc1b,0xbf3ca003bf49d112,0xbf1ebc12bf2e3bde,0xbf2c800fbf3b8f3b,0xbf0af1b7bf1c420c
.quad 0xbf1b02c6bf2beb4a,0xbeebcbbbbf08f59b,0xbf084b92bf1b02c6,0xbebf926fbee900b7,0xbee900b7bf08f59b,0xbe919dddbebe1d4a,0xbebf926fbeebcbbb,0xbe44b0b9be919ddd
.quad 0x3f7ec46d3f800000,0x3f74fa0b3f7b14be,0x3f7eb0693f800000,0x3f74484b3f7ac516,0x3f7e9bc93f800000,0x3f73913f3f7a7302,0x3f7e868b3f800000,0x3f72d4eb3f7a1e84
.quad 0x3f7e70b03f800000,0x3f7213523f79c79d,0x3f7e5a383f800000,0x3f714c7a3f796e4e,0x3f7e43233f800000,0x3f7080663f791298,0x3f7e2b723f800000,0x3f6faf1b3f78b47b
.quad 0x3f7e13243f800000,0x3f6ed89e3f7853f8,0x3f7dfa383f800000,0x3f6dfcf23f77f110,0x3f7de0b13f800000,0x3f6d1c1d3f778bc5,0x3f7dc68c3f800000,0x3f6c36243f772417
.quad 0x3f7dabcc3f800000,0x3f6b4b0c3f76ba07,0x3f7d906e3f800000,0x3f6a5ad93f764d97,0x3f7d74743f800000,0x3f6965913f75dec6,0x3f7d57de3f800000,0x3f686b393f756d97
.quad 0x3f61c5983f6c835e,0x3f45e4033f54db31,0x3f5fe4e93f6b4b0c,0x3f425b893f5233c6,0x3f5df6be3f6a09a7,0x3f3ebc1b3f4f7a1f,0x3f5bfb343f68bf3c,0x3f3b06293f4cae79
.quad 0x3f59f26a3f676bd8,0x3f373a233f49d112,0x3f57dc7f3f660f88,0x3f33587a3f46e22a,0x3f55b9933f64aa59,0x3f2f61a53f43e200,0x3f5389c73f633c5a,0x3f2b561b3f40d0da
.quad 0x3f514d3d3f61c598,0x3f2736563f3daef9,0x3f4f04173f604621,0x3f2302d33f3a7ca4,0x3f4cae793f5ebe05,0x3f1ebc123f373a23,0x3f4a4c873f5d2d53,0x3f1a62933f33e7bc
.quad 0x3f47de653f5b941a,0x3f15f6d93f3085bb,0x3f4564393f59f26a,0x3f11796b3f2d1469,0x3f42de293f584853,0x3f0cead03f299415,0x3f404c5c3f5695e5,0x3f084b923f26050a
.quad 0x3f2267993f3504f3,0x3ef15aea3f0e39da,0x3f1ce11f3f3085bb,0x3ee1fb6a3f07a136,0x3f173c073f2beb4a,0x3ed25a093f00e7e4,0x3f11796b3f273656,0x3ec27b553ef41f07
.quad 0x3f0b9a6b3f226799,0x3eb263ef3ee63375,0x3f05a02c3f1d7fd1,0x3ea218873ed8106b,0x3eff17b23f187fc0,0x3e919ddd3ec9b953,0x3ef2bd433f13682a,0x3e80f8c03ebb31a0
.quad 0x3ee633753f0e39da,0x3e605c133eac7cd4,0x3ed97cb93f08f59b,0x3e3e853e3e9d9e78,0x3ecc9b8b3f039c3d,0x3e1c76de3e8e9a22,0x3ebf926f3efc5d27,0x3df475c03e7ee6e1
.quad 0x3eb263ef3ef15aea,0x3dafb6803e605c13,0x3ea5129f3ee63375,0x3d55880e3e419b37,0x3e97a1173edae880,0x3c96c9b63e22abb6,0x3e8a11f73ecf7bca,0xbc7b514b3e039502
.quad 0x3e94a0313ec3ef15,0x3dc8bd363e47c5c2,0x3e80f8c03eb263ef,0x3d55880e3e1c76de,0x3e5a39973ea09ae5,0x3bc90f883de1bc2e,0x3e3228d43e8e9a22,0xbd2351cb3d8a200a
.quad 0x3e09cf863e78cfcc,0xbdafb6803cc90ab0,0x3dc27c393e541501,0xbe06b26ebc96c9b6,0x3d6214693e2f10a2,0xbe354098bd7b2b74,0x3c7b514b3e09cf86,0xbe636c83bdd53db9
.quad 0xbcc90ab03dc8bd36,0xbe888e93be164083,0xbd83db0a3d7b2b74,0xbe9f1cdfbe419b37,0xbdd53db93cc90ab0,0xbeb554ecbe6c9a7f,0xbe1324cabc490e90,0xbecb2aaebe8b9507
.quad 0xbe3b6ecfbd48fb30,0xbee0924fbea09ae5,0xbe636c83bdafb680,0xbef58035beb554ec,0xbe8586cebdfab273,0xbf04f484bec9b953,0xbe9920febe22abb6,0xbf0ee0dbbeddbe79
.quad 0xbdc8bd3680000000,0xbe94a031be47c5c2,0xbdcefdb780000000,0xbe9920febe4dee60,0xbdd53db980000000,0xbe9d9e78be541501,0xbddb7d3780000000,0xbea21887be5a3997
.quad 0xbde1bc2e80000000,0xbea68f12be605c13,0xbde7fa9a80000000,0xbeab0201be667c66,0xbdee387680000000,0xbeaf713abe6c9a7f,0xbdf475c080000000,0xbeb3dca5be72b651
.quad 0xbdfab27380000000,0xbeb8442abe78cfcc,0xbe00774580000000,0xbebca7afbe7ee6e1,0xbe03950280000000,0xbec1071ebe827dc0,0xbe06b26e80000000,0xbec5625cbe8586ce
.quad 0xbe09cf8680000000,0xbec9b953be888e93,0xbe0cec4a80000000,0xbece0beabe8b9507,0xbe1008b780000000,0xbed25a09be8e9a22,0xbe1324ca80000000,0xbed6a399be919ddd
.quad 0xbef15aeabec3ef15,0xbf226799bf0e39da,0xbef840c8bec9b953,0xbf269de3bf121eb0,0xbeff17b2becf7bca,0xbf2ac082bf15f6d9,0xbf02ef9fbed53641,0xbf2ecef7bf19c200
.quad 0xbf064b82bedae880,0xbf32c8c9bf1d7fd1,0xbf099f4ebee0924f,0xbf36ad7fbf212ff9,0xbf0cead0bee63375,0xbf3a7ca4bf24d225,0xbf102dd5beebcbbb,0xbf3e35c5bf286605
.quad 0xbf13682abef15aea,0xbf41d870bf2beb4a,0xbf16999fbef6e0cb,0xbf456439bf2f61a5,0xbf19c200befc5d27,0xbf48d8b3bf32c8c9,0xbf1ce11fbf00e7e4,0xbf4c3578bf36206c
.quad 0xbf1ff6cbbf039c3d,0xbf4f7a1fbf396842,0xbf2302d3bf064b82,0xbf52a649bf3ca003,0xbf26050abf08f59b,0xbf55b993bf3fc767,0xbf28fd41bf0b9a6b,0xbf58b3a1bf42de29
.quad 0xbf45e403bf3504f3,0xbf61c598bf54db31,0xbf4a4c87bf396842,0xbf65b710bf591e6a,0xbf4e8d90bf3daef9,0xbf696591bf5d2d53,0xbf52a649bf41d870,0xbf6cd007bf6106f2
.quad 0xbf5695e5bf45e403,0xbf6ff573bf64aa59,0xbf5a5ba0bf49d112,0xbf72d4ebbf6816a8,0xbf5df6bebf4d9f02,0xbf756d97bf6b4b0c,0xbf61668abf514d3d,0xbf77beb7bf6e46be
.quad 0xbf64aa59bf54db31,0xbf79c79dbf710908,0xbf67c187bf584853,0xbf7b87b2bf73913f,0xbf6aab7bbf5b941a,0xbf7cfe73bf75dec6,0xbf6d67a1bf5ebe05,0xbf7e2b72bf77f110
.quad 0xbf6ff573bf61c598,0xbf7f0e58bf79c79d,0xbf725470bf64aa59,0xbf7fa6e3bf7b61fc,0xbf748422bf676bd8,0xbf7ff4e6bf7cbfc9,0xbf76841bbf6a09a7,0xbf7ff84abf7de0b1
.quad 0xbf74fa0bbf6c835e,0xbf7ec46dbf7b14be,0xbf77beb7bf6ff573,0xbf7fa6e3bf7cfe73,0xbf7a1e84bf731447,0xbf7ffec4bf7e70b0,0xbf7c187abf75dec6,0xbf7fcbe2bf7f6ac7
.quad 0xbf7dabccbf7853f8,0xbf7f0e58bf7fec43,0xbf7ed7d4bf7a7302,0xbf7dc68cbf7ff4e6,0xbf7f9c18bf7c3b28,0xbf7bf531bf7f84ab,0xbf7ff84abf7dabcc,0xbf799b43bf7e9bc9
.quad 0xbf7fec43bf7ec46d,0xbf76ba07bf7d3aac,0xbf7f7808bf7f84ab,0xbf73530ebf7b61fc,0xbf7e9bc9bf7fec43,0xbf6f6830bf791298,0xbf7d57debf7ffb11,0xbf6afb8cbf764d97
.quad 0xbf7baccdbf7fb10f,0xbf660f88bf731447,0xbf799b43bf7f0e58,0xbf60a6cfbf6f6830,0xbf772417bf7e1324,0xbf5ac450bf6b4b0c,0xbf74484bbf7cbfc9,0xbf546b3bbf66becc
.quad 0xbdc8bd36248d3132,0xbe94a031be47c5c2,0xbe195be0bd48fb30,0xbeb0eacbbe7ee6e1,0xbe4dee60bdc8bd36,0xbecc9b8bbe9aa086,0xbe80f8c0be164083,0xbee79a5dbeb554ec
.quad 0xbe9aa086be47c5c2,0xbf00e7e4becf7bca,0xbeb3dca5be78cfcc,0xbf0d9281bee900b7,0xbecc9b8bbe94a031,0xbf19c200bf00e7e4,0xbee4cbfebeac7cd4,0xbf256bcbbf0cead0
.quad 0xbefc5d27bec3ef15,0xbf3085bbbf187fc0,0xbf099f4ebedae880,0xbf3b0629bf239da9,0xbf14b039bef15aea,0xbf44e3f5bf2e3bde,0xbf1f599fbf039c3d,0xbf4e1689bf385216
.quad 0xbf299415bf0e39da,0xbf5695e5bf41d870,0xbf33587abf187fc0,0xbf5e5aa6bf4ac77f,0xbf3ca003bf226799,0xbf655e0bbf531849,0xbf456439bf2beb4a,0xbf6b99fbbf5ac450
.quad 0xbef15aeabec3ef15,0xbf226799bf0e39da,0xbf06f686bee0924f,0xbf2ff3e6bf1c420c,0xbf14b039befc5d27,0xbf3ca003bf299415,0xbf21cbfbbf0b9a6b,0xbf485bcabf36206c
.quad 0xbf2e3bdebf187fc0,0xbf531849bf41d870,0xbf39f2acbf24d225,0xbf5cc7d1bf4cae79,0xbf44e3f5bf3085bb,0xbf655e0bbf5695e5,0xbf4f0417bf3b8f3b,0xbf6cd007bf5f8327
.quad 0xbf584853bf45e403,0xbf731447bf676bd8,0xbf60a6cfbf4f7a1f,0xbf7822d1bf6e46be,0xbf6816a8bf584853,0xbf7bf531bf740bdd,0xbf6e8ff8bf604621,0xbf7e868bbf78b47b
.quad 0xbf740bddbf676bd8,0xbf7fd397bf7c3b28,0xbf788486bf6db293,0xbf7fdaafbf7e9bc9,0xbf7bf531bf731447,0xbf7e9bc9bf7fd397,0xbf7e5a38bf778bc5,0xbf7c187abf7fe129
.quad 0xbf45e403bf3504f3,0xbf61c598bf54db31,0xbf51c0c2bf41d870,0xbf6afb8cbf5f8327,0xbf5c61c7bf4d9f02,0xbf7294f8bf68bf3c,0xbf65b710bf584853,0xbf788486bf708066
.quad 0xbf6db293bf61c598,0xbf7cbfc9bf76ba07,0xbf74484bbf6a09a7,0xbf7f3f54bf7b61fc,0xbf796e4ebf710908,0xbf7ffec4bf7e70b0,0xbf7d1cddbf76ba07,0xbf7efcc9bf7fe129
.quad 0xbf7f4e6dbf7b14be,0xbf7c3b28bf7fb10f,0xbf7fffb1bf7e1324,0xbf77beb7bf7de0b1,0xbf7f2f9dbf7fb10f,0xbf718f57bf7a7302,0xbf7cdf6cbf7fec43,0xbf69b7e4bf756d97
.quad 0xbf791298bf7ec46d,0xbf604621bf6ed89e,0xbf73ced9bf7c3b28,0xbf554aa4bf66becc,0xbf6d1c1dbf7853f8,0xbf48d8b3bf5d2d53,0xbf650479bf731447,0xbf3b0629bf5233c6
.quad 0xbf74fa0bbf6c835e,0xbf7ec46dbf7b14be,0xbf7a9c59bf740bdd,0xbf7fffb1bf7e9bc9,0xbf7e4323bf79c79d,0xbf7eea9dbf7ffb11,0xbf7fe705bf7dabcc,0xbf7b87b2bf7f2f9d
.quad 0xbf7f84abbf7fb10f,0xbf75dec6bf7c3b28,0xbf7d1cddbf7fd397,0xbf6dfcf2bf772417,0xbf78b47bbf7e1324,0xbf63f473bf6ff573,0xbf725470bf7a7302,0xbf57dc7fbf66becc
.quad 0xbf6a09a7bf74fa0b,0xbf49d112bf5b941a,0xbf5fe4e9bf6db293,0xbf39f2acbf4e8d90,0xbf53fac3bf64aa59,0xbf286605bf3fc767,0xbf466354bf59f26a,0xbf1553b7bf2f61a5
.quad 0xbf373a23bf4d9f02,0xbf00e7e4bf1d7fd1,0xbf269de3bf3fc767,0xbed6a399bf0a48ad,0xbf14b039bf3085bb,0xbea986c4beebcbbb,0xbf019573bf1ff6cb,0xbe75c35abec1071e
.quad 0xbf7ec46dbf800000,0xbf74fa0bbf7b14be,0xbf7d1cddbf7fb10f,0xbf703b37bf77f110,0xbf7ac516bf7ec46d,0xbf6aab7bbf740bdd,0xbf77beb7bf7d3aac,0xbf644facbf6f6830
.quad 0xbf740bddbf7b14be,0xbf5d2d53bf6a09a7,0xbf6faf1bbf7853f8,0xbf554aa4bf63f473,0xbf6aab7bbf74fa0b,0xbf4cae79bf5d2d53,0xbf650479bf710908,0xbf436051bf55b993
.quad 0xbf5ebe05bf6c835e,0xbf396842bf4d9f02,0xbf57dc7fbf676bd8,0xbf2ecef7bf44e3f5,0xbf5064afbf61c598,0xbf239da9bf3b8f3b,0xbf485bcabf5b941a,0xbf17de12bf31a81d
.quad 0xbf3fc767bf54db31,0xbf0b9a6bbf273656,0xbf36ad7fbf4d9f02,0xbefdbabbbf1c420c,0xbf2d1469bf45e403,0xbee363fabf10d3cd,0xbf2302d3bf3daef9,0xbec8477cbf04f484
.quad 0xbf61c598bf6c835e,0xbf45e403bf54db31,0xbf5988adbf660f88,0xbf39f2acbf4ac77f,0xbf5064afbf5ebe05,0xbf2d1469bf3fc767,0xbf466354bf5695e5,0xbf1f599fbf33e7bc
.quad 0xbf3b8f3bbf4d9f02,0xbf10d3cdbf273656,0xbf2ff3e6bf43e200,0xbf019573bf19c200,0xbf239da9bf396842,0xbee363fabf0b9a6b,0xbf16999fbf2e3bde,0xbec27b55bef9a02d
.quad 0xbf08f59bbf226799,0xbea09ae5bedae880,0xbef58035bf15f6d9,0xbe7bdba4bebb31a0,0xbed8106bbf08f59b,0xbe354098be9aa086,0xbeb9bb1ebef6e0cb,0xbddb7d37be72b651
.quad 0xbe9aa086bedae880,0xbd16c32cbe2f10a2,0xbe75c35abebe1d4a,0x3d0a342fbdd53db9,0xbe354098bea09ae5,0x3dd53db9bd16c32c,0xbde7fa9abe827dc0,0x3e3228d43cfb49ba
.quad 0xbf226799bf3504f3,0xbef15aeabf0e39da,0xbf12c39abf273656,0xbecb2aaebef9a02d,0xbf0242b1bf187fc0,0xbea395c5bed53641,0xbee1fb6abf08f59b,0xbe75c35abeaf713a
.quad 0xbebe1d4abef15aea,0xbe22abb6be888e93,0xbe9920febecf7bca,0xbd9cecf9be419b37,0xbe667c66beac7cd4,0x3bc90f88bde1bc2e,0xbe195be0be888e93,0x3db5f8dabcfb49ba
.quad 0xbd96a905be47c5c2,0x3e2f10a23d48fb30,0x3b490fc6bdfab273,0x3e80f8c03e039502,0x3da3308cbd48fb30,0x3ea986c43e541501,0x3e1f917b3cc90ab0,0x3ed0eb2a3e919ddd
.quad 0x3e6c9a7f3dc8bd36,0x3ef6e0cb3eb8442a,0x3e9c1faf3e2f10a2,0x3f0d92813eddbe79,0x3ec1071e3e78cfcc,0x3f1ebc123f00e7e4,0x3ee4cbfe3ea09ae5,0x3f2ecef73f121eb0
.quad 0xbe94a031bec3ef15,0xbdc8bd36be47c5c2,0xbe5101f1be9aa086,0xbb490fc6bdd53db9,0xbdee3876be605c13,0x3dbc3ac3bc490e90,0xbce22a7abe09cf86,0x3e3e853e3da3308c
.quad 0x3d7b2b74bd48fb30,0x3e8e9a223e2f10a2,0x3e195be03d16c32c,0x3ebca7af3e8586ce,0x3e72b6513dfab273,0x3ee900b73eb263ef,0x3ea5129f3e541501,0x3f099f4e3eddbe79
.quad 0x3ecf7bca3e94a031,0x3f1d7fd13f039c3d,0x3ef840c83ebe1d4a,0x3f2ff3e63f173c07,0x3f0f87843ee63375,0x3f40d0da3f299415,0x3f21cbfb3f064b82,0x3f4fefa83f3a7ca4
.quad 0x3f32c8c93f187fc0,0x3f5d2d533f49d112,0x3f425b893f299415,0x3f686b393f577026,0x3f5064af3f396842,0x3f718f573f633c5a,0x3f5cc7d13f47de65,0x3f7884863f6d1c1d
.quad 0x3f7d3aac3f800000,0x3f676bd83f74fa0b,0x3f7d1cdd3f800000,0x3f6667713f748422,0x3f7cfe733f800000,0x3f655e0b3f740bdd,0x3f7cdf6c3f800000,0x3f644fac3f73913f
.quad 0x3f7cbfc93f800000,0x3f633c5a3f731447,0x3f7c9f8a3f800000,0x3f62241a3f7294f8,0x3f7c7eb03f800000,0x3f6106f23f721352,0x3f7c5d3a3f800000,0x3f5fe4e93f718f57
.quad 0x3f7c3b283f800000,0x3f5ebe053f710908,0x3f7c187a3f800000,0x3f5d924d3f708066,0x3f7bf5313f800000,0x3f5c61c73f6ff573,0x3f7bd14d3f800000,0x3f5b2c793f6f6830
.quad 0x3f7baccd3f800000,0x3f59f26a3f6ed89e,0x3f7b87b23f800000,0x3f58b3a13f6e46be,0x3f7b61fc3f800000,0x3f5770263f6db293,0x3f7b3bab3f800000,0x3f5627fe3f6d1c1d
.quad 0x3f3daef93f54db31,0x3f039c3d3f226799,0x3f3b06293f531849,0x3efdbabb3f1ebc12,0x3f3852163f514d3d,0x3ef41f073f1b02c6,0x3f3592e73f4f7a1f,0x3eea66813f173c07
.quad 0x3f32c8c93f4d9f02,0x3ee0924f3f13682a,0x3f2ff3e63f4bbbf8,0x3ed6a3993f0f8784,0x3f2d14693f49d112,0x3ecc9b8b3f0b9a6b,0x3f2a2a803f47de65,0x3ec27b553f07a136
.quad 0x3f2736563f45e403,0x3eb8442a3f039c3d,0x3f24381a3f43e200,0x3eadf73c3eff17b2,0x3f212ff93f41d870,0x3ea395c53ef6e0cb,0x3f1e1e223f3fc767,0x3e9920fe3eee9479
.quad 0x3f1b02c63f3daef9,0x3e8e9a223ee63375,0x3f17de123f3b8f3b,0x3e8402703eddbe79,0x3f14b0393f396842,0x3e72b6513ed53641,0x3f11796b3f373a23,0x3e5d4b1a3ecc9b8b
.quad 0x3e78cfcc3ec3ef15,0xbd48fb303dc8bd36,0x3e5d4b1a3eb8442a,0xbda973ba3d8a200a,0x3e419b373eac7cd4,0xbdee38763d16c32c,0x3e25c58c3ea09ae5,0xbe195be03bc90f88
.quad 0x3e09cf863e94a031,0xbe3b6ecfbcc90ab0,0x3ddb7d373e888e93,0xbe5d4b1abd621469,0x3da3308c3e78cfcc,0xbe7ee6e1bdafb680,0x3d55880e3e605c13,0xbe901c2cbdee3876
.quad 0x3cc90ab03e47c5c2,0xbea09ae5be164083,0xbb490fc63e2f10a2,0xbeb0eacbbe354098,0xbcfb49ba3e164083,0xbec1071ebe541501,0xbd6ea0383dfab273,0xbed0eb2abe72b651
.quad 0xbdafb6803dc8bd36,0xbee0924fbe888e93,0xbde7fa9a3d96a905,0xbeeff7fbbe97a117,0xbe1008b73d48fb30,0xbeff17b2bea68f12,0xbe2bf8043cc90ab0,0xbf06f686beb554ec
.quad 0xbeac7cd4be47c5c2,0xbf187fc0bef15aea,0xbebf926fbe6c9a7f,0xbf21cbfbbf0242b1,0xbed25a09be888e93,0xbf2ac082bf0b9a6b,0xbee4cbfebe9aa086,0xbf33587abf14b039
.quad 0xbef6e0cbbeac7cd4,0xbf3b8f3bbf1d7fd1,0xbf044889bebe1d4a,0xbf436051bf26050a,0xbf0cead0becf7bca,0xbf4ac77fbf2e3bde,0xbf1553b7bee0924f,0xbf51c0c2bf36206c
.quad 0xbf1d7fd1bef15aea,0xbf584853bf3daef9,0xbf256bcbbf00e7e4,0xbf5e5aa6bf44e3f5,0xbf2d1469bf08f59b,0xbf63f473bf4bbbf8,0xbf34768fbf10d3cd,0xbf6912aebf5233c6
.quad 0xbf3b8f3bbf187fc0,0xbf6db293bf584853,0xbf425b89bf1ff6cb,0xbf71d19fbf5df6be,0xbf48d8b3bf273656,0xbf756d97bf633c5a,0xbf4f0417bf2e3bde,0xbf788486bf6816a8
.quad 0xbe16408380000000,0xbedae880be94a031,0xbe195be080000000,0xbedf28a9be97a117,0xbe1c76de80000000,0xbee363fabe9aa086,0xbe1f917b80000000,0xbee79a5dbe9d9e78
.quad 0xbe22abb680000000,0xbeebcbbbbea09ae5,0xbe25c58c80000000,0xbeeff7fbbea395c5,0xbe28defc80000000,0xbef41f07bea68f12,0xbe2bf80480000000,0xbef840c8bea986c4
.quad 0xbe2f10a280000000,0xbefc5d27beac7cd4,0xbe3228d480000000,0xbf003a06beaf713a,0xbe35409880000000,0xbf0242b1beb263ef,0xbe3857ec80000000,0xbf044889beb554ec
.quad 0xbe3b6ecf80000000,0xbf064b82beb8442a,0xbe3e853e80000000,0xbf084b92bebb31a0,0xbe419b3780000000,0xbf0a48adbebe1d4a,0xbe44b0b980000000,0xbf0c42c9bec1071e
.quad 0xbf2beb4abf0e39da,0xbf5b941abf45e403,0xbf2ecef7bf10d3cd,0xbf5e5aa6bf48d8b3,0xbf31a81dbf13682a,0xbf6106f2bf4bbbf8,0xbf34768fbf15f6d9,0xbf6398acbf4e8d90
.quad 0xbf373a23bf187fc0,0xbf660f88bf514d3d,0xbf39f2acbf1b02c6,0xbf686b39bf53fac3,0xbf3ca003bf1d7fd1,0xbf6aab7bbf5695e5,0xbf3f41fcbf1ff6cb,0xbf6cd007bf591e6a
.quad 0xbf41d870bf226799,0xbf6ed89ebf5b941a,0xbf446337bf24d225,0xbf70c501bf5df6be,0xbf46e22abf273656,0xbf7294f8bf604621,0xbf495521bf299415,0xbf74484bbf628210
.quad 0xbf4bbbf8bf2beb4a,0xbf75dec6bf64aa59,0xbf4e1689bf2e3bde,0xbf77583abf66becc,0xbf5064afbf3085bb,0xbf78b47bbf68bf3c,0xbf52a649bf32c8c9,0xbf79f35ebf6aab7b
.quad 0xbf7853f8bf6c835e,0xbf7fb10fbf7ec46d,0xbf79f35ebf6ed89e,0xbf7f1f49bf7f6ac7,0xbf7b61fcbf710908,0xbf7e4323bf7fd397,0xbf7c9f8abf731447,0xbf7d1cddbf7ffec4
.quad 0xbf7dabccbf74fa0b,0xbf7baccdbf7fec43,0xbf7e868bbf76ba07,0xbf79f35ebf7f9c18,0xbf7f2f9dbf7853f8,0xbf77f110bf7f0e58,0xbf7fa6e3bf79c79d,0xbf75a67bbf7e4323
.quad 0xbf7fec43bf7b14be,0xbf731447bf7d3aac,0xbf7fffb1bf7c3b28,0xbf703b37bf7bf531,0xbf7fe129bf7d3aac,0xbf6d1c1dbf7a7302,0xbf7f90b1bf7e1324,0xbf69b7e4bf78b47b
.quad 0xbf7f0e58bf7ec46d,0xbf660f88bf76ba07,0xbf7e5a38bf7f4e6d,0xbf62241abf748422,0xbf7d7474bf7fb10f,0xbf5df6bebf721352,0xbf7c5d3abf7fec43,0xbf5988adbf6f6830
.quad 0xbf710908bf7b14be,0xbf4d9f02bf61c598,0xbf6d67a1bf791298,0xbf466354bf5c61c7,0xbf696591bf76ba07,0xbf3ebc1bbf5695e5,0xbf650479bf740bdd,0xbf36ad7fbf5064af
.quad 0xbf604621bf710908,0xbf2e3bdebf49d112,0xbf5b2c79bf6db293,0xbf256bcbbf42de29,0xbf55b993bf6a09a7,0xbf1c420cbf3b8f3b,0xbf4fefa8bf660f88,0xbf12c39abf33e7bc
.quad 0xbf49d112bf61c598,0xbf08f59bbf2beb4a,0xbf436051bf5d2d53,0xbefdbabbbf239da9,0xbf3ca003bf584853,0xbee900b7bf1b02c6,0xbf3592e7bf531849,0xbed3c867bf121eb0
.quad 0xbf2e3bdebf4d9f02,0xbebe1d4abf08f59b,0xbf269de3bf47de65,0xbea80b1fbeff17b2,0xbf1ebc12bf41d870,0xbe919dddbeebcbbb,0xbf16999fbf3b8f3b,0xbe75c35abed8106b
.quad 0xbf4d9f02bf3504f3,0xbf710908bf61c598,0xbf554aa4bf3daef9,0xbf75a67bbf6816a8,0xbf5c61c7bf45e403,0xbf796e4ebf6db293,0xbf62df7bbf4d9f02,0xbf7c5d3abf7294f8
.quad 0xbf68bf3cbf54db31,0xbf7e70b0bf76ba07,0xbf6dfcf2bf5b941a,0xbf7fa6e3bf7a1e84,0xbf7294f8bf61c598,0xbf7ffec4bf7cbfc9,0xbf76841bbf676bd8,0xbf7f7808bf7e9bc9
.quad 0xbf79c79dbf6c835e,0xbf7e1324bf7fb10f,0xbf7c5d3abf710908,0xbf7bd14dbf7ffec4,0xbf7e4323bf74fa0b,0xbf78b47bbf7f84ab,0xbf7f7808bf7853f8,0xbf74bf62bf7e4323
.quad 0xbf7ffb11bf7b14be,0xbf6ff573bf7c3b28,0xbf7fcbe2bf7d3aac,0xbf6a5ad9bf796e4e,0xbf7eea9dbf7ec46d,0xbf63f473bf75dec6,0xbf7d57debf7fb10f,0xbf5cc7d1bf718f57
.quad 0xbf7fb10fbf7b14be,0xbf7853f8bf7ec46d,0xbf7ff84abf7dabcc,0xbf73530ebf7c7eb0,0xbf7f2f9dbf7f4e6d,0xbf6d1c1dbf791298,0xbf7d57debf7ffb11,0xbf65b710bf748422
.quad 0xbf7a7302bf7fb10f,0xbf5d2d53bf6ed89e,0xbf76841bbf7e70b0,0xbf5389c7bf6816a8,0xbf718f57bf7c3b28,0xbf48d8b3bf604621,0xbf6b99fbbf791298,0xbf3d27b8bf577026
.quad 0xbf64aa59bf74fa0b,0xbf3085bbbf4d9f02,0xbf5cc7d1bf6ff573,0xbf2302d3bf42de29,0xbf53fac3bf6a09a7,0xbf14b039bf373a23,0xbf4a4c87bf633c5a,0xbf05a02cbf2ac082
.quad 0xbf3fc767bf5b941a,0xbeebcbbbbf1d7fd1,0xbf34768fbf531849,0xbecb2aaebf0f8784,0xbf286605bf49d112,0xbea986c4bf00e7e4,0xbf1ba299bf3fc767,0xbe870adabee363fa
.quad 0xbf5b941abf6c835e,0xbf2beb4abf45e403,0xbf50d937bf64aa59,0xbf1ba299bf385216,0xbf44e3f5bf5b941a,0xbf0a48adbf299415,0xbf37c655bf514d3d,0xbeeff7fbbf19c200
.quad 0xbf299415bf45e403,0xbec9b953bf08f59b,0xbf1a6293bf396842,0xbea21887beee9479,0xbf0a48adbf2beb4a,0xbe72b651bec9b953,0xbef2bd43bf1d7fd1,0xbe1f917bbea395c5
.quad 0xbecf7bcabf0e39da,0xbd96a905be78cfcc,0xbeab0201befc5d27,0x3c16cb58be28defc,0xbe8586cebedae880,0x3dbc3ac3bdafb680,0xbe3e853ebeb8442a,0x3e3228d4bbc90f88
.quad 0xbde1bc2ebe94a031,0x3e827dc03d96a905,0xbd0a342fbe605c13,0x3eab02013e1c76de,0x3d2fe007be164083,0x3ed25a093e6c9a7f,0x3df475c0bd96a905,0x3ef840c83e9d9e78
.quad 0xbedae880bf0e39da,0xbe164083be94a031,0xbeb0eacbbef6e0cb,0xbd55880ebe4dee60,0xbe8586cebecf7bca,0x3d2fe007bde1bc2e,0xbe3228d4bea68f12,0x3e0cec4abc96c9b6
.quad 0xbdafb680be78cfcc,0x3e6c9a7f3d96a905,0x3b490fc6be22abb6,0x3ea5129f3e28defc,0x3dbc3ac3bd96a905,0x3ed25a093e827dc0,0x3e3857ec3c490e90,0x3efdbabb3eaf713a
.quad 0x3e888e933dc8bd36,0x3f13682a3edae880,0x3eb3dca53e3b6ecf,0x3f269de33f0242b1,0x3eddbe793e888e93,0x3f3852163f15f6d9,0x3f02ef9f3eb263ef,0x3f485bca3f286605
.quad 0x3f15f6d93edae880,0x3f5695e53f396842,0x3f27ce613f00e7e4,0x3f62df7b3f48d8b3,0x3f3852163f13682a,0x3f6d1c1d3f5695e5,0x3f4760853f24d225,0x3f75341d3f628210
.quad 0xbf187fc0bf3504f3,0xbeac7cd4bef15aea,0xbf0d9281bf2beb4a,0xbe901c2cbed8106b,0xbf0242b1bf226799,0xbe667c66bebe1d4a,0xbeed3063bf187fc0,0xbe2bf804bea395c5
.quad 0xbed53641bf0e39da,0xbde1bc2ebe888e93,0xbebca7afbf039c3d,0xbd55880ebe5a3997,0xbea395c5bef15aea,0x3bc90f88be22abb6,0xbe8a11f7bedae880,0x3d83db0abdd53db9
.quad 0xbe605c13bec3ef15,0x3dfab273bd48fb30,0xbe2bf804beac7cd4,0x3e3857ec3bc90f88,0xbdee3876be94a031,0x3e72b6513d7b2b74,0xbd83db0abe78cfcc,0x3e9620d23dee3876
.quad 0xbc490e90be47c5c2,0x3eb263ef3e2f10a2,0x3d2351cbbe164083,0x3ece0bea3e667c66,0x3dbc3ac3bdc8bd36,0x3ee900b73e8e9a22,0x3e1324cabd48fb30,0x3f0195733ea986c4
.quad 0xbd48fb30be47c5c2,0x3e78cfcc3dc8bd36,0x3c7b514bbe09cf86,0x3e9f1cdf3e28defc,0x3da3308cbd96a905,0x3ec1071e3e6c9a7f,0x3e1324cabc490e90,0x3ee1fb6a3e97a117
.quad 0x3e5415013d48fb30,0x3f00e7e43eb8442a,0x3e8a11f73de1bc2e,0x3f102dd53ed8106b,0x3ea986c43e2f10a2,0x3f1ebc123ef6e0cb,0x3ec8477c3e6c9a7f,0x3f2c800f3f0a48ad
.quad 0x3ee633753e94a031,0x3f3968423f187fc0,0x3f0195733eb263ef,0x3f4564393f26050a,0x3f0f87843ecf7bca,0x3f5064af3f32c8c9,0x3f1ce11f3eebcbbb,0x3f5a5ba03f3ebc1b
.quad 0x3f2994153f039c3d,0x3f633c5a3f49d112,0x3f3592e73f10d3cd,0x3f6afb8c3f53fac3,0x3f40d0da3f1d7fd1,0x3f718f573f5d2d53,0x3f4b41fa3f299415,0x3f76ef5b3f655e0b
.quad 0x3f039c3d3ec3ef15,0x3f3daef93f226799,0x3f140c5f3ee63375,0x3f4b41fa3f31a81d,0x3f239da93f039c3d,0x3f5770263f3fc767,0x3f3238aa3f13682a,0x3f62241a3f4cae79
.quad 0x3f3fc7673f226799,0x3f6b4b0c3f584853,0x3f4c35783f3085bb,0x3f72d4eb3f628210,0x3f5770263f3daef9,0x3f78b47b3f6b4b0c,0x3f61668a3f49d112,0x3f7cdf6c3f7294f8
.quad 0x3f6a09a73f54db31,0x3f7f4e6d3f7853f8,0x3f714c7a3f5ebe05,0x3f7ffd393f7c7eb0,0x3f7724173f676bd8,0x3f7eea9d3f7f0e58,0x3f7b87b23f6ed89e,0x3f7c187a3f7ffec4
.quad 0x3f7e70b03f74fa0b,0x3f778bc53f7f4e6d,0x3f7fdaaf3f79c79d,0x3f714c7a3f7cfe73,0x3f7fc38f3f7d3aac,0x3f6965913f791298,0x3f7e2b723f7f4e6d,0x3f5fe4e93f73913f
.quad 0x3f676bd83f54db31,0x3f7d3aac3f74fa0b,0x3f703b373f604621,0x3f7fa6e33f7ac516,0x3f7724173f6a09a7,0x3f7fc38f3f7e70b0,0x3f7c187a3f721352,0x3f7d906e3f7ff4e6
.quad 0x3f7f0e583f7853f8,0x3f7912983f7f4e6d,0x3f7fffb13f7cbfc9,0x3f7254703f7c7eb0,0x3f7eea9d3f7f4e6d,0x3f6965913f778bc5,0x3f7bd14d3f7ffb11,0x3f5e5aa63f708066
.quad 0x3f76ba073f7ec46d,0x3f514d3d3f676bd8,0x3f6faf1b3f7baccd,0x3f425b893f5c61c7,0x3f66becc3f76ba07,0x3f31a81d3f4f7a1f,0x3f5bfb343f6ff573,0x3f1f599f3f40d0da
.quad 0x3f4f7a1f3f676bd8,0x3f0b9a6b3f3085bb,0x3f4154e13f5d2d53,0x3eed30633f1ebc12,0x3f31a81d3f514d3d,0x3ec1071e3f0b9a6b,0x3f2093933f43e200,0x3e931f353eee9479
.quad 0x3f8000003f800000,0x3f8000003f800000,0x3f7fffb13f800000,0x3f7ffd393f7ffec4,0x3f7ffec43f800000,0x3f7ff4e63f7ffb11,0x3f7ffd393f800000,0x3f7fe7053f7ff4e6
.quad 0x3f7ffb113f800000,0x3f7fd3973f7fec43,0x3f7ff84a3f800000,0x3f7fba9e3f7fe129,0x3f7ff4e63f800000,0x3f7f9c183f7fd397,0x3f7ff0e33f800000,0x3f7f78083f7fc38f
.quad 0x3f7fec433f800000,0x3f7f4e6d3f7fb10f,0x3f7fe7053f800000,0x3f7f1f493f7f9c18,0x3f7fe1293f800000,0x3f7eea9d3f7f84ab,0x3f7fdaaf3f800000,0x3f7eb0693f7f6ac7
.quad 0x3f7fd3973f800000,0x3f7e70b03f7f4e6d,0x3f7fcbe23f800000,0x3f7e2b723f7f2f9d,0x3f7fc38f3f800000,0x3f7de0b13f7f0e58,0x3f7fba9e3f800000,0x3f7d906e3f7eea9d
.quad 0x3f8000003f800000,0x3f8000003f800000,0x3f7ff84a3f7ffb11,0x3f7ff0e33f7ff4e6,0x3f7fe1293f7fec43,0x3f7fc38f3f7fd397,0x3f7fba9e3f7fd397,0x3f7f78083f7f9c18
.quad 0x3f7f84ab3f7fb10f,0x3f7f0e583f7f4e6d,0x3f7f3f543f7f84ab,0x3f7e868b3f7eea9d,0x3f7eea9d3f7f4e6d,0x3f7de0b13f7e70b0,0x3f7e868b3f7f0e58,0x3f7d1cdd3f7de0b1
.quad 0x3f7e13243f7ec46d,0x3f7c3b283f7d3aac,0x3f7d906e3f7e70b0,0x3f7b3bab3f7c7eb0,0x3f7cfe733f7e1324,0x3f7a1e843f7baccd,0x3f7c5d3a3f7dabcc,0x3f78e3d63f7ac516
.quad 0x3f7baccd3f7d3aac,0x3f778bc53f79c79d,0x3f7aed373f7cbfc9,0x3f76167a3f78b47b,0x3f7a1e843f7c3b28,0x3f7484223f778bc5,0x3f7940c03f7baccd,0x3f72d4eb3f764d97
.quad 0x3f8000003f800000,0x3f8000003f800000,0x3f7fe7053f7fec43,0x3f7fdaaf3f7fe129,0x3f7f9c183f7fb10f,0x3f7f6ac73f7f84ab,0x3f7f1f493f7f4e6d,0x3f7eb0693f7eea9d
.quad 0x3f7e70b03f7ec46d,0x3f7dabcc3f7e1324,0x3f7d906e3f7e1324,0x3f7c5d3a3f7cfe73,0x3f7c7eb03f7d3aac,0x3f7ac5163f7baccd,0x3f7b3bab3f7c3b28,0x3f78e3d63f7a1e84
.quad 0x3f79c79d3f7b14be,0x3f76ba073f7853f8,0x3f7822d13f79c79d,0x3f74484b3f764d97,0x3f764d973f7853f8,0x3f718f573f740bdd,0x3f74484b3f76ba07,0x3f6e8ff83f718f57
.quad 0x3f7213523f74fa0b,0x3f6b4b0c3f6ed89e,0x3f6faf1b3f731447,0x3f67c1873f6be858,0x3f6d1c1d3f710908,0x3f63f4733f68bf3c,0x3f6a5ad93f6ed89e,0x3f5fe4e93f655e0b
.quad 0x3f8000003f800000,0x3f8000003f800000,0x3f7fcbe23f7fd397,0x3f7fba9e3f7fc38f,0x3f7f2f9d3f7f4e6d,0x3f7eea9d3f7f0e58,0x3f7e2b723f7e70b0,0x3f7d906e3f7de0b1
.quad 0x3f7cbfc93f7d3aac,0x3f7baccd3f7c3b28,0x3f7aed373f7baccd,0x3f7940c03f7a1e84,0x3f78b47b3f79c79d,0x3f764d973f778bc5,0x3f76167a3f778bc5,0x3f72d4eb3f748422
.quad 0x3f7314473f74fa0b,0x3f6ed89e3f710908,0x3f6faf1b3f721352,0x3f6a5ad93f6d1c1d,0x3f6be8583f6ed89e,0x3f655e0b3f68bf3c,0x3f67c1873f6b4b0c,0x3f5fe4e93f63f473
.quad 0x3f633c5a3f676bd8,0x3f59f26a3f5ebe05,0x3f5e5aa63f633c5a,0x3f5389c73f591e6a,0x3f591e6a3f5ebe05,0x3f4cae793f531849,0x3f5389c73f59f26a,0x3f4564393f4cae79
.quad 0x0,0x0,0x3b490fc600000000,0x3c16cb583bc90f88,0x3bc90f8800000000,0x3c96c9b63c490e90,0x3c16cb5800000000,0x3ce22a7a3c96c9b6
.quad 0x3c490e9000000000,0x3d16c32c3cc90ab0,0x3c7b514b00000000,0x3d3c6dd53cfb49ba,0x3c96c9b600000000,0x3d6214693d16c32c,0x3cafea6900000000,0x3d83db0a3d2fe007
.quad 0x3cc90ab000000000,0x3d96a9053d48fb30,0x3ce22a7a00000000,0x3da973ba3d621469,0x3cfb49ba00000000,0x3dbc3ac33d7b2b74,0x3d0a342f00000000,0x3dcefdb73d8a200a
.quad 0x3d16c32c00000000,0x3de1bc2e3d96a905,0x3d2351cb00000000,0x3df475c03da3308c,0x3d2fe00700000000,0x3e0395023dafb680,0x3d3c6dd500000000,0x3e0cec4a3dbc3ac3
.quad 0x0,0x0,0x3c7b514b3c490e90,0x3cafea693c96c9b6,0x3cfb49ba3cc90ab0,0x3d2fe0073d16c32c,0x3d3c6dd53d16c32c,0x3d83db0a3d621469
.quad 0x3d7b2b743d48fb30,0x3dafb6803d96a905,0x3d9cecf93d7b2b74,0x3ddb7d373dbc3ac3,0x3dbc3ac33d96a905,0x3e0395023de1bc2e,0x3ddb7d373dafb680,0x3e195be03e039502
.quad 0x3dfab2733dc8bd36,0x3e2f10a23e164083,0x3e0cec4a3de1bc2e,0x3e44b0b93e28defc,0x3e1c76de3dfab273,0x3e5a39973e3b6ecf,0x3e2bf8043e09cf86,0x3e6fa8b23e4dee60
.quad 0x3e3b6ecf3e164083,0x3e827dc03e605c13,0x3e4ada4f3e22abb6,0x3e8d17c03e72b651,0x3e5a39973e2f10a2,0x3e97a1173e827dc0,0x3e698bba3e3b6ecf,0x3ea218873e8b9507
.quad 0x0,0x0,0x3ce22a7a3cc90ab0,0x3d0a342f3cfb49ba,0x3d6214693d48fb30,0x3d8a200a3d7b2b74,0x3da973ba3d96a905,0x3dcefdb73dbc3ac3
.quad 0x3de1bc2e3dc8bd36,0x3e09cf863dfab273,0x3e0cec4a3dfab273,0x3e2bf8043e1c76de,0x3e28defc3e164083,0x3e4dee603e3b6ecf,0x3e44b0b93e2f10a2,0x3e6fa8b23e5a3997
.quad 0x3e605c133e47c5c2,0x3e888e933e78cfcc,0x3e7bdba43e605c13,0x3e9920fe3e8b9507,0x3e8b95073e78cfcc,0x3ea986c43e9aa086,0x3e9920fe3e888e93,0x3eb9bb1e3ea986c4
.quad 0x3ea68f123e94a031,0x3ec9b9533eb8442a,0x3eb3dca53ea09ae5,0x3ed97cb93ec6d529,0x3ec1071e3eac7cd4,0x3ee900b73ed53641,0x3ece0bea3eb8442a,0x3ef840c83ee363fa
.quad 0x0,0x0,0x3d2351cb3d16c32c,0x3d3c6dd53d2fe007,0x3da3308c3d96a905,0x3dbc3ac33dafb680,0x3df475c03de1bc2e,0x3e0cec4a3e039502
.quad 0x3e22abb63e164083,0x3e3b6ecf3e2f10a2,0x3e4ada4f3e3b6ecf,0x3e698bba3e5a3997,0x3e72b6513e605c13,0x3e8b95073e827dc0,0x3e8d17c03e827dc0,0x3ea218873e97a117
.quad 0x3ea09ae53e94a031,0x3eb8442a3eac7cd4,0x3eb3dca53ea68f12,0x3ece0bea3ec1071e,0x3ec6d5293eb8442a,0x3ee363fa3ed53641,0x3ed97cb93ec9b953,0x3ef840c83ee900b7
.quad 0x3eebcbbb3edae880,0x3f064b823efc5d27,0x3efdbabb3eebcbbb,0x3f102dd53f07a136,0x3f07a1363efc5d27,0x3f19c2003f10d3cd,0x3f102dd53f064b82,0x3f2302d33f19c200
.quad 0x3f7fb10f3f800000,0x3f7d3aac3f7ec46d,0x3f7fa6e33f800000,0x3f7cdf6c3f7e9bc9,0x3f7f9c183f800000,0x3f7c7eb03f7e70b0,0x3f7f90b13f800000,0x3f7c187a3f7e4323
.quad 0x3f7f84ab3f800000,0x3f7baccd3f7e1324,0x3f7f78083f800000,0x3f7b3bab3f7de0b1,0x3f7f6ac73f800000,0x3f7ac5163f7dabcc,0x3f7f5ce93f800000,0x3f7a49103f7d7474
.quad 0x3f7f4e6d3f800000,0x3f79c79d3f7d3aac,0x3f7f3f543f800000,0x3f7940c03f7cfe73,0x3f7f2f9d3f800000,0x3f78b47b3f7cbfc9,0x3f7f1f493f800000,0x3f7822d13f7c7eb0
.quad 0x3f7f0e583f800000,0x3f778bc53f7c3b28,0x3f7efcc93f800000,0x3f76ef5b3f7bf531,0x3f7eea9d3f800000,0x3f764d973f7baccd,0x3f7ed7d43f800000,0x3f75a67b3f7b61fc
.quad 0x3f7853f83f7b14be,0x3f7109083f74fa0b,0x3f77583a3f7a7302,0x3f6f20b03f73913f,0x3f764d973f79c79d,0x3f6d1c1d3f721352,0x3f75341d3f791298,0x3f6afb8c3f708066
.quad 0x3f740bdd3f7853f8,0x3f68bf3c3f6ed89e,0x3f72d4eb3f778bc5,0x3f6667713f6d1c1d,0x3f718f573f76ba07,0x3f63f4733f6b4b0c,0x3f703b373f75dec6,0x3f61668a3f696591
.quad 0x3f6ed89e3f74fa0b,0x3f5ebe053f676bd8,0x3f6d67a13f740bdd,0x3f5bfb343f655e0b,0x3f6be8583f731447,0x3f591e6a3f633c5a,0x3f6a5ad93f721352,0x3f5627fe3f6106f2
.quad 0x3f68bf3c3f710908,0x3f5318493f5ebe05,0x3f6715993f6ff573,0x3f4fefa83f5c61c7,0x3f655e0b3f6ed89e,0x3f4cae793f59f26a,0x3f6398ac3f6db293,0x3f4955213f577026
.quad 0x3f676bd83f6c835e,0x3f5b941a3f61c598,0x3f644fac3f6a09a7,0x3f5703483f5df6be,0x3f6106f23f676bd8,0x3f5233c63f59f26a,0x3f5d924d3f64aa59,0x3f4d26fd3f55b993
.quad 0x3f59f26a3f61c598,0x3f47de653f514d3d,0x3f5627fe3f5ebe05,0x3f425b893f4cae79,0x3f5233c63f5b941a,0x3f3ca0033f47de65,0x3f4e16893f584853,0x3f36ad7f3f42de29
.quad 0x3f49d1123f54db31,0x3f3085bb3f3daef9,0x3f4564393f514d3d,0x3f2a2a803f385216,0x3f40d0da3f4d9f02,0x3f239da93f32c8c9,0x3f3c17d93f49d112,0x3f1ce11f3f2d1469
.quad 0x3f373a233f45e403,0x3f15f6d93f273656,0x3f3238aa3f41d870,0x3f0ee0db3f212ff9,0x3f2d14693f3daef9,0x3f07a1363f1b02c6,0x3f27ce613f396842,0x3f003a063f14b039
.quad 0x3f4d9f023f54db31,0x3f3daef93f45e403,0x3f4760853f4f7a1f,0x3f3592e73f3ebc1b,0x3f40d0da3f49d112,0x3f2d14693f373a23,0x3f39f2ac3f43e200,0x3f24381a3f2f61a5
.quad 0x3f32c8c93f3daef9,0x3f1b02c63f273656,0x3f2b561b3f373a23,0x3f11796b3f1ebc12,0x3f239da93f3085bb,0x3f07a1363f15f6d9,0x3f1ba2993f299415,0x3efafef73f0cead0
.quad 0x3f13682a3f226799,0x3ee633753f039c3d,0x3f0af1b73f1b02c6,0x3ed0eb2a3ef41f07,0x3f0242b13f13682a,0x3ebb31a03ee0924f,0x3ef2bd433f0b9a6b,0x3ea5129f3ecc9b8b
.quad 0x3ee0924f3f039c3d,0x3e8e9a223eb8442a,0x3ece0bea3ef6e0cb,0x3e6fa8b23ea395c5,0x3ebb31a03ee63375,0x3e419b373e8e9a22,0x3ea80b1f3ed53641,0x3e1324ca3e72b651
.quad 0x3d48fb3000000000,0x3e1640833dc8bd36,0x3d55880e00000000,0x3e1f917b3dd53db9,0x3d62146900000000,0x3e28defc3de1bc2e,0x3d6ea03800000000,0x3e3228d43dee3876
.quad 0x3d7b2b7400000000,0x3e3b6ecf3dfab273,0x3d83db0a00000000,0x3e44b0b93e039502,0x3d8a200a00000000,0x3e4dee603e09cf86,0x3d9064b400000000,0x3e57278f3e1008b7
.quad 0x3d96a90500000000,0x3e605c133e164083,0x3d9cecf900000000,0x3e698bba3e1c76de,0x3da3308c00000000,0x3e72b6513e22abb6,0x3da973ba00000000,0x3e7bdba43e28defc
.quad 0x3dafb68000000000,0x3e827dc03e2f10a2,0x3db5f8da00000000,0x3e870ada3e354098,0x3dbc3ac300000000,0x3e8b95073e3b6ecf,0x3dc27c3900000000,0x3e901c2c3e419b37
.quad 0x3e78cfcc3e47c5c2,0x3eac7cd43e94a031,0x3e8402703e541501,0x3eb6ccc33e9d9e78,0x3e8b95073e605c13,0x3ec1071e3ea68f12,0x3e931f353e6c9a7f,0x3ecb2aae3eaf713a
.quad 0x3e9aa0863e78cfcc,0x3ed536413eb8442a,0x3ea218873e827dc0,0x3edf28a93ec1071e,0x3ea986c43e888e93,0x3ee900b73ec9b953,0x3eb0eacb3e8e9a22,0x3ef2bd433ed25a09
.quad 0x3eb8442a3e94a031,0x3efc5d273edae880,0x3ebf926f3e9aa086,0x3f02ef9f3ee363fa,0x3ec6d5293ea09ae5,0x3f07a1363eebcbbb,0x3ece0bea3ea68f12,0x3f0c42c93ef41f07
.quad 0x3ed536413eac7cd4,0x3f10d3cd3efc5d27,0x3edc53c13eb263ef,0x3f1553b73f0242b1,0x3ee363fa3eb8442a,0x3f19c2003f064b82,0x3eea66813ebe1d4a,0x3f1e1e223f0a48ad
.quad 0x3edae8803ec3ef15,0x3f039c3d3ef15aea,0x3ee79a5d3ecf7bca,0x3f0af1b73eff17b2,0x3ef41f073edae880,0x3f121eb03f064b82,0x3f003a063ee63375,0x3f19210f3f0cead0
.quad 0x3f064b823ef15aea,0x3f1ff6cb3f13682a,0x3f0c42c93efc5d27,0x3f269de33f19c200,0x3f121eb03f039c3d,0x3f2d14693f1ff6cb,0x3f17de123f08f59b,0x3f33587a3f26050a
.quad 0x3f1d7fd13f0e39da,0x3f3968423f2beb4a,0x3f2302d33f13682a,0x3f3f41fc3f31a81d,0x3f2866053f187fc0,0x3f44e3f53f373a23,0x3f2da8593f1d7fd1,0x3f4a4c873f3ca003
.quad 0x3f32c8c93f226799,0x3f4f7a1f3f41d870,0x3f37c6553f273656,0x3f546b3b3f46e22a,0x3f3ca0033f2beb4a,0x3f591e6a3f4bbbf8,0x3f4154e13f3085bb,0x3f5d924d3f5064af
.quad 0x3f187fc03f0e39da,0x3f2beb4a3f226799,0x3f2093933f15f6d9,0x3f34768f3f2ac082,0x3f2866053f1d7fd1,0x3f3ca0033f32c8c9,0x3f2ff3e63f24d225,0x3f4463373f3a7ca4
.quad 0x3f373a233f2beb4a,0x3f4bbbf83f41d870,0x3f3e35c53f32c8c9,0x3f52a6493f48d8b3,0x3f44e3f53f396842,0x3f591e6a3f4f7a1f,0x3f4b41fa3f3fc767,0x3f5f20db3f55b993
.quad 0x3f514d3d3f45e403,0x3f64aa593f5b941a,0x3f5703483f4bbbf8,0x3f69b7e43f6106f2,0x3f5c61c73f514d3d,0x3f6e46be3f660f88,0x3f61668a3f5695e5,0x3f7254703f6aab7b
.quad 0x3f660f883f5b941a,0x3f75dec63f6ed89e,0x3f6a5ad93f604621,0x3f78e3d63f7294f8,0x3f6e46be3f64aa59,0x3f7b61fc3f75dec6,0x3f71d19f3f68bf3c,0x3f7d57de3f78b47b
.quad 0x3f8000003f800000,0x3f8000003f800000,0x3f7fa6e33f7fb10f,0x3f7f90b13f7f9c18,0x3f7e9bc93f7ec46d,0x3f7e43233f7e70b0,0x3f7cdf6c3f7d3aac,0x3f7c187a3f7c7eb0
.quad 0x3f7a73023f7b14be,0x3f7912983f79c79d,0x3f77583a3f7853f8,0x3f75341d3f764d97,0x3f73913f3f74fa0b,0x3f7080663f721352,0x3f6f20b03f710908,0x3f6afb8c3f6d1c1d
.quad 0x3f6a09a73f6c835e,0x3f64aa593f676bd8,0x3f644fac3f676bd8,0x3f5d924d3f6106f2,0x3f5df6be3f61c598,0x3f55b9933f59f26a,0x3f5703483f5b941a,0x3f4d26fd3f5233c6
.quad 0x3f4f7a1f3f54db31,0x3f43e2003f49d112,0x3f4760853f4d9f02,0x3f39f2ac3f40d0da,0x3f3ebc1b3f45e403,0x3f2f61a53f373a23,0x3f3592e73f3daef9,0x3f24381a3f2d1469
.quad 0x3f8000003f800000,0x3f8000003f800000,0x3f7f78083f7f84ab,0x3f7f5ce93f7f6ac7,0x3f7de0b13f7e1324,0x3f7d74743f7dabcc,0x3f7b3bab3f7baccd,0x3f7a49103f7ac516
.quad 0x3f778bc53f7853f8,0x3f75dec63f76ba07,0x3f72d4eb3f740bdd,0x3f703b373f718f57,0x3f6d1c1d3f6ed89e,0x3f6965913f6b4b0c,0x3f6667713f68bf3c,0x3f61668a3f63f473
.quad 0x3f5ebe053f61c598,0x3f5848533f5b941a,0x3f5627fe3f59f26a,0x3f4e16893f5233c6,0x3f4cae793f514d3d,0x3f42de293f47de65,0x3f425b893f47de65,0x3f36ad7f3f3ca003
.quad 0x3f373a233f3daef9,0x3f2994153f3085bb,0x3f2b561b3f32c8c9,0x3f1ba2993f239da9,0x3f1ebc123f273656,0x3f0cead03f15f6d9,0x3f11796b3f1b02c6,0x3efafef73f07a136
.quad 0x3f8000003f800000,0x3f8000003f800000,0x3f7f3f543f7f4e6d,0x3f7f1f493f7f2f9d,0x3f7cfe733f7d3aac,0x3f7c7eb03f7cbfc9,0x3f7940c03f79c79d,0x3f7822d13f78b47b
.quad 0x3f740bdd3f74fa0b,0x3f7213523f731447,0x3f6d67a13f6ed89e,0x3f6a5ad93f6be858,0x3f655e0b3f676bd8,0x3f6106f23f633c5a,0x3f5bfb343f5ebe05,0x3f5627fe3f591e6a
.quad 0x3f514d3d3f54db31,0x3f49d1123f4d9f02,0x3f4564393f49d112,0x3f3c17d93f40d0da,0x3f3852163f3daef9,0x3f2d14693f32c8c9,0x3f2a2a803f3085bb,0x3f1ce11f3f239da9
.quad 0x3f1b02c63f226799,0x3f0b9a6b3f13682a,0x3f0af1b73f13682a,0x3ef2bd433f0242b1,0x3ef41f073f039c3d,0x3ecc9b8b3ee0924f,0x3ed0eb2a3ee63375,0x3ea5129f3ebb31a0
.quad 0x3f8000003f800000,0x3f8000003f800000,0x3f7efcc93f7f0e58,0x3f7ed7d43f7eea9d,0x3f7bf5313f7c3b28,0x3f7b61fc3f7baccd,0x3f76ef5b3f778bc5,0x3f75a67b3f764d97
.quad 0x3f6ff5733f710908,0x3f6db2933f6ed89e,0x3f6715993f68bf3c,0x3f6398ac3f655e0b,0x3f5c61c73f5ebe05,0x3f5770263f59f26a,0x3f4fefa83f531849,0x3f4955213f4cae79
.quad 0x3f41d8703f45e403,0x3f3968423f3daef9,0x3f3238aa3f373a23,0x3f27ce613f2d1469,0x3f212ff93f273656,0x3f14b0393f1b02c6,0x3f0ee0db3f15f6d9,0x3f003a063f07a136
.quad 0x3ef6e0cb3f039c3d,0x3ed536413ee63375,0x3ece0bea3ee0924f,0x3ea80b1f3ebb31a0,0x3ea395c53eb8442a,0x3e72b6513e8e9a22,0x3e6fa8b23e8e9a22,0x3e1324ca3e419b37
.quad 0x0,0x0,0x3d55880e3d48fb30,0x3d6ea0383d621469,0x3dd53db93dc8bd36,0x3dee38763de1bc2e,0x3e1f917b3e164083,0x3e3228d43e28defc
.quad 0x3e5415013e47c5c2,0x3e6c9a7f3e605c13,0x3e8402703e78cfcc,0x3e931f353e8b9507,0x3e9d9e783e94a031,0x3eaf713a3ea68f12,0x3eb6ccc33eac7cd4,0x3ecb2aae3ec1071e
.quad 0x3ecf7bca3ec3ef15,0x3ee633753edae880,0x3ee79a5d3edae880,0x3f003a063ef41f07,0x3eff17b23ef15aea,0x3f0cead03f064b82,0x3f0af1b73f039c3d,0x3f19210f3f121eb0
.quad 0x3f15f6d93f0e39da,0x3f24d2253f1d7fd1,0x3f2093933f187fc0,0x3f2ff3e63f286605,0x3f2ac0823f226799,0x3f3a7ca43f32c8c9,0x3f34768f3f2beb4a,0x3f4463373f3ca003
.quad 0x0,0x0,0x3d83db0a3d7b2b74,0x3d9064b43d8a200a,0x3e0395023dfab273,0x3e1008b73e09cf86,0x3e44b0b93e3b6ecf,0x3e57278f3e4dee60
.quad 0x3e827dc03e78cfcc,0x3e8e9a223e888e93,0x3ea218873e9aa086,0x3eb0eacb3ea986c4,0x3ec1071e3eb8442a,0x3ed25a093ec9b953,0x3edf28a93ed53641,0x3ef2bd433ee900b7
.quad 0x3efc5d273ef15aea,0x3f08f59b3f039c3d,0x3f0c42c93f064b82,0x3f17de123f121eb0,0x3f19c2003f13682a,0x3f26050a3f1ff6cb,0x3f269de33f1ff6cb,0x3f33587a3f2d1469
.quad 0x3f32c8c93f2beb4a,0x3f3fc7673f396842,0x3f3e35c53f373a23,0x3f4b41fa3f44e3f5,0x3f48d8b33f41d870,0x3f55b9933f4f7a1f,0x3f52a6493f4bbbf8,0x3f5f20db3f591e6a
.quad 0x0,0x0,0x3d9cecf93d96a905,0x3da973ba3da3308c,0x3e1c76de3e164083,0x3e28defc3e22abb6,0x3e698bba3e605c13,0x3e7bdba43e72b651
.quad 0x3e9aa0863e94a031,0x3ea68f123ea09ae5,0x3ebf926f3eb8442a,0x3ece0bea3ec6d529,0x3ee363fa3edae880,0x3ef41f073eebcbbb,0x3f02ef9f3efc5d27,0x3f0c42c93f07a136
.quad 0x3f13682a3f0e39da,0x3f1d7fd13f187fc0,0x3f2302d33f1d7fd1,0x3f2da8593f286605,0x3f31a81d3f2beb4a,0x3f3ca0033f373a23,0x3f3f41fc3f396842,0x3f4a4c873f44e3f5
.quad 0x3f4bbbf83f45e403,0x3f5695e53f514d3d,0x3f5703483f514d3d,0x3f61668a3f5c61c7,0x3f6106f23f5b941a,0x3f6aab7b3f660f88,0x3f69b7e43f64aa59,0x3f7254703f6e46be
.quad 0x0,0x0,0x3db5f8da3dafb680,0x3dc27c393dbc3ac3,0x3e3540983e2f10a2,0x3e419b373e3b6ecf,0x3e870ada3e827dc0,0x3e901c2c3e8b9507
.quad 0x3eb263ef3eac7cd4,0x3ebe1d4a3eb8442a,0x3edc53c13ed53641,0x3eea66813ee363fa,0x3f0242b13efc5d27,0x3f0a48ad3f064b82,0x3f1553b73f10d3cd,0x3f1e1e223f19c200
.quad 0x3f2736563f226799,0x3f3085bb3f2beb4a,0x3f37c6553f32c8c9,0x3f4154e13f3ca003,0x3f46e22a3f41d870,0x3f5064af3f4bbbf8,0x3f546b3b3f4f7a1f,0x3f5d924d3f591e6a
.quad 0x3f6046213f5b941a,0x3f68bf3c3f64aa59,0x3f6a5ad93f660f88,0x3f71d19f3f6e46be,0x3f7294f83f6ed89e,0x3f78b47b3f75dec6,0x3f78e3d63f75dec6,0x3f7d57de3f7b61fc
.quad 0x3f2beb4a3f3504f3,0x3f187fc03f226799,0x3f21cbfb3f2beb4a,0x3f0c42c93f173c07,0x3f173c073f226799,0x3eff17b23f0b9a6b,0x3f0c42c93f187fc0,0x3ee4cbfe3eff17b2
.quad 0x3f00e7e43f0e39da,0x3ec9b9533ee63375,0x3eea66813f039c3d,0x3eadf73c3ecc9b8b,0x3ed25a093ef15aea,0x3e919ddd3eb263ef,0x3eb9bb1e3edae880,0x3e698bba3e97a117
.quad 0x3ea09ae53ec3ef15,0x3e2f10a23e78cfcc,0x3e870ada3eac7cd4,0x3de7fa9a3e419b37,0x3e5a39973e94a031,0x3d6214693e09cf86,0x3e25c58c3e78cfcc,0xbb490fc63da3308c
.quad 0x3de1bc2e3e47c5c2,0xbd7b2b743cc90ab0,0x3d6ea0383e164083,0xbdf475c0bcfb49ba,0x3bc90f883dc8bd36,0xbe354098bdafb680,0xbd3c6dd53d48fb30,0xbe6fa8b2be1008b7
.quad 0x3f039c3d3f0e39da,0x3edae8803ef15aea,0x3eea66813f00e7e4,0x3eb9bb1e3ed25a09,0x3ecc9b8b3ee63375,0x3e97a1173eb263ef,0x3eadf73c3ec9b953,0x3e698bba3e919ddd
.quad 0x3e8e9a223eac7cd4,0x3e22abb63e605c13,0x3e5d4b1a3e8e9a22,0x3db5f8da3e1c76de,0x3e1c76de3e605c13,0x3c96c9b63dafb680,0x3db5f8da3e22abb6,0xbd55880e3c96c9b6
.quad 0x3cc90ab03dc8bd36,0xbdfab273bd48fb30,0xbd2351cb3d16c32c,0xbe44b0b9bdee3876,0xbdd53db9bcc90ab0,0xbe8586cebe3b6ecf,0xbe2bf804bdafb680,0xbea80b1fbe7ee6e1
.quad 0xbe6c9a7fbe164083,0xbec9b953bea09ae5,0xbe9620d2be541501,0xbeea6681bec1071e,0xbeb554ecbe888e93,0xbf04f484bee0924f,0xbed3c867bea68f12,0xbf140c5fbeff17b2
.quad 0x3eac7cd43ec3ef15,0x3e78cfcc3e94a031,0x3e870ada3ea09ae5,0x3e25c58c3e5a3997,0x3e419b373e78cfcc,0x3da3308c3e09cf86,0x3de7fa9a3e2f10a2,0xbb490fc63d621469
.quad 0x3d16c32c3dc8bd36,0xbdafb680bcc90ab0,0xbd2351cb3cc90ab0,0xbe2bf804bdd53db9,0xbdee3876bd48fb30,0xbe7ee6e1be3b6ecf,0xbe44b0b9bdfab273,0xbea80b1fbe8586ce
.quad 0xbe888e93be47c5c2,0xbecf7bcabeac7cd4,0xbeadf73cbe888e93,0xbef58035bed25a09,0xbed25a09beac7cd4,0xbf0cead0bef6e0cb,0xbef58035becf7bca,0xbf1e1e22bf0cead0
.quad 0xbf0b9a6bbef15aea,0xbf2e3bdebf1d7fd1,0xbf1ba299bf08f59b,0xbf3d27b8bf2d1469,0xbf2ac082bf187fc0,0xbf4ac77fbf3b8f3b,0xbf38dd65bf273656,0xbf570348bf48d8b3
.quad 0x3e1640833e47c5c2,0x3d48fb303dc8bd36,0x3d6ea0383de1bc2e,0xbd3c6dd53bc90f88,0xbcfb49ba3cc90ab0,0xbe1008b7bdafb680,0xbdf475c0bd7b2b74,0xbe6fa8b2be354098
.quad 0xbe541501be164083,0xbea68f12be888e93,0xbe9620d2be6c9a7f,0xbed3c867beb554ec,0xbec1071ebea09ae5,0xbeff17b2bee0924f,0xbeea6681bec9b953,0xbf140c5fbf04f484
.quad 0xbf08f59bbef15aea,0xbf273656bf187fc0,0xbf1ba299bf0b9a6b,0xbf38dd65bf2ac082,0xbf2d1469bf1d7fd1,0xbf48d8b3bf3b8f3b,0xbf3d27b8bf2e3bde,0xbf570348bf4ac77f
.quad 0xbf4bbbf8bf3daef9,0xbf633c5abf584853,0xbf58b3a1bf4bbbf8,0xbf6d67a1bf63f473,0xbf63f473bf584853,0xbf756d97bf6db293,0xbf6d67a1bf633c5a,0xbf7b3babbf756d97
.quad 0x3f3daef93f3504f3,0x3f4d9f023f45e403,0x3f4663543f3daef9,0x3f5627fe3f4e8d90,0x3f4e8d903f45e403,0x3f5df6be3f5695e5,0x3f5627fe3f4d9f02,0x3f6504793f5df6be
.quad 0x3f5d2d533f54db31,0x3f6b4b0c3f64aa59,0x3f6398ac3f5b941a,0x3f70c5013f6aab7b,0x3f6965913f61c598,0x3f756d973f6ff573,0x3f6e8ff83f676bd8,0x3f7940c03f748422
.quad 0x3f7314473f6c835e,0x3f7c3b283f7853f8,0x3f76ef5b3f710908,0x3f7e5a383f7b61fc,0x3f7a1e843f74fa0b,0x3f7f9c183f7dabcc,0x3f7c9f8a3f7853f8,0x3f7fffb13f7f2f9d
.quad 0x3f7e70b03f7b14be,0x3f7f84ab3f7fec43,0x3f7f90b13f7d3aac,0x3f7e2b723f7fe129,0x3f7ffec43f7ec46d,0x3f7bf5313f7f0e58,0x3f7fba9e3f7fb10f,0x3f78e3d63f7d7474
.quad 0x3f5b941a3f54db31,0x3f676bd83f61c598,0x3f6398ac3f5d2d53,0x3f6e8ff83f696591,0x3f6aab7b3f64aa59,0x3f7484223f6ff573,0x3f70c5013f6b4b0c,0x3f7940c03f756d97
.quad 0x3f75dec63f710908,0x3f7cbfc93f79c79d,0x3f79f35e3f75dec6,0x3f7efcc93f7cfe73,0x3f7cfe733f79c79d,0x3f7ff4e63f7f0e58,0x3f7efcc93f7cbfc9,0x3f7fa6e33f7ff4e6
.quad 0x3f7fec433f7ec46d,0x3f7e13243f7fb10f,0x3f7fcbe23f7fd397,0x3f7b3bab3f7e4323,0x3f7e9bc93f7fec43,0x3f7724173f7baccd,0x3f7c5d3a3f7f0e58,0x3f71d19f3f77f110
.quad 0x3f7912983f7d3aac,0x3f6b4b0c3f731447,0x3f74bf623f7a7302,0x3f6398ac3f6d1c1d,0x3f6f68303f76ba07,0x3f5ac4503f660f88,0x3f6912ae3f721352,0x3f50d9373f5df6be
.quad 0x3f7109083f6c835e,0x3f7853f83f74fa0b,0x3f76ef5b3f731447,0x3f7c9f8a3f7a1e84,0x3f7b61fc3f7853f8,0x3f7f2f9d3f7dabcc,0x3f7e5a383f7c3b28,0x3f7fffb13f7f9c18
.quad 0x3f7fd3973f7ec46d,0x3f7f0e583f7fec43,0x3f7fcbe23f7fec43,0x3f7c5d3a3f7e9bc9,0x3f7e43233f7fb10f,0x3f77f1103f7baccd,0x3f7b3bab3f7e1324,0x3f71d19f3f772417
.quad 0x3f76ba073f7b14be,0x3f6a09a73f710908,0x3f70c5013f76ba07,0x3f60a6cf3f696591,0x3f6965913f710908,0x3f55b9933f604621,0x3f60a6cf3f6a09a7,0x3f4955213f55b993
.quad 0x3f5695e53f61c598,0x3f3b8f3b3f49d112,0x3f4b41fa3f584853,0x3f2c800f3f3ca003,0x3f3ebc1b3f4d9f02,0x3f1c420c3f2e3bde,0x3f3117223f41d870,0x3f0af1b73f1ebc12
.quad 0x3f7d3aac3f7b14be,0x3f7fb10f3f7ec46d,0x3f7f90b13f7e70b0,0x3f7fba9e3f7ffec4,0x3f7fe1293f7fec43,0x3f7d74743f7f0e58,0x3f7e2b723f7f84ab,0x3f78e3d63f7bf531
.quad 0x3f7a73023f7d3aac,0x3f7213523f76ba07,0x3f74bf623f791298,0x3f6912ae3f6f6830,0x3f6d1c1d3f731447,0x3f5df6be3f660f88,0x3f6398ac3f6b4b0c,0x3f50d9373f5ac450
.quad 0x3f5848533f61c598,0x3f41d8703f4d9f02,0x3f4b41fa3f5695e5,0x3f3117223f3ebc1b,0x3f3ca0033f49d112,0x3f1ebc123f2e3bde,0x3f2c800f3f3b8f3b,0x3f0af1b73f1c420c
.quad 0x3f1b02c63f2beb4a,0x3eebcbbb3f08f59b,0x3f084b923f1b02c6,0x3ebf926f3ee900b7,0x3ee900b73f08f59b,0x3e919ddd3ebe1d4a,0x3ebf926f3eebcbbb,0x3e44b0b93e919ddd
.quad 0x3f8000003f800000,0x3f8000003f800000,0x3f7eb0693f7ec46d,0x3f7e868b3f7e9bc9,0x3f7ac5163f7b14be,0x3f7a1e843f7a7302,0x3f74484b3f74fa0b,0x3f72d4eb3f73913f
.quad 0x3f6b4b0c3f6c835e,0x3f68bf3c3f6a09a7,0x3f5fe4e93f61c598,0x3f5bfb343f5df6be,0x3f5233c63f54db31,0x3f4cae793f4f7a1f,0x3f425b893f45e403,0x3f3b06293f3ebc1b
.quad 0x3f3085bb3f3504f3,0x3f2736563f2beb4a,0x3f1ce11f3f226799,0x3f11796b3f173c07,0x3f07a1363f0e39da,0x3ef41f073f00e7e4,0x3ee1fb6a3ef15aea,0x3ec27b553ed25a09
.quad 0x3eb263ef3ec3ef15,0x3e8e9a223ea09ae5,0x3e80f8c03e94a031,0x3e3228d43e5a3997,0x3e1c76de3e47c5c2,0x3d8a200a3de1bc2e,0x3d55880e3dc8bd36,0xbd2351cb3bc90f88
.quad 0x3f8000003f800000,0x3f8000003f800000,0x3f7e5a383f7e70b0,0x3f7e2b723f7e4323,0x3f796e4e3f79c79d,0x3f78b47b3f791298,0x3f714c7a3f721352,0x3f6faf1b3f708066
.quad 0x3f660f883f676bd8,0x3f633c5a3f64aa59,0x3f57dc7f3f59f26a,0x3f5389c73f55b993,0x3f46e22a3f49d112,0x3f40d0da3f43e200,0x3f33587a3f373a23,0x3f2b561b3f2f61a5
.quad 0x3f1d7fd13f226799,0x3f13682a3f187fc0,0x3f05a02c3f0b9a6b,0x3ef2bd433eff17b2,0x3ed8106b3ee63375,0x3ebb31a03ec9b953,0x3ea218873eb263ef,0x3e80f8c03e919ddd
.quad 0x3e5415013e78cfcc,0x3e09cf863e2f10a2,0x3dc27c393e09cf86,0x3c7b514b3d621469,0xbc96c9b63cc90ab0,0xbdd53db9bd7b2b74,0xbe06b26ebdafb680,0xbe636c83be354098
.quad 0x3f8000003f800000,0x3f8000003f800000,0x3f7dfa383f7e1324,0x3f7dc68c3f7de0b1,0x3f77f1103f7853f8,0x3f7724173f778bc5,0x3f6dfcf23f6ed89e,0x3f6c36243f6d1c1d
.quad 0x3f6046213f61c598,0x3f5d2d533f5ebe05,0x3f4f04173f514d3d,0x3f4a4c873f4cae79,0x3f3a7ca43f3daef9,0x3f33e7bc3f373a23,0x3f2302d33f273656,0x3f1a62933f1ebc12
.quad 0x3f08f59b3f0e39da,0x3efc5d273f039c3d,0x3ed97cb93ee63375,0x3ebf926f3ecc9b8b,0x3e9d9e783eac7cd4,0x3e7ee6e13e8e9a22,0x3e3e853e3e605c13,0x3df475c03e1c76de
.quad 0x3d7b2b743dc8bd36,0xbc490e903cc90ab0,0xbd83db0abcc90ab0,0xbe1324cabdd53db9,0xbe419b37be164083,0xbe8b9507be6c9a7f,0xbe9f1cdfbe888e93,0xbecb2aaebeb554ec
.quad 0x3f8000003f800000,0x3f8000003f800000,0x3f7d906e3f7dabcc,0x3f7d57de3f7d7474,0x3f764d973f76ba07,0x3f756d973f75dec6,0x3f6a5ad93f6b4b0c,0x3f686b393f696591
.quad 0x3f59f26a3f5b941a,0x3f5695e53f584853,0x3f4564393f47de65,0x3f404c5c3f42de29,0x3f2d14693f3085bb,0x3f26050a3f299415,0x3f11796b3f15f6d9,0x3f084b923f0cead0
.quad 0x3ee633753ef15aea,0x3ecf7bca3edae880,0x3ea5129f3eb263ef,0x3e8a11f73e97a117,0x3e419b373e605c13,0x3e0395023e22abb6,0x3d55880e3dafb680,0xbc7b514b3c96c9b6
.quad 0xbdafb680bd48fb30,0xbe22abb6bdfab273,0xbe636c83be3b6ecf,0xbe9920febe8586ce,0xbeb554ecbea09ae5,0xbeddbe79bec9b953,0xbef58035bee0924f,0xbf0ee0dbbf04f484
.quad 0x0,0x0,0x3dcefdb73dc8bd36,0x3ddb7d373dd53db9,0x3e4dee603e47c5c2,0x3e5a39973e541501,0x3e9920fe3e94a031,0x3ea218873e9d9e78
.quad 0x3ec9b9533ec3ef15,0x3ed536413ecf7bca,0x3ef840c83ef15aea,0x3f02ef9f3eff17b2,0x3f121eb03f0e39da,0x3f19c2003f15f6d9,0x3f269de33f226799,0x3f2ecef73f2ac082
.quad 0x3f3968423f3504f3,0x3f41d8703f3daef9,0x3f4a4c873f45e403,0x3f52a6493f4e8d90,0x3f591e6a3f54db31,0x3f6106f23f5d2d53,0x3f65b7103f61c598,0x3f6cd0073f696591
.quad 0x3f6ff5733f6c835e,0x3f75dec63f731447,0x3f77beb73f74fa0b,0x3f7c187a3f7a1e84,0x3f7cfe733f7b14be,0x3f7f6ac73f7e70b0,0x3f7fa6e33f7ec46d,0x3f7fcbe23f7ffec4
.quad 0x0,0x0,0x3de7fa9a3de1bc2e,0x3df475c03dee3876,0x3e667c663e605c13,0x3e72b6513e6c9a7f,0x3eab02013ea68f12,0x3eb3dca53eaf713a
.quad 0x3ee0924f3edae880,0x3eebcbbb3ee63375,0x3f099f4e3f064b82,0x3f102dd53f0cead0,0x3f212ff93f1d7fd1,0x3f2866053f24d225,0x3f36ad7f3f32c8c9,0x3f3e35c53f3a7ca4
.quad 0x3f49d1123f45e403,0x3f514d3d3f4d9f02,0x3f5a5ba03f5695e5,0x3f61668a3f5df6be,0x3f6816a83f64aa59,0x3f6e46be3f6b4b0c,0x3f72d4eb3f6ff573,0x3f77beb73f756d97
.quad 0x3f7a73023f7853f8,0x3f7dabcc3f7c3b28,0x3f7ed7d43f7dabcc,0x3f7ff84a3f7f9c18,0x3f7ff4e63f7fec43,0x3f7e9bc93f7f84ab,0x3f7dc68c3f7f0e58,0x3f799b433f7bf531
.quad 0x0,0x0,0x3e0077453dfab273,0x3e06b26e3e039502,0x3e7ee6e13e78cfcc,0x3e8586ce3e827dc0,0x3ebca7af3eb8442a,0x3ec5625c3ec1071e
.quad 0x3ef6e0cb3ef15aea,0x3f00e7e43efc5d27,0x3f16999f3f13682a,0x3f1ce11f3f19c200,0x3f2f61a53f2beb4a,0x3f36206c3f32c8c9,0x3f4564393f41d870,0x3f4c35783f48d8b3
.quad 0x3f5848533f54db31,0x3f5ebe053f5b941a,0x3f67c1873f64aa59,0x3f6d67a13f6aab7b,0x3f73913f3f710908,0x3f77f1103f75dec6,0x3f7b87b23f79c79d,0x3f7e2b723f7cfe73
.quad 0x3f7f84ab3f7ec46d,0x3f7ffb113f7fec43,0x3f7f78083f7fec43,0x3f7d57de3f7e9bc9,0x3f7b61fc3f7d3aac,0x3f764d973f791298,0x3f73530e3f76ba07,0x3f6afb8c3f6f6830
.quad 0x0,0x0,0x3e0cec4a3e09cf86,0x3e1324ca3e1008b7,0x3e8b95073e888e93,0x3e919ddd3e8e9a22,0x3ece0bea3ec9b953,0x3ed6a3993ed25a09
.quad 0x3f064b823f039c3d,0x3f0b9a6b3f08f59b,0x3f2302d33f1ff6cb,0x3f28fd413f26050a,0x3f3ca0033f396842,0x3f42de293f3fc767,0x3f52a6493f4f7a1f,0x3f58b3a13f55b993
.quad 0x3f64aa593f61c598,0x3f6a09a73f676bd8,0x3f7254703f6ff573,0x3f76841b3f748422,0x3f7b61fc3f79c79d,0x3f7de0b13f7cbfc9,0x3f7fa6e33f7f0e58,0x3f7ff84a3f7ff4e6
.quad 0x3f7f0e583f7fb10f,0x3f7cbfc93f7e1324,0x3f799b433f7baccd,0x3f74484b3f772417,0x3f6f68303f731447,0x3f66becc3f6b4b0c,0x3f60a6cf3f660f88,0x3f546b3b3f5ac450
.quad 0xbd48fb30248d3132,0xbe164083bdc8bd36,0xbe195be0bdc8bd36,0xbe80f8c0be4dee60,0xbe7ee6e1be47c5c2,0xbeb554ecbe9aa086,0xbeb0eacbbe94a031,0xbee79a5dbecc9b8b
.quad 0xbee0924fbec3ef15,0xbf0b9a6bbefc5d27,0xbf06f686bef15aea,0xbf21cbfbbf14b039,0xbf1c420cbf0e39da,0xbf36206cbf299415,0xbf2ff3e6bf226799,0xbf485bcabf3ca003
.quad 0xbf41d870bf3504f3,0xbf584853bf4d9f02,0xbf51c0c2bf45e403,0xbf65b710bf5c61c7,0xbf5f8327bf54db31,0xbf708066bf68bf3c,0xbf6afb8cbf61c598,0xbf788486bf7294f8
.quad 0xbf740bddbf6c835e,0xbf7dabccbf79c79d,0xbf7a9c59bf74fa0b,0xbf7fe705bf7e4323,0xbf7e9bc9bf7b14be,0xbf7f2f9dbf7ffb11,0xbf7fffb1bf7ec46d,0xbf7b87b2bf7eea9d
.quad 0xbe78cfccbe47c5c2,0xbeac7cd4be94a031,0xbeb3dca5be9aa086,0xbee4cbfebecc9b8b,0xbee900b7becf7bca,0xbf0cead0bf00e7e4,0xbf0d9281bf00e7e4,0xbf256bcbbf19c200
.quad 0xbf24d225bf187fc0,0xbf3b8f3bbf3085bb,0xbf39f2acbf2e3bde,0xbf4f0417bf44e3f5,0xbf4cae79bf41d870,0xbf5f8327bf5695e5,0xbf5cc7d1bf531849,0xbf6cd007bf655e0b
.quad 0xbf6a09a7bf61c598,0xbf76ba07bf710908,0xbf74484bbf6db293,0xbf7d1cddbf796e4e,0xbf7b61fcbf76ba07,0xbf7fe129bf7e70b0,0xbf7f3f54bf7cbfc9,0xbf7efcc9bf7ffec4
.quad 0xbf7fd397bf7fb10f,0xbf7a7302bf7e1324,0xbf7d1cddbf7f84ab,0xbf725470bf78b47b,0xbf772417bf7c3b28,0xbf66beccbf6ff573,0xbf6dfcf2bf75dec6,0xbf57dc7fbf63f473
.quad 0xbedae880bec3ef15,0xbf039c3dbef15aea,0xbf099f4ebefc5d27,0xbf1f599fbf14b039,0xbf239da9bf187fc0,0xbf385216bf2e3bde,0xbf3b0629bf3085bb,0xbf4e1689bf44e3f5
.quad 0xbf4f7a1fbf45e403,0xbf604621bf584853,0xbf60a6cfbf584853,0xbf6e8ff8bf6816a8,0xbf6e46bebf676bd8,0xbf78b47bbf740bdd,0xbf7822d1bf731447,0xbf7e868bbf7bf531
.quad 0xbf7e1324bf7b14be,0xbf7fec43bf7fb10f,0xbf7fffb1bf7f4e6d,0xbf7cdf6cbf7f2f9d,0xbf7de0b1bf7fb10f,0xbf756d97bf7a7302,0xbf77beb7bf7c3b28,0xbf69b7e4bf718f57
.quad 0xbf6db293bf74fa0b,0xbf59f26abf64aa59,0xbf5fe4e9bf6a09a7,0xbf466354bf53fac3,0xbf4e8d90bf5b941a,0xbf2f61a5bf3fc767,0xbf39f2acbf49d112,0xbf1553b7bf286605
.quad 0xbf187fc0bf0e39da,0xbf2beb4abf226799,0xbf33587abf299415,0xbf456439bf3ca003,0xbf4ac77fbf41d870,0xbf5ac450bf531849,0xbf5e5aa6bf5695e5,0xbf6b99fbbf655e0b
.quad 0xbf6db293bf676bd8,0xbf778bc5bf731447,0xbf788486bf740bdd,0xbf7e5a38bf7bf531,0xbf7e9bc9bf7c3b28,0xbf7fe129bf7fd397,0xbf7fdaafbf7fd397,0xbf7c187abf7e9bc9
.quad 0xbf7c3b28bf7ec46d,0xbf731447bf7853f8,0xbf73ced9bf791298,0xbf650479bf6d1c1d,0xbf66beccbf6ed89e,0xbf5233c6bf5d2d53,0xbf554aa4bf604621,0xbf3b0629bf48d8b3
.quad 0xbf3fc767bf4d9f02,0xbf1ff6cbbf3085bb,0xbf269de3bf373a23,0xbf019573bf14b039,0xbf0a48adbf1d7fd1,0xbec1071ebeebcbbb,0xbed6a399bf00e7e4,0xbe75c35abea986c4
.quad 0x3f7fb10f3f800000,0x3f7d3aac3f7ec46d,0x3f7d1cdd3f7ec46d,0x3f77beb73f7ac516,0x3f77f1103f7b14be,0x3f6f68303f740bdd,0x3f703b373f74fa0b,0x3f644fac3f6aab7b
.quad 0x3f660f883f6c835e,0x3f5695e53f5ebe05,0x3f5988ad3f61c598,0x3f4663543f5064af,0x3f4ac77f3f54db31,0x3f33e7bc3f3fc767,0x3f39f2ac3f45e403,0x3f1f599f3f2d1469
.quad 0x3f2736563f3504f3,0x3f08f59b3f187fc0,0x3f12c39a3f226799,0x3ee1fb6a3f0242b1,0x3ef9a02d3f0e39da,0x3eaf713a3ed53641,0x3ecb2aae3ef15aea,0x3e75c35a3ea395c5
.quad 0x3e9aa0863ec3ef15,0x3e09cf863e605c13,0x3e5101f13e94a031,0x3ce22a7a3dee3876,0x3dd53db93e47c5c2,0xbda3308c3c490e90,0x3b490fc63dc8bd36,0xbe3e853ebdbc3ac3
.quad 0x3f7853f83f7b14be,0x3f7109083f74fa0b,0x3f6faf1b3f740bdd,0x3f6504793f6aab7b,0x3f63f4733f6a09a7,0x3f55b9933f5d2d53,0x3f554aa43f5d2d53,0x3f4360513f4cae79
.quad 0x3f43e2003f4d9f02,0x3f2e3bde3f396842,0x3f2ff3e63f3b8f3b,0x3f16999f3f239da9,0x3f19c2003f273656,0x3ef9a02d3f0b9a6b,0x3f0195733f10d3cd,0x3ec27b553ee363fa
.quad 0x3ecf7bca3ef15aea,0x3e888e933eac7cd4,0x3e9920fe3ebe1d4a,0x3e195be03e667c66,0x3e419b373e888e93,0x3cfb49ba3de1bc2e,0x3d9cecf93e22abb6,0xbdb5f8dabbc90f88
.quad 0xbd16c32c3d48fb30,0xbe541501bdfab273,0xbe195be0bd7b2b74,0xbea5129fbe72b651,0xbe8586cebe2f10a2,0xbeddbe79beb263ef,0xbebca7afbe8e9a22,0xbf099f4ebee900b7
.quad 0x3f676bd83f6c835e,0x3f5b941a3f61c598,0x3f57dc7f3f5ebe05,0x3f485bca3f5064af,0x3f44e3f53f4d9f02,0x3f31a81d3f3b8f3b,0x3f2ecef73f396842,0x3f17de123f239da9
.quad 0x3f15f6d93f226799,0x3ef6e0cb3f08f59b,0x3ef580353f08f59b,0x3eb9bb1e3ed8106b,0x3ebb31a03edae880,0x3e72b6513e9aa086,0x3e7bdba43ea09ae5,0x3ddb7d373e354098
.quad 0x3dfab2733e47c5c2,0xbcc90ab03d48fb30,0xbb490fc63d96a905,0xbe1f917bbda3308c,0xbe039502bd48fb30,0xbe919dddbe541501,0xbe80f8c0be2f10a2,0xbed0eb2abea986c4
.quad 0xbebe1d4abe94a031,0xbf064b82bee63375,0xbef840c8becf7bca,0xbf21cbfbbf0f8784,0xbf173c07bf039c3d,0xbf3a7ca4bf299415,0xbf2ff3e6bf1d7fd1,0xbf4fefa8bf40d0da
.quad 0x3f4d9f023f54db31,0x3f3daef93f45e403,0x3f36ad7f3f3fc767,0x3f2302d33f2d1469,0x3f1c420c3f273656,0x3f04f4843f10d3cd,0x3efdbabb3f0b9a6b,0x3ec8477c3ee363fa
.quad 0x3ebe1d4a3edae880,0x3e827dc03ea09ae5,0x3e75c35a3e9aa086,0x3de7fa9a3e354098,0x3dd53db93e2f10a2,0xbcfb49ba3d16c32c,0xbd0a342f3d16c32c,0xbe3228d4bdd53db9
.quad 0xbe2f10a2bdc8bd36,0xbea09ae5be78cfcc,0xbe9c1fafbe6c9a7f,0xbee4cbfebec1071e,0xbeddbe79beb8442a,0xbf121eb0bf00e7e4,0xbf0d9281bef6e0cb,0xbf2ecef7bf1ebc12
.quad 0xbf299415bf187fc0,0xbf47de65bf396842,0xbf425b89bf32c8c9,0xbf5cc7d1bf5064af,0xbf577026bf49d112,0xbf6d1c1dbf633c5a,0xbf686b39bf5d2d53,0xbf788486bf718f57
.quad 0x3f8000003f800000,0x3f8000003f800000,0x3f7d1cdd3f7d3aac,0x3f7cdf6c3f7cfe73,0x3f7484223f74fa0b,0x3f73913f3f740bdd,0x3f6667713f676bd8,0x3f644fac3f655e0b
.quad 0x3f5318493f54db31,0x3f4f7a1f3f514d3d,0x3f3b06293f3daef9,0x3f3592e73f385216,0x3f1ebc123f226799,0x3f173c073f1b02c6,0x3efdbabb3f039c3d,0x3eea66813ef41f07
.quad 0x3eb8442a3ec3ef15,0x3ea09ae53eac7cd4,0x3e5d4b1a3e78cfcc,0x3e25c58c3e419b37,0x3d8a200a3dc8bd36,0x3bc90f883d16c32c,0xbda973babd48fb30,0xbe195be0bdee3876
.quad 0xbe6c9a7fbe47c5c2,0xbe9aa086be888e93,0xbebf926fbeac7cd4,0xbee4cbfebed25a09,0xbf0242b1bef15aea,0xbf14b039bf0b9a6b,0xbf21cbfbbf187fc0,0xbf33587abf2ac082
.quad 0x3f8000003f800000,0x3f8000003f800000,0x3f7c9f8a3f7cbfc9,0x3f7c5d3a3f7c7eb0,0x3f7294f83f731447,0x3f718f573f721352,0x3f62241a3f633c5a,0x3f5fe4e93f6106f2
.quad 0x3f4bbbf83f4d9f02,0x3f47de653f49d112,0x3f2ff3e63f32c8c9,0x3f2a2a803f2d1469,0x3f0f87843f13682a,0x3f07a1363f0b9a6b,0x3ed6a3993ee0924f,0x3ec27b553ecc9b8b
.quad 0x3e888e933e94a031,0x3e605c133e78cfcc,0x3ddb7d373e09cf86,0x3d55880e3da3308c,0xbd621469bcc90ab0,0xbdee3876bdafb680,0xbe5d4b1abe3b6ecf,0xbe901c2cbe7ee6e1
.quad 0xbebe1d4abeac7cd4,0xbee0924fbecf7bca,0xbf044889bef6e0cb,0xbf1553b7bf0cead0,0xbf26050abf1d7fd1,0xbf36206cbf2e3bde,0xbf436051bf3b8f3b,0xbf51c0c2bf4ac77f
.quad 0x3f8000003f800000,0x3f8000003f800000,0x3f7c187a3f7c3b28,0x3f7bd14d3f7bf531,0x3f7080663f710908,0x3f6f68303f6ff573,0x3f5d924d3f5ebe05,0x3f5b2c793f5c61c7
.quad 0x3f43e2003f45e403,0x3f3fc7673f41d870,0x3f24381a3f273656,0x3f1e1e223f212ff9,0x3eff17b23f039c3d,0x3eee94793ef6e0cb,0x3eadf73c3eb8442a,0x3e9920fe3ea395c5
.quad 0x3e2f10a23e47c5c2,0x3dfab2733e164083,0xbb490fc63cc90ab0,0xbd6ea038bcfb49ba,0xbe354098be164083,0xbe72b651be541501,0xbeb0eacbbea09ae5,0xbed0eb2abec1071e
.quad 0xbf00e7e4bef15aea,0xbf10d3cdbf08f59b,0xbf256bcbbf1d7fd1,0xbf34768fbf2d1469,0xbf44e3f5bf3daef9,0xbf5233c6bf4bbbf8,0xbf5e5aa6bf584853,0xbf6912aebf63f473
.quad 0x3f8000003f800000,0x3f8000003f800000,0x3f7b87b23f7baccd,0x3f7b3bab3f7b61fc,0x3f6e46be3f6ed89e,0x3f6d1c1d3f6db293,0x3f58b3a13f59f26a,0x3f5627fe3f577026
.quad 0x3f3b8f3b3f3daef9,0x3f373a233f396842,0x3f17de123f1b02c6,0x3f11796b3f14b039,0x3eddbe793ee63375,0x3ecc9b8b3ed53641,0x3e8402703e8e9a22,0x3e5d4b1a3e72b651
.quad 0x3d96a9053dc8bd36,0x3cc90ab03d48fb30,0xbde7fa9abdafb680,0xbe2bf804be1008b7,0xbe97a117be888e93,0xbeb554ecbea68f12,0xbeeff7fbbee0924f,0xbf06f686beff17b2
.quad 0xbf1ff6cbbf187fc0,0xbf2e3bdebf273656,0xbf425b89bf3b8f3b,0xbf4f0417bf48d8b3,0xbf5df6bebf584853,0xbf6816a8bf633c5a,0xbf71d19fbf6db293,0xbf788486bf756d97
.quad 0x0,0x0,0x3e195be03e164083,0x3e1f917b3e1c76de,0x3e97a1173e94a031,0x3e9d9e783e9aa086,0x3edf28a93edae880,0x3ee79a5d3ee363fa
.quad 0x3f10d3cd3f0e39da,0x3f15f6d93f13682a,0x3f2ecef73f2beb4a,0x3f34768f3f31a81d,0x3f48d8b33f45e403,0x3f4e8d903f4bbbf8,0x3f5e5aa63f5b941a,0x3f6398ac3f6106f2
.quad 0x3f6ed89e3f6c835e,0x3f7314473f710908,0x3f79f35e3f7853f8,0x3f7c9f8a3f7b61fc,0x3f7f6ac73f7ec46d,0x3f7ffec43f7fd397,0x3f7f1f493f7fb10f,0x3f7d1cdd3f7e4323
.quad 0x3f7912983f7b14be,0x3f740bdd3f76ba07,0x3f6d67a13f710908,0x3f6504793f696591,0x3f5c61c73f61c598,0x3f5064af3f5695e5,0x3f4663543f4d9f02,0x3f36ad7f3f3ebc1b
.quad 0x0,0x0,0x3e25c58c3e22abb6,0x3e2bf8043e28defc,0x3ea395c53ea09ae5,0x3ea986c43ea68f12,0x3eeff7fb3eebcbbb,0x3ef840c83ef41f07
.quad 0x3f1b02c63f187fc0,0x3f1ff6cb3f1d7fd1,0x3f39f2ac3f373a23,0x3f3f41fc3f3ca003,0x3f53fac33f514d3d,0x3f591e6a3f5695e5,0x3f686b393f660f88,0x3f6cd0073f6aab7b
.quad 0x3f76ba073f74fa0b,0x3f79c79d3f7853f8,0x3f7e868b3f7dabcc,0x3f7fa6e33f7f2f9d,0x3f7f9c183f7fec43,0x3f7e43233f7f0e58,0x3f79f35e3f7baccd,0x3f75a67b3f77f110
.quad 0x3f6db2933f710908,0x3f660f883f6a09a7,0x3f5b2c793f604621,0x3f4fefa83f55b993,0x3f42de293f49d112,0x3f33e7bc3f3b8f3b,0x3f256bcb3f2e3bde,0x3f12c39a3f1c420c
.quad 0x0,0x0,0x3e3228d43e2f10a2,0x3e3857ec3e354098,0x3eaf713a3eac7cd4,0x3eb554ec3eb263ef,0x3f003a063efc5d27,0x3f0448893f0242b1
.quad 0x3f24d2253f226799,0x3f2994153f273656,0x3f4463373f41d870,0x3f4955213f46e22a,0x3f5df6be3f5b941a,0x3f6282103f604621,0x3f70c5013f6ed89e,0x3f74484b3f7294f8
.quad 0x3f7c3b283f7b14be,0x3f7e13243f7d3aac,0x3f7fffb13f7fec43,0x3f7f90b13f7fe129,0x3f7bf5313f7d3aac,0x3f78b47b3f7a7302,0x3f703b373f731447,0x3f69b7e43f6d1c1d
.quad 0x3f5d2d533f61c598,0x3f5318493f584853,0x3f4360513f49d112,0x3f3592e73f3ca003,0x3f239da93f2beb4a,0x3f121eb03f1b02c6,0x3efdbabb3f08f59b,0x3ed3c8673ee900b7
.quad 0x0,0x0,0x3e3e853e3e3b6ecf,0x3e44b0b93e419b37,0x3ebb31a03eb8442a,0x3ec1071e3ebe1d4a,0x3f084b923f064b82,0x3f0c42c93f0a48ad
.quad 0x3f2e3bde3f2beb4a,0x3f32c8c93f3085bb,0x3f4e16893f4bbbf8,0x3f52a6493f5064af,0x3f66becc3f64aa59,0x3f6aab7b3f68bf3c,0x3f77583a3f75dec6,0x3f79f35e3f78b47b
.quad 0x3f7f4e6d3f7ec46d,0x3f7fec433f7fb10f,0x3f7e5a383f7f0e58,0x3f7c5d3a3f7d7474,0x3f7484223f76ba07,0x3f6f68303f721352,0x3f62241a3f660f88,0x3f5988ad3f5df6be
.quad 0x3f47de653f4d9f02,0x3f3b8f3b3f41d870,0x3f269de33f2e3bde,0x3f16999f3f1ebc12,0x3eff17b23f08f59b,0x3ed8106b3eebcbbb,0x3ea80b1f3ebe1d4a,0x3e75c35a3e919ddd
.quad 0xbf3daef9bf3504f3,0xbf4d9f02bf45e403,0xbf554aa4bf4d9f02,0xbf62df7bbf5c61c7,0xbf6816a8bf61c598,0xbf7294f8bf6db293,0xbf75a67bbf710908,0xbf7c5d3abf796e4e
.quad 0xbf7dabccbf7b14be,0xbf7ffb11bf7f4e6d,0xbf7ff84abf7fb10f,0xbf7d57debf7f2f9d,0xbf7c7eb0bf7ec46d,0xbf748422bf791298,0xbf73530ebf7853f8,0xbf65b710bf6d1c1d
.quad 0xbf64aa59bf6c835e,0xbf514d3dbf5b941a,0xbf50d937bf5b941a,0xbf37c655bf44e3f5,0xbf385216bf45e403,0xbf19c200bf299415,0xbf1ba299bf2beb4a,0xbeeff7fbbf0a48ad
.quad 0xbef6e0cbbf0e39da,0xbea68f12becf7bca,0xbeb0eacbbedae880,0xbe3228d4be8586ce,0xbe4dee60be94a031,0xbc96c9b6bde1bc2e,0xbd55880ebe164083,0x3e0cec4a3d2fe007
.quad 0xbf5b941abf54db31,0xbf676bd8bf61c598,0xbf6dfcf2bf68bf3c,0xbf76841bbf7294f8,0xbf7a1e84bf76ba07,0xbf7e9bc9bf7cbfc9,0xbf7fa6e3bf7e70b0,0xbf7f7808bf7ffec4
.quad 0xbf7e70b0bf7fb10f,0xbf791298bf7c3b28,0xbf76841bbf7a7302,0xbf6b99fbbf718f57,0xbf6816a8bf6ed89e,0xbf577026bf604621,0xbf5389c7bf5d2d53,0xbf3d27b8bf48d8b3
.quad 0xbf396842bf45e403,0xbf1d7fd1bf2beb4a,0xbf1a6293bf299415,0xbef2bd43bf0a48ad,0xbeee9479bf08f59b,0xbea395c5bec9b953,0xbea21887bec9b953,0xbe1f917bbe72b651
.quad 0xbe22abb6be78cfcc,0x3c490e90bd96a905,0x3b490fc6bdafb680,0x3e3857ec3dbc3ac3,0x3e28defc3d96a905,0x3eaf713a3e827dc0,0x3ea5129f3e6c9a7f,0x3efdbabb3ed25a09
.quad 0xbf710908bf6c835e,0xbf7853f8bf74fa0b,0xbf7c5d3abf79c79d,0xbf7f7808bf7e4323,0xbf7ffec4bf7fb10f,0xbf7e4323bf7f84ab,0xbf7bd14dbf7e1324,0xbf74bf62bf78b47b
.quad 0xbf6ff573bf74fa0b,0xbf633c5abf6a09a7,0xbf5cc7d1bf64aa59,0xbf4a4c87bf53fac3,0xbf42de29bf4d9f02,0xbf2ac082bf373a23,0xbf2302d3bf3085bb,0xbf05a02cbf14b039
.quad 0xbefc5d27bf0e39da,0xbeb8442abedae880,0xbeab0201becf7bca,0xbe3e853ebe8586ce,0xbe28defcbe78cfcc,0xbbc90f88bdafb680,0x3c16cb58bd96a905,0x3e3228d43dbc3ac3
.quad 0x3e3b6ecf3dc8bd36,0x3eb263ef3e888e93,0x3eb3dca53e888e93,0x3f02ef9f3eddbe79,0x3f0242b13edae880,0x3f2866053f15f6d9,0x3f269de33f13682a,0x3f485bca3f385216
.quad 0xbf7d3aacbf7b14be,0xbf7fb10fbf7ec46d,0xbf7fcbe2bf7ffb11,0xbf7d57debf7eea9d,0xbf796e4ebf7c3b28,0xbf718f57bf75dec6,0xbf6a5ad9bf6ff573,0xbf5cc7d1bf63f473
.quad 0xbf531849bf5b941a,0xbf3fc767bf49d112,0xbf34768fbf3fc767,0xbf1ba299bf286605,0xbf0f8784bf1d7fd1,0xbee363fabf00e7e4,0xbecb2aaebeebcbbb,0xbe870adabea986c4
.quad 0xbe605c13be94a031,0xbd96a905be164083,0xbd0a342fbde1bc2e,0x3df475c03d2fe007,0x3e1c76de3d96a905,0x3e9d9e783e6c9a7f,0x3eab02013e827dc0,0x3ef840c83ed25a09
.quad 0x3f00e7e43edae880,0x3f24d2253f13682a,0x3f27ce613f15f6d9,0x3f4760853f385216,0x3f48d8b33f396842,0x3f6282103f5695e5,0x3f62df7b3f5695e5,0x3f75341d3f6d1c1d
.quad 0x3f2beb4a3f3504f3,0x3f187fc03f226799,0x3f0d92813f187fc0,0x3eed30633f0242b1,0x3ed8106b3ef15aea,0x3ea395c53ebe1d4a,0x3e901c2c3eac7cd4,0x3e2bf8043e667c66
.quad 0x3e09cf863e47c5c2,0x3c490e903d96a905,0xbc7b514b3d48fb30,0xbe1324cabda3308c,0xbe28defcbdc8bd36,0xbe97a117be6c9a7f,0xbe9f1cdfbe78cfcc,0xbee1fb6abec1071e
.quad 0xbee63375bec3ef15,0xbf13682abf039c3d,0xbf140c5fbf039c3d,0xbf3238aabf239da9,0xbf31a81dbf226799,0xbf4cae79bf3fc767,0xbf4b41fabf3daef9,0xbf62241abf577026
.quad 0xbf604621bf54db31,0xbf721352bf6a09a7,0xbf703b37bf676bd8,0xbf7c187abf772417,0xbf7ac516bf74fa0b,0xbf7ff4e6bf7e70b0,0xbf7fa6e3bf7d3aac,0xbf7d906ebf7fc38f
.quad 0x3f039c3d3f0e39da,0x3edae8803ef15aea,0x3ebca7af3ed53641,0x3e8a11f73ea395c5,0x3e5a39973e888e93,0x3dd53db93e22abb6,0x3d55880e3de1bc2e,0xbd83db0abbc90f88
.quad 0xbde1bc2ebd48fb30,0xbe6c9a7fbe2f10a2,0xbe8a11f7be541501,0xbec8477cbea986c4,0xbed8106bbeb8442a,0xbf0a48adbef6e0cb,0xbf102dd5bf00e7e4,0xbf2c800fbf1ebc12
.quad 0xbf3085bbbf226799,0xbf49d112bf3daef9,0xbf4c3578bf3fc767,0xbf61668abf577026,0xbf628210bf584853,0xbf7294f8bf6b4b0c,0xbf72d4ebbf6b4b0c,0xbf7cdf6cbf78b47b
.quad 0xbf7cbfc9bf7853f8,0xbf7ffb11bf7f4e6d,0xbf7fffb1bf7f0e58,0xbf7bd14dbf7eea9d,0xbf7c7eb0bf7f4e6d,0xbf708066bf778bc5,0xbf725470bf791298,0xbf5e5aa6bf696591
.quad 0x3eac7cd43ec3ef15,0x3e78cfcc3e94a031,0x3e2bf8043e605c13,0x3d83db0a3dee3876,0xbbc90f883d48fb30,0xbdee3876bd7b2b74,0xbe3857ecbdfab273,0xbe9620d2be72b651
.quad 0xbeb263efbe94a031,0xbeebcbbbbecf7bca,0xbf019573bee63375,0xbf1ce11fbf0f8784,0xbf26050abf187fc0,0xbf3ebc1bbf32c8c9,0xbf456439bf396842,0xbf5a5ba0bf5064af
.quad 0xbf5ebe05bf54db31,0xbf6ed89ebf676bd8,0xbf714c7abf6a09a7,0xbf7b87b2bf772417,0xbf7c7eb0bf7853f8,0xbf7ffec4bf7f0e58,0xbf7ffd39bf7f4e6d,0xbf7c187abf7eea9d
.quad 0xbf7baccdbf7ec46d,0xbf6ff573bf76ba07,0xbf6faf1bbf76ba07,0xbf5bfb34bf66becc,0xbf5c61c7bf676bd8,0xbf40d0dabf4f7a1f,0xbf425b89bf514d3d,0xbf1f599fbf31a81d
.quad 0x3e1640833e47c5c2,0x3d48fb303dc8bd36,0xbd2351cb3c490e90,0xbe1324cabdbc3ac3,0xbe667c66be2f10a2,0xbea986c4be8e9a22,0xbece0beabeb263ef,0xbf019573bee900b7
.quad 0xbf10d3cdbf039c3d,0xbf299415bf1d7fd1,0xbf3592e7bf299415,0xbf4b41fabf40d0da,0xbf53fac3bf49d112,0xbf655e0bbf5d2d53,0xbf6afb8cbf633c5a,0xbf76ef5bbf718f57
.quad 0xbf79c79dbf74fa0b,0xbf7f4e6dbf7d3aac,0xbf7fdaafbf7e70b0,0xbf7e2b72bf7fc38f,0xbf7cfe73bf7f4e6d,0xbf73913fbf791298,0xbf714c7abf778bc5,0xbf5fe4e9bf696591
.quad 0xbf5d2d53bf676bd8,0xbf43e200bf514d3d,0xbf4154e1bf4f7a1f,0xbf209393bf31a81d,0xbf1ebc12bf3085bb,0xbeee9479bf0b9a6b,0xbeed3063bf0b9a6b,0xbe931f35bec1071e
```
